```python
import torch

def _softmax(x, axis=-1):
    return torch.softmax(x, dim=axis)
def _gelu(x):
    return torch.nn.functional.gelu(x, approximate="tanh")
def _silu(x):
    return torch.nn.functional.silu(x)
def _sigmoid(x):
    return torch.sigmoid(x)
def _layernorm(x, axis=-1, eps=1e-5):
    m = x.mean(dim=axis, keepdim=True)
    v = x.var(dim=axis, keepdim=True, unbiased=False)
    return (x - m) / torch.sqrt(v + eps)
def _scatter_add(tgt, idx, src, axis=0):
    return tgt.clone().index_add_(axis, idx, src)
def _segment_sum(src, seg, n):
    out = torch.zeros((n,) + src.shape[1:], dtype=src.dtype)
    return out.index_add_(0, seg, src)
def _pad(x, pw):
    flat = tuple(v for pair in reversed(pw) for v in pair)
    return torch.nn.functional.pad(x, flat)

kernel_name = 'standalone__mha_block_cached__near_ridge'

def setup_inputs():

    _w = (lambda a: (lambda t: t.to(torch.bfloat16) if t.is_floating_point() else t)(torch.as_tensor(a)))
    B, Sq, D = 8, 256, 576
    H, Sk, Dh = 32, 1024, 128
    return {
        "x": _w((lambda *s: torch.randn(*s, dtype=torch.bfloat16) * 0.8)(B, Sq, D)),
        "k_cache": _w((lambda *s: torch.randn(*s, dtype=torch.bfloat16) * 0.8)(B, H, Sk, Dh)),
        "v_cache": _w((lambda *s: torch.randn(*s, dtype=torch.bfloat16) * 0.05)(B, H, Sk, Dh)),
        "wq": _w((lambda *s: torch.randn(*s, dtype=torch.bfloat16) * 0.8)(D, H * Dh) * (D ** -0.5)),
        "wo": _w((lambda *s: torch.randn(*s, dtype=torch.bfloat16) * 0.05)(H * Dh, D) * ((H * Dh) ** -0.5)),
    }

def reference(x, k_cache, v_cache, wq, wo):
    B, Sq, D = x.shape
    H, Dh = 32, 128
    q = (lambda x, *d: x.permute(*d))((x @ wq).reshape(B, Sq, H, Dh), 0, 2, 1, 3)
    scores = torch.einsum("bhqd,bhkd->bhqk", q, k_cache) * (Dh ** -0.5)
    p = _softmax(scores, axis=-1)
    o = torch.einsum("bhqk,bhkd->bhqd", p, v_cache)
    return (lambda x, *d: x.permute(*d))(o, 0, 2, 1, 3).reshape(B, Sq, H * Dh) @ wo
```

```asm
; @launch grid=(256,1,1) block=(256,1,1) lds=163840
.amdgcn_target "amdgcn-amd-amdhsa--gfx950"
.text
.globl standalone__mha_block_cached__near_ridge_kernel
.p2align 8
.type standalone__mha_block_cached__near_ridge_kernel,@function
standalone__mha_block_cached__near_ridge_kernel:
    s_cmp_ge_u32 s2, 256
    s_cbranch_scc1 L_end
    s_load_dwordx16 s[4:19], s[0:1], 0
    v_and_b32 v1, 63, v0
    v_lshrrev_b32 v2, 6, v0
    s_and_b32 s54, s2, 7
    s_lshr_b32 s66, s2, 3
    v_readfirstlane_b32 s3, v2
    s_and_b32 s64, s54, 1
    s_xor_b32 s64, s64, 0
    s_lshl_b32 s64, s64, 2
    s_and_b32 s55, s66, 3
    s_add_u32 s64, s64, s55
    s_lshr_b32 s65, s54, 1
    s_lshl_b32 s65, s65, 3
    s_lshr_b32 s55, s66, 2
    s_add_u32 s65, s65, s55
    s_nop 0
    s_lshr_b32 s68, s65, 2
    s_and_b32 s69, s65, 3
    s_lshl_b32 s48, s3, 12
    s_add_u32 s70, s65, s64
    s_and_b32 s70, s70, 15
    s_lshl_b32 s70, s70, 14
    s_add_u32 s70, s70, s48
    v_lshrrev_b32 v2, 3, v1
    s_lshl_b32 s54, s3, 6
    v_add_u32 v2, s54, v2
    v_mul_u32_u24 v2, 1152, v2
    v_lshrrev_b32 v3, 4, v1
    v_and_b32 v4, 7, v1
    v_xor_b32 v5, v4, v3
    v_xor_b32 v6, 4, v5
    v_lshl_add_u32 v5, v5, 4, v2
    v_lshl_add_u32 v6, v6, 4, v2
    v_add_u32 v32, 0, v5
    v_add_u32 v33, 8192, v6
    v_add_u32 v34, 16384, v5
    v_add_u32 v35, 24576, v6
    v_add_u32 v36, 36864, v5
    v_add_u32 v37, 45056, v6
    v_add_u32 v38, 53248, v5
    v_add_u32 v39, 61440, v6
    v_lshlrev_b32 v4, 2, v3
    v_and_b32 v5, 15, v1
    v_xor_b32 v4, v4, v5
    v_lshlrev_b32 v4, 4, v4
    s_lshl_b32 s54, s3, 4
    v_add_u32 v6, s54, v3
    v_lshl_add_u32 v7, v6, 13, v4
    v_add_u32 v40, 0, v7
    v_add_u32 v41, 31744, v7
    v_add_u32 v42, 63488, v7
    v_add_u32 v43, 95232, v7
    v_lshrrev_b32 v7, 3, v1
    s_lshr_b32 s54, s66, 2
    s_lshl_b32 s54, s54, 5
    s_lshl_b32 s55, s3, 3
    s_add_u32 s54, s54, s55
    v_add_u32 v7, s54, v7
    v_mul_u32_u24 v7, 1152, v7
    v_and_b32 v4, 7, v1
    v_lshl_add_u32 v118, v4, 4, v7
    s_and_b32 s54, s66, 3
    s_lshl_b32 s54, s54, 4
    s_lshl_b32 s55, s3, 2
    s_add_u32 s54, s54, s55
    v_add_u32 v7, s54, v3
    v_lshlrev_b32 v7, 13, v7
    v_and_b32 v4, 15, v1
    v_lshl_add_u32 v119, v4, 4, v7
    s_waitcnt lgkmcnt(0)
    s_mul_i32 s54, s64, 294912
    s_add_u32 s20, s4, s54
    s_addc_u32 s21, s5, 0
    s_mov_b32 s22, 294912
    s_mov_b32 s23, 0x20000
    s_lshl_b32 s54, s65, 8
    s_add_u32 s24, s10, s54
    s_addc_u32 s25, s11, 0
    s_sub_u32 s26, 4718592, s54
    s_mov_b32 s27, 0x20000
    s_mov_b32 s36, s18
    s_mov_b32 s37, s19
    s_mov_b32 s38, 0x8000000
    s_mov_b32 s39, 0x20000
    s_lshl_b32 s62, s3, 13
    s_mov_b32 s55, 0
    buffer_load_dwordx4 v[44:47], v119, s[24:27], s55 offen
    buffer_load_dwordx4 v[48:51], v118, s[20:23], 0 offen offset:0
    s_mov_b32 s55, 524288
    buffer_load_dwordx4 v[52:55], v119, s[24:27], s55 offen
    buffer_load_dwordx4 v[56:59], v118, s[20:23], 0 offen offset:128
    s_mov_b32 s55, 1048576
    buffer_load_dwordx4 v[60:63], v119, s[24:27], s55 offen
    buffer_load_dwordx4 v[64:67], v118, s[20:23], 0 offen offset:256
    s_mov_b32 s55, 1572864
    buffer_load_dwordx4 v[68:71], v119, s[24:27], s55 offen
    buffer_load_dwordx4 v[72:75], v118, s[20:23], 0 offen offset:384
    s_getpc_b64 s[56:57]
L_pc:
    v_and_b32 v7, 15, v1
    s_lshr_b32 s54, s2, 3
    s_and_b32 s56, s56, 0xffffff00
    s_lshl_b32 s54, s54, 4
    s_sub_u32 s56, s56, ((L_pc - standalone__mha_block_cached__near_ridge_kernel) & 0xffffff00)
    v_add_u32 v7, s54, v7
    s_subb_u32 s57, s57, 0
    v_lshlrev_b32 v7, 7, v7
    v_min_u32 v7, (L_codeend - standalone__mha_block_cached__near_ridge_kernel - 128), v7
    global_load_dword v92, v7, s[56:57]
    s_lshl_b32 s54, s64, 5
    s_add_u32 s54, s54, s65
    s_lshl_b32 s54, s54, 18
    s_add_u32 s28, s6, s54
    s_addc_u32 s29, s7, 0
    s_mov_b32 s30, 262144
    s_mov_b32 s31, 0x20000
    s_add_u32 s32, s8, s54
    s_addc_u32 s33, s9, 0
    s_mov_b32 s34, 262144
    s_mov_b32 s35, 0x20000
    s_mul_i32 s54, s68, 589824
    s_mul_i32 s55, s69, 288
    s_add_u32 s54, s54, s55
    s_add_u32 s40, s12, s54
    s_addc_u32 s41, s13, 0
    s_sub_u32 s42, 4718592, s54
    s_mov_b32 s43, 0x20000
    s_mov_b32 s44, s14
    s_mov_b32 s45, s15
    s_mov_b32 s46, 2359296
    s_mov_b32 s47, 0x20000
    v_lshrrev_b32 v3, 4, v1
    v_and_b32 v5, 15, v1
    v_mov_b32 v6, v3
    v_add_u32 v4, 0, v3
    v_xor_b32 v4, v4, v5
    v_lshlrev_b32 v4, 4, v4
    v_lshl_add_u32 v20, v6, 8, v4
    v_add_u32 v4, 4, v3
    v_xor_b32 v4, v4, v5
    v_lshlrev_b32 v4, 4, v4
    v_lshl_add_u32 v21, v6, 8, v4
    v_add_u32 v4, 8, v3
    v_xor_b32 v4, v4, v5
    v_lshlrev_b32 v4, 4, v4
    v_lshl_add_u32 v22, v6, 8, v4
    v_add_u32 v4, 12, v3
    v_xor_b32 v4, v4, v5
    v_lshlrev_b32 v4, 4, v4
    v_lshl_add_u32 v23, v6, 8, v4
    v_add_u32 v4, 0, v3
    v_lshlrev_b32 v4, 1, v4
    v_xor_b32 v4, v4, v5
    v_lshlrev_b32 v4, 4, v4
    v_lshl_add_u32 v24, v6, 8, v4
    v_add_u32 v4, 4, v3
    v_lshlrev_b32 v4, 1, v4
    v_xor_b32 v4, v4, v5
    v_lshlrev_b32 v4, 4, v4
    v_lshl_add_u32 v25, v6, 8, v4
    s_waitcnt vmcnt(7)
    s_add_u32 m0, s48, 114688
    s_mov_b32 s61, 0
    buffer_load_dwordx4 v40, s[24:27], s61 offen offset:0 lds
    buffer_load_dwordx4 v41, s[24:27], s61 offen offset:1024 lds
    buffer_load_dwordx4 v42, s[24:27], s61 offen offset:2048 lds
    buffer_load_dwordx4 v43, s[24:27], s61 offen offset:3072 lds
    s_add_u32 m0, s62, 32768
    s_mov_b32 s60, 0
    buffer_load_dwordx4 v32, s[20:23], s60 offen offset:0 lds
    buffer_load_dwordx4 v33, s[20:23], s60 offen offset:1024 lds
    buffer_load_dwordx4 v34, s[20:23], s60 offen offset:2048 lds
    buffer_load_dwordx4 v35, s[20:23], s60 offen offset:3072 lds
    s_add_u32 m0, s62, 36864
    s_nop 0
    buffer_load_dwordx4 v36, s[20:23], s60 offen offset:0 lds
    buffer_load_dwordx4 v37, s[20:23], s60 offen offset:1024 lds
    buffer_load_dwordx4 v38, s[20:23], s60 offen offset:2048 lds
    buffer_load_dwordx4 v39, s[20:23], s60 offen offset:3072 lds
    v_lshrrev_b32 v2, 4, v1
    v_bfe_u32 v3, v1, 2, 2
    v_and_b32 v4, 3, v1
    v_and_b32 v5, 15, v1
    v_lshl_add_u32 v6, v2, 3, v3
    v_lshlrev_b32 v6, 8, v6
    v_lshl_add_u32 v6, v4, 4, v6
    v_add_u32 v6, 114688, v6
    v_xor_b32 v7, 0, v3
    v_lshl_add_u32 v114, v7, 6, v6
    v_xor_b32 v7, 1, v3
    v_lshl_add_u32 v115, v7, 6, v6
    v_xor_b32 v7, 2, v3
    v_lshl_add_u32 v116, v7, 6, v6
    v_xor_b32 v7, 3, v3
    v_lshl_add_u32 v117, v7, 6, v6
    s_lshl_b32 s54, s3, 13
    s_add_u32 s54, s54, 32768
    v_lshlrev_b32 v6, 7, v5
    v_add_u32 v6, s54, v6
    v_lshrrev_b32 v30, 1, v5
    v_add_u32 v7, 0, v2
    v_xor_b32 v7, v7, v30
    v_lshl_add_u32 v112, v7, 4, v6
    v_add_u32 v7, 4, v2
    v_xor_b32 v7, v7, v30
    v_lshl_add_u32 v113, v7, 4, v6
    v_lshrrev_b32 v2, 4, v1
    v_bfe_u32 v3, v1, 2, 2
    v_and_b32 v4, 3, v1
    v_and_b32 v5, 15, v1
    v_lshlrev_b32 v6, 8, v5
    v_add_u32 v7, 0, v2
    v_xor_b32 v7, v7, v5
    v_lshl_add_u32 v8, v7, 4, v6
    v_add_u32 v7, 4, v2
    v_xor_b32 v7, v7, v5
    v_lshl_add_u32 v9, v7, 4, v6
    v_add_u32 v7, 8, v2
    v_xor_b32 v7, v7, v5
    v_lshl_add_u32 v10, v7, 4, v6
    v_add_u32 v7, 12, v2
    v_xor_b32 v7, v7, v5
    v_lshl_add_u32 v11, v7, 4, v6
    v_lshl_add_u32 v6, v2, 2, v3
    v_and_b32 v30, 7, v6
    v_lshlrev_b32 v30, 1, v30
    v_lshlrev_b32 v6, 8, v6
    v_and_b32 v7, 1, v4
    v_lshl_add_u32 v6, v7, 3, v6
    v_add_u32 v6, 65536, v6
    v_lshrrev_b32 v31, 1, v4
    v_add_u32 v7, 0, v31
    v_xor_b32 v7, v7, v30
    v_lshl_add_u32 v12, v7, 4, v6
    v_add_u32 v7, 2, v31
    v_xor_b32 v7, v7, v30
    v_lshl_add_u32 v13, v7, 4, v6
    v_add_u32 v7, 4, v31
    v_xor_b32 v7, v7, v30
    v_lshl_add_u32 v14, v7, 4, v6
    v_add_u32 v7, 6, v31
    v_xor_b32 v7, v7, v30
    v_lshl_add_u32 v15, v7, 4, v6
    v_add_u32 v7, 8, v31
    v_xor_b32 v7, v7, v30
    v_lshl_add_u32 v16, v7, 4, v6
    v_add_u32 v7, 10, v31
    v_xor_b32 v7, v7, v30
    v_lshl_add_u32 v17, v7, 4, v6
    v_add_u32 v7, 12, v31
    v_xor_b32 v7, v7, v30
    v_lshl_add_u32 v18, v7, 4, v6
    v_add_u32 v7, 14, v31
    v_xor_b32 v7, v7, v30
    v_lshl_add_u32 v19, v7, 4, v6
    s_mov_b32 s58, 0x3e0293ee
    s_mov_b32 s59, 0x3e0293ee
    v_mov_b32 v7, 0x3f803f80
    v_accvgpr_write_b32 a252, v7
    v_accvgpr_write_b32 a253, v7
    v_accvgpr_write_b32 a254, v7
    v_accvgpr_write_b32 a255, v7
    v_accvgpr_write_b32 a188, 0
    v_accvgpr_write_b32 a189, 0
    v_accvgpr_write_b32 a190, 0
    v_accvgpr_write_b32 a191, 0
    v_mov_b32 v26, 0xff800000
    v_mov_b32 v27, 0xff800000
    v_mov_b32 v28, 0xff800000
    v_mov_b32 v29, 0xff800000
    s_mov_b32 s71, 0
    s_mov_b32 s67, 0
    s_add_u32 m0, s48, 131072
    s_mov_b32 s61, 524288
    buffer_load_dwordx4 v40, s[24:27], s61 offen offset:0 lds
    buffer_load_dwordx4 v41, s[24:27], s61 offen offset:1024 lds
    buffer_load_dwordx4 v42, s[24:27], s61 offen offset:2048 lds
    buffer_load_dwordx4 v43, s[24:27], s61 offen offset:3072 lds
    s_add_u32 m0, s62, 81920
    s_mov_b32 s60, 128
    buffer_load_dwordx4 v32, s[20:23], s60 offen offset:0 lds
    buffer_load_dwordx4 v33, s[20:23], s60 offen offset:1024 lds
    buffer_load_dwordx4 v34, s[20:23], s60 offen offset:2048 lds
    buffer_load_dwordx4 v35, s[20:23], s60 offen offset:3072 lds
    s_add_u32 m0, s62, 86016
    s_nop 0
    buffer_load_dwordx4 v36, s[20:23], s60 offen offset:0 lds
    buffer_load_dwordx4 v37, s[20:23], s60 offen offset:1024 lds
    buffer_load_dwordx4 v38, s[20:23], s60 offen offset:2048 lds
    buffer_load_dwordx4 v39, s[20:23], s60 offen offset:3072 lds
    s_lshl_b32 s54, s64, 5
    s_add_u32 s54, s54, s65
    s_lshl_b32 s54, s54, 7
    s_add_u32 s54, s54, 62914560
    v_mov_b32 v4, 0
    v_and_b32 v5, 15, v1
    v_lshlrev_b32 v7, 2, v5
    v_bfe_u32 v3, v1, 4, 1
    v_mul_u32_u24 v3, 65536, v3
    v_add_u32 v7, v7, v3
    v_cmp_gt_u32 vcc, 32, v1
    v_mov_b32 v6, 0x7fffffff
    s_cmp_eq_u32 s3, 0
    s_cselect_b64 vcc, vcc, 0
    s_nop 1
    v_cndmask_b32 v7, v6, v7, vcc
    buffer_store_dword v4, v7, s[36:39], s54 offen sc1
    s_waitcnt vmcnt(13)
    s_barrier
    ds_read_b128 a[64:67], v112 offset:0
    ds_read_b64_tr_b16 a[96:97], v114 offset:0
    ds_read_b64_tr_b16 a[98:99], v114 offset:1024
    ds_read_b128 a[68:71], v112 offset:2048
    ds_read_b128 a[72:75], v112 offset:4096
    ds_read_b128 a[76:79], v112 offset:6144
    ds_read_b64_tr_b16 a[100:101], v114 offset:8
    ds_read_b64_tr_b16 a[102:103], v114 offset:1032
    ds_read_b64_tr_b16 a[104:105], v115 offset:0
    ds_read_b64_tr_b16 a[106:107], v115 offset:1024
    ds_read_b64_tr_b16 a[108:109], v115 offset:8
    ds_read_b64_tr_b16 a[110:111], v115 offset:1032
    ds_read_b64_tr_b16 a[112:113], v116 offset:0
    ds_read_b64_tr_b16 a[114:115], v116 offset:1024
    ds_read_b64_tr_b16 a[116:117], v116 offset:8
    ds_read_b64_tr_b16 a[118:119], v116 offset:1032
    ds_read_b64_tr_b16 a[120:121], v117 offset:0
    ds_read_b64_tr_b16 a[122:123], v117 offset:1024
    ds_read_b64_tr_b16 a[124:125], v117 offset:8
    ds_read_b64_tr_b16 a[126:127], v117 offset:1032
    s_waitcnt lgkmcnt(0)
    v_mfma_f32_16x16x32_bf16 v[128:131], a[96:99], a[64:67], 0
    ds_read_b128 a[80:83], v113 offset:0
    ds_read_b64_tr_b16 a[128:129], v114 offset:8192
    v_mfma_f32_16x16x32_bf16 v[132:135], a[96:99], a[68:71], 0
    s_mov_b32 s55, 2097152
    buffer_load_dwordx4 v[76:79], v119, s[24:27], s55 offen
    buffer_load_dwordx4 v[80:83], v118, s[20:23], 0 offen offset:512
    v_mfma_f32_16x16x32_bf16 v[136:139], a[96:99], a[72:75], 0
    ds_read_b64_tr_b16 a[130:131], v114 offset:9216
    ds_read_b128 a[84:87], v113 offset:2048
    v_mfma_f32_16x16x32_bf16 v[140:143], a[96:99], a[76:79], 0
    s_mov_b32 s55, 2621440
    buffer_load_dwordx4 v[84:87], v119, s[24:27], s55 offen
    buffer_load_dwordx4 v[88:91], v118, s[20:23], 0 offen offset:640
    v_mfma_f32_16x16x32_bf16 v[144:147], a[100:103], a[64:67], 0
    ds_read_b128 a[88:91], v113 offset:4096
    ds_read_b128 a[92:95], v113 offset:6144
    v_mfma_f32_16x16x32_bf16 v[148:151], a[100:103], a[68:71], 0
    v_mfma_f32_16x16x32_bf16 v[152:155], a[100:103], a[72:75], 0
    ds_read_b64_tr_b16 a[132:133], v114 offset:8200
    ds_read_b64_tr_b16 a[134:135], v114 offset:9224
    v_mfma_f32_16x16x32_bf16 v[156:159], a[100:103], a[76:79], 0
    s_mov_b32 s55, 3145728
    buffer_load_dwordx4 v[96:99], v119, s[24:27], s55 offen
    buffer_load_dwordx4 v[100:103], v118, s[20:23], 0 offen offset:768
    v_mfma_f32_16x16x32_bf16 v[160:163], a[104:107], a[64:67], 0
    ds_read_b64_tr_b16 a[136:137], v115 offset:8192
    ds_read_b64_tr_b16 a[138:139], v115 offset:9216
    v_mfma_f32_16x16x32_bf16 v[164:167], a[104:107], a[68:71], 0
    v_mfma_f32_16x16x32_bf16 v[168:171], a[104:107], a[72:75], 0
    ds_read_b64_tr_b16 a[140:141], v115 offset:8200
    ds_read_b64_tr_b16 a[142:143], v115 offset:9224
    v_mfma_f32_16x16x32_bf16 v[172:175], a[104:107], a[76:79], 0
    s_mov_b32 s55, 3670016
    buffer_load_dwordx4 v[104:107], v119, s[24:27], s55 offen
    buffer_load_dwordx4 v[108:111], v118, s[20:23], 0 offen offset:896
    v_mfma_f32_16x16x32_bf16 v[176:179], a[108:111], a[64:67], 0
    ds_read_b64_tr_b16 a[144:145], v116 offset:8192
    ds_read_b64_tr_b16 a[146:147], v116 offset:9216
    v_mfma_f32_16x16x32_bf16 v[180:183], a[108:111], a[68:71], 0
    v_mfma_f32_16x16x32_bf16 v[184:187], a[108:111], a[72:75], 0
    ds_read_b64_tr_b16 a[148:149], v116 offset:8200
    ds_read_b64_tr_b16 a[150:151], v116 offset:9224
    v_mfma_f32_16x16x32_bf16 v[188:191], a[108:111], a[76:79], 0
    s_mov_b32 s55, 4194304
    buffer_load_dwordx4 v[120:123], v119, s[24:27], s55 offen
    buffer_load_dwordx4 v[124:127], v118, s[20:23], 0 offen offset:1024
    v_mfma_f32_16x16x32_bf16 v[192:195], a[112:115], a[64:67], 0
    ds_read_b64_tr_b16 a[152:153], v117 offset:8192
    ds_read_b64_tr_b16 a[154:155], v117 offset:9216
    v_mfma_f32_16x16x32_bf16 v[196:199], a[112:115], a[68:71], 0
    s_add_u32 m0, s48, 147456
    s_mov_b32 s61, 1048576
    buffer_load_dwordx4 v40, s[24:27], s61 offen offset:0 lds
    v_mfma_f32_16x16x32_bf16 v[200:203], a[112:115], a[72:75], 0
    ds_read_b64_tr_b16 a[156:157], v117 offset:8200
    ds_read_b64_tr_b16 a[158:159], v117 offset:9224
    v_mfma_f32_16x16x32_bf16 v[204:207], a[112:115], a[76:79], 0
    v_mfma_f32_16x16x32_bf16 v[208:211], a[116:119], a[64:67], 0
    v_mfma_f32_16x16x32_bf16 v[212:215], a[116:119], a[68:71], 0
    buffer_load_dwordx4 v41, s[24:27], s61 offen offset:1024 lds
    v_mfma_f32_16x16x32_bf16 v[216:219], a[116:119], a[72:75], 0
    v_mfma_f32_16x16x32_bf16 v[220:223], a[116:119], a[76:79], 0
    v_mfma_f32_16x16x32_bf16 v[224:227], a[120:123], a[64:67], 0
    v_mfma_f32_16x16x32_bf16 v[228:231], a[120:123], a[68:71], 0
    buffer_load_dwordx4 v42, s[24:27], s61 offen offset:2048 lds
    v_mfma_f32_16x16x32_bf16 v[232:235], a[120:123], a[72:75], 0
    v_mfma_f32_16x16x32_bf16 v[236:239], a[120:123], a[76:79], 0
    v_mfma_f32_16x16x32_bf16 v[240:243], a[124:127], a[64:67], 0
    v_mfma_f32_16x16x32_bf16 v[244:247], a[124:127], a[68:71], 0
    buffer_load_dwordx4 v43, s[24:27], s61 offen offset:3072 lds
    v_mfma_f32_16x16x32_bf16 v[248:251], a[124:127], a[72:75], 0
    v_mfma_f32_16x16x32_bf16 v[252:255], a[124:127], a[76:79], 0
    s_waitcnt vmcnt(15) lgkmcnt(0)
    s_barrier
    v_mfma_f32_16x16x32_bf16 v[128:131], a[128:131], a[80:83], v[128:131]
    ds_read_b128 a[64:67], v112 offset:49152
    ds_read_b64_tr_b16 a[96:97], v114 offset:16384
    v_mfma_f32_16x16x32_bf16 v[132:135], a[128:131], a[84:87], v[132:135]
    s_add_u32 m0, s62, 32768
    s_mov_b32 s60, 256
    buffer_load_dwordx4 v32, s[20:23], s60 offen offset:0 lds
    v_mfma_f32_16x16x32_bf16 v[136:139], a[128:131], a[88:91], v[136:139]
    ds_read_b64_tr_b16 a[98:99], v114 offset:17408
    ds_read_b128 a[68:71], v112 offset:51200
    v_mfma_f32_16x16x32_bf16 v[140:143], a[128:131], a[92:95], v[140:143]
    v_mfma_f32_16x16x32_bf16 v[144:147], a[132:135], a[80:83], v[144:147]
    ds_read_b128 a[72:75], v112 offset:53248
    ds_read_b128 a[76:79], v112 offset:55296
    v_mfma_f32_16x16x32_bf16 v[148:151], a[132:135], a[84:87], v[148:151]
    buffer_load_dwordx4 v33, s[20:23], s60 offen offset:1024 lds
    v_mfma_f32_16x16x32_bf16 v[152:155], a[132:135], a[88:91], v[152:155]
    ds_read_b64_tr_b16 a[100:101], v114 offset:16392
    ds_read_b64_tr_b16 a[102:103], v114 offset:17416
    v_mfma_f32_16x16x32_bf16 v[156:159], a[132:135], a[92:95], v[156:159]
    v_mfma_f32_16x16x32_bf16 v[160:163], a[136:139], a[80:83], v[160:163]
    ds_read_b64_tr_b16 a[104:105], v115 offset:16384
    ds_read_b64_tr_b16 a[106:107], v115 offset:17408
    v_mfma_f32_16x16x32_bf16 v[164:167], a[136:139], a[84:87], v[164:167]
    buffer_load_dwordx4 v34, s[20:23], s60 offen offset:2048 lds
    v_mfma_f32_16x16x32_bf16 v[168:171], a[136:139], a[88:91], v[168:171]
    ds_read_b64_tr_b16 a[108:109], v115 offset:16392
    ds_read_b64_tr_b16 a[110:111], v115 offset:17416
    v_mfma_f32_16x16x32_bf16 v[172:175], a[136:139], a[92:95], v[172:175]
    v_mfma_f32_16x16x32_bf16 v[176:179], a[140:143], a[80:83], v[176:179]
    ds_read_b64_tr_b16 a[112:113], v116 offset:16384
    ds_read_b64_tr_b16 a[114:115], v116 offset:17408
    v_mfma_f32_16x16x32_bf16 v[180:183], a[140:143], a[84:87], v[180:183]
    buffer_load_dwordx4 v35, s[20:23], s60 offen offset:3072 lds
    v_mfma_f32_16x16x32_bf16 v[184:187], a[140:143], a[88:91], v[184:187]
    ds_read_b64_tr_b16 a[116:117], v116 offset:16392
    ds_read_b64_tr_b16 a[118:119], v116 offset:17416
    v_mfma_f32_16x16x32_bf16 v[188:191], a[140:143], a[92:95], v[188:191]
    v_mfma_f32_16x16x32_bf16 v[192:195], a[144:147], a[80:83], v[192:195]
    ds_read_b64_tr_b16 a[120:121], v117 offset:16384
    ds_read_b64_tr_b16 a[122:123], v117 offset:17408
    v_mfma_f32_16x16x32_bf16 v[196:199], a[144:147], a[84:87], v[196:199]
    s_add_u32 m0, s62, 36864
    s_nop 0
    buffer_load_dwordx4 v36, s[20:23], s60 offen offset:0 lds
    v_mfma_f32_16x16x32_bf16 v[200:203], a[144:147], a[88:91], v[200:203]
    ds_read_b64_tr_b16 a[124:125], v117 offset:16392
    ds_read_b64_tr_b16 a[126:127], v117 offset:17416
    v_mfma_f32_16x16x32_bf16 v[204:207], a[144:147], a[92:95], v[204:207]
    v_mfma_f32_16x16x32_bf16 v[208:211], a[148:151], a[80:83], v[208:211]
    v_mfma_f32_16x16x32_bf16 v[212:215], a[148:151], a[84:87], v[212:215]
    buffer_load_dwordx4 v37, s[20:23], s60 offen offset:1024 lds
    v_mfma_f32_16x16x32_bf16 v[216:219], a[148:151], a[88:91], v[216:219]
    v_mfma_f32_16x16x32_bf16 v[220:223], a[148:151], a[92:95], v[220:223]
    v_mfma_f32_16x16x32_bf16 v[224:227], a[152:155], a[80:83], v[224:227]
    v_mfma_f32_16x16x32_bf16 v[228:231], a[152:155], a[84:87], v[228:231]
    buffer_load_dwordx4 v38, s[20:23], s60 offen offset:2048 lds
    v_mfma_f32_16x16x32_bf16 v[232:235], a[152:155], a[88:91], v[232:235]
    v_mfma_f32_16x16x32_bf16 v[236:239], a[152:155], a[92:95], v[236:239]
    v_mfma_f32_16x16x32_bf16 v[240:243], a[156:159], a[80:83], v[240:243]
    v_mfma_f32_16x16x32_bf16 v[244:247], a[156:159], a[84:87], v[244:247]
    buffer_load_dwordx4 v39, s[20:23], s60 offen offset:3072 lds
    v_mfma_f32_16x16x32_bf16 v[248:251], a[156:159], a[88:91], v[248:251]
    v_mfma_f32_16x16x32_bf16 v[252:255], a[156:159], a[92:95], v[252:255]
    s_waitcnt lgkmcnt(0)
    v_mfma_f32_16x16x32_bf16 v[128:131], a[96:99], a[64:67], v[128:131]
    ds_read_b128 a[80:83], v113 offset:49152
    ds_read_b64_tr_b16 a[128:129], v114 offset:24576
    v_mfma_f32_16x16x32_bf16 v[132:135], a[96:99], a[68:71], v[132:135]
    s_add_u32 m0, s48, 114688
    s_mov_b32 s61, 1572864
    buffer_load_dwordx4 v40, s[24:27], s61 offen offset:0 lds
    v_mfma_f32_16x16x32_bf16 v[136:139], a[96:99], a[72:75], v[136:139]
    ds_read_b64_tr_b16 a[130:131], v114 offset:25600
    ds_read_b128 a[84:87], v113 offset:51200
    v_mfma_f32_16x16x32_bf16 v[140:143], a[96:99], a[76:79], v[140:143]
    v_add_u32 v2, 0, v1
    v_mul_u32_u24 v3, 3641, v2
    v_mfma_f32_16x16x32_bf16 v[144:147], a[100:103], a[64:67], v[144:147]
    ds_read_b128 a[88:91], v113 offset:53248
    ds_read_b128 a[92:95], v113 offset:55296
    v_mfma_f32_16x16x32_bf16 v[148:151], a[100:103], a[68:71], v[148:151]
    v_lshrrev_b32 v3, 16, v3
    v_mul_u32_u24 v4, 18, v3
    v_mfma_f32_16x16x32_bf16 v[152:155], a[100:103], a[72:75], v[152:155]
    ds_read_b64_tr_b16 a[132:133], v114 offset:24584
    ds_read_b64_tr_b16 a[134:135], v114 offset:25608
    v_mfma_f32_16x16x32_bf16 v[156:159], a[100:103], a[76:79], v[156:159]
    v_sub_u32 v4, v2, v4
    v_mul_u32_u24 v3, 1152, v3
    v_mfma_f32_16x16x32_bf16 v[160:163], a[104:107], a[64:67], v[160:163]
    ds_read_b64_tr_b16 a[136:137], v115 offset:24576
    ds_read_b64_tr_b16 a[138:139], v115 offset:25600
    v_mfma_f32_16x16x32_bf16 v[164:167], a[104:107], a[68:71], v[164:167]
    buffer_load_dwordx4 v41, s[24:27], s61 offen offset:1024 lds
    v_mfma_f32_16x16x32_bf16 v[168:171], a[104:107], a[72:75], v[168:171]
    ds_read_b64_tr_b16 a[140:141], v115 offset:24584
    ds_read_b64_tr_b16 a[142:143], v115 offset:25608
    v_mfma_f32_16x16x32_bf16 v[172:175], a[104:107], a[76:79], v[172:175]
    v_lshl_add_u32 v3, v4, 4, v3
    v_accvgpr_write_b32 a240, v3
    v_mfma_f32_16x16x32_bf16 v[176:179], a[108:111], a[64:67], v[176:179]
    ds_read_b64_tr_b16 a[144:145], v116 offset:24576
    ds_read_b64_tr_b16 a[146:147], v116 offset:25600
    v_mfma_f32_16x16x32_bf16 v[180:183], a[108:111], a[68:71], v[180:183]
    v_add_u32 v2, 64, v1
    v_mul_u32_u24 v3, 3641, v2
    v_mfma_f32_16x16x32_bf16 v[184:187], a[108:111], a[72:75], v[184:187]
    ds_read_b64_tr_b16 a[148:149], v116 offset:24584
    ds_read_b64_tr_b16 a[150:151], v116 offset:25608
    v_mfma_f32_16x16x32_bf16 v[188:191], a[108:111], a[76:79], v[188:191]
    v_lshrrev_b32 v3, 16, v3
    v_mul_u32_u24 v4, 18, v3
    v_mfma_f32_16x16x32_bf16 v[192:195], a[112:115], a[64:67], v[192:195]
    ds_read_b64_tr_b16 a[152:153], v117 offset:24576
    ds_read_b64_tr_b16 a[154:155], v117 offset:25600
    v_mfma_f32_16x16x32_bf16 v[196:199], a[112:115], a[68:71], v[196:199]
    buffer_load_dwordx4 v42, s[24:27], s61 offen offset:2048 lds
    v_mfma_f32_16x16x32_bf16 v[200:203], a[112:115], a[72:75], v[200:203]
    ds_read_b64_tr_b16 a[156:157], v117 offset:24584
    ds_read_b64_tr_b16 a[158:159], v117 offset:25608
    v_mfma_f32_16x16x32_bf16 v[204:207], a[112:115], a[76:79], v[204:207]
    v_sub_u32 v4, v2, v4
    v_mul_u32_u24 v3, 1152, v3
    v_mfma_f32_16x16x32_bf16 v[208:211], a[116:119], a[64:67], v[208:211]
    v_lshl_add_u32 v3, v4, 4, v3
    v_subrev_u32 v3, 1024, v3
    v_mfma_f32_16x16x32_bf16 v[212:215], a[116:119], a[68:71], v[212:215]
    v_accvgpr_write_b32 a241, v3
    v_add_u32 v2, 128, v1
    v_mfma_f32_16x16x32_bf16 v[216:219], a[116:119], a[72:75], v[216:219]
    v_mul_u32_u24 v3, 3641, v2
    v_lshrrev_b32 v3, 16, v3
    v_mfma_f32_16x16x32_bf16 v[220:223], a[116:119], a[76:79], v[220:223]
    v_mul_u32_u24 v4, 18, v3
    v_sub_u32 v4, v2, v4
    v_mfma_f32_16x16x32_bf16 v[224:227], a[120:123], a[64:67], v[224:227]
    v_mul_u32_u24 v3, 1152, v3
    v_lshl_add_u32 v3, v4, 4, v3
    v_mfma_f32_16x16x32_bf16 v[228:231], a[120:123], a[68:71], v[228:231]
    buffer_load_dwordx4 v43, s[24:27], s61 offen offset:3072 lds
    v_mfma_f32_16x16x32_bf16 v[232:235], a[120:123], a[72:75], v[232:235]
    v_subrev_u32 v3, 2048, v3
    v_accvgpr_write_b32 a242, v3
    v_mfma_f32_16x16x32_bf16 v[236:239], a[120:123], a[76:79], v[236:239]
    v_add_u32 v2, 192, v1
    v_mul_u32_u24 v3, 3641, v2
    v_mfma_f32_16x16x32_bf16 v[240:243], a[124:127], a[64:67], v[240:243]
    v_lshrrev_b32 v3, 16, v3
    v_mul_u32_u24 v4, 18, v3
    v_mfma_f32_16x16x32_bf16 v[244:247], a[124:127], a[68:71], v[244:247]
    v_sub_u32 v4, v2, v4
    v_mul_u32_u24 v3, 1152, v3
    v_mfma_f32_16x16x32_bf16 v[248:251], a[124:127], a[72:75], v[248:251]
    v_lshl_add_u32 v3, v4, 4, v3
    v_subrev_u32 v3, 3072, v3
    v_mfma_f32_16x16x32_bf16 v[252:255], a[124:127], a[76:79], v[252:255]
    v_accvgpr_write_b32 a243, v3
    v_add_u32 v2, 256, v1
    s_waitcnt vmcnt(4) lgkmcnt(0)
    s_barrier
    v_mfma_f32_16x16x32_bf16 v[128:131], a[128:131], a[80:83], v[128:131]
    ds_read_b128 a[64:67], v112 offset:0
    ds_read_b64_tr_b16 a[96:97], v114 offset:32768
    v_mfma_f32_16x16x32_bf16 v[132:135], a[128:131], a[84:87], v[132:135]
    s_add_u32 m0, s62, 81920
    s_mov_b32 s60, 384
    buffer_load_dwordx4 v32, s[20:23], s60 offen offset:0 lds
    v_mfma_f32_16x16x32_bf16 v[136:139], a[128:131], a[88:91], v[136:139]
    ds_read_b64_tr_b16 a[98:99], v114 offset:33792
    ds_read_b128 a[68:71], v112 offset:2048
    v_mfma_f32_16x16x32_bf16 v[140:143], a[128:131], a[92:95], v[140:143]
    v_mul_u32_u24 v3, 3641, v2
    v_lshrrev_b32 v3, 16, v3
    v_mfma_f32_16x16x32_bf16 v[144:147], a[132:135], a[80:83], v[144:147]
    ds_read_b128 a[72:75], v112 offset:4096
    ds_read_b128 a[76:79], v112 offset:6144
    v_mfma_f32_16x16x32_bf16 v[148:151], a[132:135], a[84:87], v[148:151]
    buffer_load_dwordx4 v33, s[20:23], s60 offen offset:1024 lds
    v_mfma_f32_16x16x32_bf16 v[152:155], a[132:135], a[88:91], v[152:155]
    ds_read_b64_tr_b16 a[100:101], v114 offset:32776
    ds_read_b64_tr_b16 a[102:103], v114 offset:33800
    v_mfma_f32_16x16x32_bf16 v[156:159], a[132:135], a[92:95], v[156:159]
    v_mul_u32_u24 v4, 18, v3
    v_sub_u32 v4, v2, v4
    v_mfma_f32_16x16x32_bf16 v[160:163], a[136:139], a[80:83], v[160:163]
    ds_read_b64_tr_b16 a[104:105], v115 offset:32768
    ds_read_b64_tr_b16 a[106:107], v115 offset:33792
    v_mfma_f32_16x16x32_bf16 v[164:167], a[136:139], a[84:87], v[164:167]
    buffer_load_dwordx4 v34, s[20:23], s60 offen offset:2048 lds
    v_mfma_f32_16x16x32_bf16 v[168:171], a[136:139], a[88:91], v[168:171]
    ds_read_b64_tr_b16 a[108:109], v115 offset:32776
    ds_read_b64_tr_b16 a[110:111], v115 offset:33800
    v_mfma_f32_16x16x32_bf16 v[172:175], a[136:139], a[92:95], v[172:175]
    v_mul_u32_u24 v3, 1152, v3
    v_lshl_add_u32 v3, v4, 4, v3
    v_mfma_f32_16x16x32_bf16 v[176:179], a[140:143], a[80:83], v[176:179]
    ds_read_b64_tr_b16 a[112:113], v116 offset:32768
    ds_read_b64_tr_b16 a[114:115], v116 offset:33792
    v_mfma_f32_16x16x32_bf16 v[180:183], a[140:143], a[84:87], v[180:183]
    buffer_load_dwordx4 v35, s[20:23], s60 offen offset:3072 lds
    v_mfma_f32_16x16x32_bf16 v[184:187], a[140:143], a[88:91], v[184:187]
    ds_read_b64_tr_b16 a[116:117], v116 offset:32776
    ds_read_b64_tr_b16 a[118:119], v116 offset:33800
    v_mfma_f32_16x16x32_bf16 v[188:191], a[140:143], a[92:95], v[188:191]
    v_accvgpr_write_b32 a244, v3
    v_add_u32 v2, 320, v1
    v_mfma_f32_16x16x32_bf16 v[192:195], a[144:147], a[80:83], v[192:195]
    ds_read_b64_tr_b16 a[120:121], v117 offset:32768
    ds_read_b64_tr_b16 a[122:123], v117 offset:33792
    v_mfma_f32_16x16x32_bf16 v[196:199], a[144:147], a[84:87], v[196:199]
    s_add_u32 m0, s62, 86016
    s_nop 0
    buffer_load_dwordx4 v36, s[20:23], s60 offen offset:0 lds
    v_mfma_f32_16x16x32_bf16 v[200:203], a[144:147], a[88:91], v[200:203]
    ds_read_b64_tr_b16 a[124:125], v117 offset:32776
    ds_read_b64_tr_b16 a[126:127], v117 offset:33800
    v_mfma_f32_16x16x32_bf16 v[204:207], a[144:147], a[92:95], v[204:207]
    v_mul_u32_u24 v3, 3641, v2
    v_lshrrev_b32 v3, 16, v3
    v_mfma_f32_16x16x32_bf16 v[208:211], a[148:151], a[80:83], v[208:211]
    v_mul_u32_u24 v4, 18, v3
    v_sub_u32 v4, v2, v4
    v_mfma_f32_16x16x32_bf16 v[212:215], a[148:151], a[84:87], v[212:215]
    buffer_load_dwordx4 v37, s[20:23], s60 offen offset:1024 lds
    v_mfma_f32_16x16x32_bf16 v[216:219], a[148:151], a[88:91], v[216:219]
    v_mul_u32_u24 v3, 1152, v3
    v_lshl_add_u32 v3, v4, 4, v3
    v_mfma_f32_16x16x32_bf16 v[220:223], a[148:151], a[92:95], v[220:223]
    v_subrev_u32 v3, 1024, v3
    v_accvgpr_write_b32 a245, v3
    v_mfma_f32_16x16x32_bf16 v[224:227], a[152:155], a[80:83], v[224:227]
    v_add_u32 v2, 384, v1
    v_mul_u32_u24 v3, 3641, v2
    v_mfma_f32_16x16x32_bf16 v[228:231], a[152:155], a[84:87], v[228:231]
    buffer_load_dwordx4 v38, s[20:23], s60 offen offset:2048 lds
    v_mfma_f32_16x16x32_bf16 v[232:235], a[152:155], a[88:91], v[232:235]
    v_lshrrev_b32 v3, 16, v3
    v_mul_u32_u24 v4, 18, v3
    v_mfma_f32_16x16x32_bf16 v[236:239], a[152:155], a[92:95], v[236:239]
    v_sub_u32 v4, v2, v4
    v_mul_u32_u24 v3, 1152, v3
    v_mfma_f32_16x16x32_bf16 v[240:243], a[156:159], a[80:83], v[240:243]
    v_lshl_add_u32 v3, v4, 4, v3
    v_subrev_u32 v3, 2048, v3
    v_mfma_f32_16x16x32_bf16 v[244:247], a[156:159], a[84:87], v[244:247]
    buffer_load_dwordx4 v39, s[20:23], s60 offen offset:3072 lds
    v_mfma_f32_16x16x32_bf16 v[248:251], a[156:159], a[88:91], v[248:251]
    v_accvgpr_write_b32 a246, v3
    v_add_u32 v2, 448, v1
    v_mfma_f32_16x16x32_bf16 v[252:255], a[156:159], a[92:95], v[252:255]
    v_mul_u32_u24 v3, 3641, v2
    v_lshrrev_b32 v3, 16, v3
    s_waitcnt lgkmcnt(0)
    v_mfma_f32_16x16x32_bf16 v[128:131], a[96:99], a[64:67], v[128:131]
    ds_read_b128 a[80:83], v113 offset:0
    ds_read_b64_tr_b16 a[128:129], v114 offset:40960
    v_mfma_f32_16x16x32_bf16 v[132:135], a[96:99], a[68:71], v[132:135]
    s_add_u32 m0, s48, 131072
    s_mov_b32 s61, 2097152
    buffer_load_dwordx4 v40, s[24:27], s61 offen offset:0 lds
    v_mfma_f32_16x16x32_bf16 v[136:139], a[96:99], a[72:75], v[136:139]
    ds_read_b64_tr_b16 a[130:131], v114 offset:41984
    ds_read_b128 a[84:87], v113 offset:2048
    v_mfma_f32_16x16x32_bf16 v[140:143], a[96:99], a[76:79], v[140:143]
    v_mul_u32_u24 v4, 18, v3
    v_sub_u32 v4, v2, v4
    v_mfma_f32_16x16x32_bf16 v[144:147], a[100:103], a[64:67], v[144:147]
    ds_read_b128 a[88:91], v113 offset:4096
    ds_read_b128 a[92:95], v113 offset:6144
    v_mfma_f32_16x16x32_bf16 v[148:151], a[100:103], a[68:71], v[148:151]
    v_mul_u32_u24 v3, 1152, v3
    v_lshl_add_u32 v3, v4, 4, v3
    v_mfma_f32_16x16x32_bf16 v[152:155], a[100:103], a[72:75], v[152:155]
    ds_read_b64_tr_b16 a[132:133], v114 offset:40968
    ds_read_b64_tr_b16 a[134:135], v114 offset:41992
    v_mfma_f32_16x16x32_bf16 v[156:159], a[100:103], a[76:79], v[156:159]
    v_subrev_u32 v3, 3072, v3
    v_accvgpr_write_b32 a247, v3
    v_mfma_f32_16x16x32_bf16 v[160:163], a[104:107], a[64:67], v[160:163]
    ds_read_b64_tr_b16 a[136:137], v115 offset:40960
    ds_read_b64_tr_b16 a[138:139], v115 offset:41984
    v_mfma_f32_16x16x32_bf16 v[164:167], a[104:107], a[68:71], v[164:167]
    buffer_load_dwordx4 v41, s[24:27], s61 offen offset:1024 lds
    v_mfma_f32_16x16x32_bf16 v[168:171], a[104:107], a[72:75], v[168:171]
    ds_read_b64_tr_b16 a[140:141], v115 offset:40968
    ds_read_b64_tr_b16 a[142:143], v115 offset:41992
    v_mfma_f32_16x16x32_bf16 v[172:175], a[104:107], a[76:79], v[172:175]
    v_add_u32 v2, 512, v1
    v_mul_u32_u24 v3, 3641, v2
    v_mfma_f32_16x16x32_bf16 v[176:179], a[108:111], a[64:67], v[176:179]
    ds_read_b64_tr_b16 a[144:145], v116 offset:40960
    ds_read_b64_tr_b16 a[146:147], v116 offset:41984
    v_mfma_f32_16x16x32_bf16 v[180:183], a[108:111], a[68:71], v[180:183]
    v_lshrrev_b32 v3, 16, v3
    v_mul_u32_u24 v4, 18, v3
    v_mfma_f32_16x16x32_bf16 v[184:187], a[108:111], a[72:75], v[184:187]
    ds_read_b64_tr_b16 a[148:149], v116 offset:40968
    ds_read_b64_tr_b16 a[150:151], v116 offset:41992
    v_mfma_f32_16x16x32_bf16 v[188:191], a[108:111], a[76:79], v[188:191]
    v_sub_u32 v4, v2, v4
    v_mul_u32_u24 v3, 1152, v3
    v_mfma_f32_16x16x32_bf16 v[192:195], a[112:115], a[64:67], v[192:195]
    ds_read_b64_tr_b16 a[152:153], v117 offset:40960
    ds_read_b64_tr_b16 a[154:155], v117 offset:41984
    v_mfma_f32_16x16x32_bf16 v[196:199], a[112:115], a[68:71], v[196:199]
    buffer_load_dwordx4 v42, s[24:27], s61 offen offset:2048 lds
    v_mfma_f32_16x16x32_bf16 v[200:203], a[112:115], a[72:75], v[200:203]
    ds_read_b64_tr_b16 a[156:157], v117 offset:40968
    ds_read_b64_tr_b16 a[158:159], v117 offset:41992
    v_mfma_f32_16x16x32_bf16 v[204:207], a[112:115], a[76:79], v[204:207]
    v_lshl_add_u32 v3, v4, 4, v3
    v_accvgpr_write_b32 a248, v3
    v_mfma_f32_16x16x32_bf16 v[208:211], a[116:119], a[64:67], v[208:211]
    s_mov_b32 s4, 137216
    s_cmp_eq_u32 s3, 1
    s_cselect_b32 s4, 146432, s4
    v_mfma_f32_16x16x32_bf16 v[212:215], a[116:119], a[68:71], v[212:215]
    s_cmp_eq_u32 s3, 2
    s_cselect_b32 s4, 0, s4
    v_mfma_f32_16x16x32_bf16 v[216:219], a[116:119], a[72:75], v[216:219]
    s_cmp_eq_u32 s3, 3
    s_cselect_b32 s4, 0, s4
    v_mfma_f32_16x16x32_bf16 v[220:223], a[116:119], a[76:79], v[220:223]
    s_add_u32 s55, s3, 0
    s_lshr_b32 s54, s55, 2
    v_mfma_f32_16x16x32_bf16 v[224:227], a[120:123], a[64:67], v[224:227]
    s_add_u32 s54, s54, s69
    s_and_b32 s54, s54, 3
    v_mfma_f32_16x16x32_bf16 v[228:231], a[120:123], a[68:71], v[228:231]
    buffer_load_dwordx4 v43, s[24:27], s61 offen offset:3072 lds
    v_mfma_f32_16x16x32_bf16 v[232:235], a[120:123], a[72:75], v[232:235]
    s_lshl_b32 s54, s54, 2
    s_and_b32 s55, s55, 3
    v_mfma_f32_16x16x32_bf16 v[236:239], a[120:123], a[76:79], v[236:239]
    s_add_u32 s54, s54, s55
    s_mul_i32 s9, s54, 36864
    v_mfma_f32_16x16x32_bf16 v[240:243], a[124:127], a[64:67], v[240:243]
    s_mov_b32 s5, 9216
    s_cmp_eq_u32 s3, 1
    s_cselect_b32 s5, 18432, s5
    v_mfma_f32_16x16x32_bf16 v[244:247], a[124:127], a[68:71], v[244:247]
    s_cmp_eq_u32 s3, 2
    s_cselect_b32 s5, 81920, s5
    v_mfma_f32_16x16x32_bf16 v[248:251], a[124:127], a[72:75], v[248:251]
    s_cmp_eq_u32 s3, 3
    s_cselect_b32 s5, 81920, s5
    v_mfma_f32_16x16x32_bf16 v[252:255], a[124:127], a[76:79], v[252:255]
    s_add_u32 s55, s3, 3
    s_lshr_b32 s54, s55, 2
    s_waitcnt vmcnt(4) lgkmcnt(0)
    s_barrier
    v_mfma_f32_16x16x32_bf16 v[128:131], a[128:131], a[80:83], v[128:131]
    ds_read_b128 a[64:67], v112 offset:49152
    ds_read_b64_tr_b16 a[96:97], v114 offset:0
    v_mfma_f32_16x16x32_bf16 v[132:135], a[128:131], a[84:87], v[132:135]
    s_add_u32 m0, s62, 32768
    s_mov_b32 s60, 512
    buffer_load_dwordx4 v32, s[20:23], s60 offen offset:0 lds
    v_mfma_f32_16x16x32_bf16 v[136:139], a[128:131], a[88:91], v[136:139]
    ds_read_b64_tr_b16 a[98:99], v114 offset:1024
    ds_read_b128 a[68:71], v112 offset:51200
    v_mfma_f32_16x16x32_bf16 v[140:143], a[128:131], a[92:95], v[140:143]
    s_add_u32 s54, s54, s69
    s_and_b32 s54, s54, 3
    v_mfma_f32_16x16x32_bf16 v[144:147], a[132:135], a[80:83], v[144:147]
    ds_read_b128 a[72:75], v112 offset:53248
    ds_read_b128 a[76:79], v112 offset:55296
    v_mfma_f32_16x16x32_bf16 v[148:151], a[132:135], a[84:87], v[148:151]
    buffer_load_dwordx4 v33, s[20:23], s60 offen offset:1024 lds
    v_mfma_f32_16x16x32_bf16 v[152:155], a[132:135], a[88:91], v[152:155]
    ds_read_b64_tr_b16 a[100:101], v114 offset:8
    ds_read_b64_tr_b16 a[102:103], v114 offset:1032
    v_mfma_f32_16x16x32_bf16 v[156:159], a[132:135], a[92:95], v[156:159]
    s_lshl_b32 s54, s54, 2
    s_and_b32 s55, s55, 3
    v_mfma_f32_16x16x32_bf16 v[160:163], a[136:139], a[80:83], v[160:163]
    ds_read_b64_tr_b16 a[104:105], v115 offset:0
    ds_read_b64_tr_b16 a[106:107], v115 offset:1024
    v_mfma_f32_16x16x32_bf16 v[164:167], a[136:139], a[84:87], v[164:167]
    buffer_load_dwordx4 v34, s[20:23], s60 offen offset:2048 lds
    v_mfma_f32_16x16x32_bf16 v[168:171], a[136:139], a[88:91], v[168:171]
    ds_read_b64_tr_b16 a[108:109], v115 offset:8
    ds_read_b64_tr_b16 a[110:111], v115 offset:1032
    v_mfma_f32_16x16x32_bf16 v[172:175], a[136:139], a[92:95], v[172:175]
    s_add_u32 s54, s54, s55
    s_mul_i32 s10, s54, 36864
    v_mfma_f32_16x16x32_bf16 v[176:179], a[140:143], a[80:83], v[176:179]
    ds_read_b64_tr_b16 a[112:113], v116 offset:0
    ds_read_b64_tr_b16 a[114:115], v116 offset:1024
    v_mfma_f32_16x16x32_bf16 v[180:183], a[140:143], a[84:87], v[180:183]
    buffer_load_dwordx4 v35, s[20:23], s60 offen offset:3072 lds
    v_mfma_f32_16x16x32_bf16 v[184:187], a[140:143], a[88:91], v[184:187]
    ds_read_b64_tr_b16 a[116:117], v116 offset:8
    ds_read_b64_tr_b16 a[118:119], v116 offset:1032
    v_mfma_f32_16x16x32_bf16 v[188:191], a[140:143], a[92:95], v[188:191]
    s_mov_b32 s6, 27648
    s_cmp_eq_u32 s3, 1
    s_cselect_b32 s6, 36864, s6
    v_mfma_f32_16x16x32_bf16 v[192:195], a[144:147], a[80:83], v[192:195]
    ds_read_b64_tr_b16 a[120:121], v117 offset:0
    ds_read_b64_tr_b16 a[122:123], v117 offset:1024
    v_mfma_f32_16x16x32_bf16 v[196:199], a[144:147], a[84:87], v[196:199]
    s_add_u32 m0, s62, 36864
    s_nop 0
    buffer_load_dwordx4 v36, s[20:23], s60 offen offset:0 lds
    v_mfma_f32_16x16x32_bf16 v[200:203], a[144:147], a[88:91], v[200:203]
    ds_read_b64_tr_b16 a[124:125], v117 offset:8
    ds_read_b64_tr_b16 a[126:127], v117 offset:1032
    v_mfma_f32_16x16x32_bf16 v[204:207], a[144:147], a[92:95], v[204:207]
    s_cmp_eq_u32 s3, 2
    s_cselect_b32 s6, 91136, s6
    v_mfma_f32_16x16x32_bf16 v[208:211], a[148:151], a[80:83], v[208:211]
    s_cmp_eq_u32 s3, 3
    s_cselect_b32 s6, 100352, s6
    v_mfma_f32_16x16x32_bf16 v[212:215], a[148:151], a[84:87], v[212:215]
    buffer_load_dwordx4 v37, s[20:23], s60 offen offset:1024 lds
    v_mfma_f32_16x16x32_bf16 v[216:219], a[148:151], a[88:91], v[216:219]
    s_add_u32 s55, s3, 6
    s_lshr_b32 s54, s55, 2
    v_mfma_f32_16x16x32_bf16 v[220:223], a[148:151], a[92:95], v[220:223]
    s_add_u32 s54, s54, s69
    s_and_b32 s54, s54, 3
    v_mfma_f32_16x16x32_bf16 v[224:227], a[152:155], a[80:83], v[224:227]
    s_lshl_b32 s54, s54, 2
    s_and_b32 s55, s55, 3
    v_mfma_f32_16x16x32_bf16 v[228:231], a[152:155], a[84:87], v[228:231]
    buffer_load_dwordx4 v38, s[20:23], s60 offen offset:2048 lds
    v_mfma_f32_16x16x32_bf16 v[232:235], a[152:155], a[88:91], v[232:235]
    s_add_u32 s54, s54, s55
    s_mul_i32 s11, s54, 36864
    v_mfma_f32_16x16x32_bf16 v[236:239], a[152:155], a[92:95], v[236:239]
    s_mov_b32 s7, 46080
    s_cmp_eq_u32 s3, 1
    s_cselect_b32 s7, 55296, s7
    v_mfma_f32_16x16x32_bf16 v[240:243], a[156:159], a[80:83], v[240:243]
    s_cmp_eq_u32 s3, 2
    s_cselect_b32 s7, 109568, s7
    v_mfma_f32_16x16x32_bf16 v[244:247], a[156:159], a[84:87], v[244:247]
    buffer_load_dwordx4 v39, s[20:23], s60 offen offset:3072 lds
    v_mfma_f32_16x16x32_bf16 v[248:251], a[156:159], a[88:91], v[248:251]
    s_cmp_eq_u32 s3, 3
    s_cselect_b32 s7, 109568, s7
    v_mfma_f32_16x16x32_bf16 v[252:255], a[156:159], a[92:95], v[252:255]
    s_add_u32 s55, s3, 10
    s_lshr_b32 s54, s55, 2
    s_waitcnt lgkmcnt(0)
    v_mfma_f32_16x16x32_bf16 v[128:131], a[96:99], a[64:67], v[128:131]
    ds_read_b128 a[80:83], v113 offset:49152
    ds_read_b64_tr_b16 a[128:129], v114 offset:8192
    v_mfma_f32_16x16x32_bf16 v[132:135], a[96:99], a[68:71], v[132:135]
    s_add_u32 m0, s48, 147456
    s_mov_b32 s61, 2621440
    buffer_load_dwordx4 v40, s[24:27], s61 offen offset:0 lds
    v_mfma_f32_16x16x32_bf16 v[136:139], a[96:99], a[72:75], v[136:139]
    ds_read_b64_tr_b16 a[130:131], v114 offset:9216
    ds_read_b128 a[84:87], v113 offset:51200
    v_mfma_f32_16x16x32_bf16 v[140:143], a[96:99], a[76:79], v[140:143]
    s_add_u32 s54, s54, s69
    s_and_b32 s54, s54, 3
    v_mfma_f32_16x16x32_bf16 v[144:147], a[100:103], a[64:67], v[144:147]
    ds_read_b128 a[88:91], v113 offset:53248
    ds_read_b128 a[92:95], v113 offset:55296
    v_mfma_f32_16x16x32_bf16 v[148:151], a[100:103], a[68:71], v[148:151]
    s_lshl_b32 s54, s54, 2
    s_and_b32 s55, s55, 3
    v_mfma_f32_16x16x32_bf16 v[152:155], a[100:103], a[72:75], v[152:155]
    ds_read_b64_tr_b16 a[132:133], v114 offset:8200
    ds_read_b64_tr_b16 a[134:135], v114 offset:9224
    v_mfma_f32_16x16x32_bf16 v[156:159], a[100:103], a[76:79], v[156:159]
    s_add_u32 s54, s54, s55
    s_mul_i32 s12, s54, 36864
    v_mfma_f32_16x16x32_bf16 v[160:163], a[104:107], a[64:67], v[160:163]
    ds_read_b64_tr_b16 a[136:137], v115 offset:8192
    ds_read_b64_tr_b16 a[138:139], v115 offset:9216
    v_mfma_f32_16x16x32_bf16 v[164:167], a[104:107], a[68:71], v[164:167]
    buffer_load_dwordx4 v41, s[24:27], s61 offen offset:1024 lds
    v_mfma_f32_16x16x32_bf16 v[168:171], a[104:107], a[72:75], v[168:171]
    ds_read_b64_tr_b16 a[140:141], v115 offset:8200
    ds_read_b64_tr_b16 a[142:143], v115 offset:9224
    v_mfma_f32_16x16x32_bf16 v[172:175], a[104:107], a[76:79], v[172:175]
    s_mov_b32 s8, 118784
    s_cmp_eq_u32 s3, 1
    s_cselect_b32 s8, 128000, s8
    v_mfma_f32_16x16x32_bf16 v[176:179], a[108:111], a[64:67], v[176:179]
    ds_read_b64_tr_b16 a[144:145], v116 offset:8192
    ds_read_b64_tr_b16 a[146:147], v116 offset:9216
    v_mfma_f32_16x16x32_bf16 v[180:183], a[108:111], a[68:71], v[180:183]
    s_cmp_eq_u32 s3, 2
    s_cselect_b32 s8, 65536, s8
    v_mfma_f32_16x16x32_bf16 v[184:187], a[108:111], a[72:75], v[184:187]
    ds_read_b64_tr_b16 a[148:149], v116 offset:8200
    ds_read_b64_tr_b16 a[150:151], v116 offset:9224
    v_mfma_f32_16x16x32_bf16 v[188:191], a[108:111], a[76:79], v[188:191]
    s_cmp_eq_u32 s3, 3
    s_cselect_b32 s8, 65536, s8
    v_mfma_f32_16x16x32_bf16 v[192:195], a[112:115], a[64:67], v[192:195]
    ds_read_b64_tr_b16 a[152:153], v117 offset:8192
    ds_read_b64_tr_b16 a[154:155], v117 offset:9216
    v_mfma_f32_16x16x32_bf16 v[196:199], a[112:115], a[68:71], v[196:199]
    buffer_load_dwordx4 v42, s[24:27], s61 offen offset:2048 lds
    v_mfma_f32_16x16x32_bf16 v[200:203], a[112:115], a[72:75], v[200:203]
    ds_read_b64_tr_b16 a[156:157], v117 offset:8200
    ds_read_b64_tr_b16 a[158:159], v117 offset:9224
    v_mfma_f32_16x16x32_bf16 v[204:207], a[112:115], a[76:79], v[204:207]
    s_add_u32 s55, s3, 13
    s_lshr_b32 s54, s55, 2
    v_mfma_f32_16x16x32_bf16 v[208:211], a[116:119], a[64:67], v[208:211]
    s_add_u32 s54, s54, s69
    s_and_b32 s54, s54, 3
    v_mfma_f32_16x16x32_bf16 v[212:215], a[116:119], a[68:71], v[212:215]
    s_lshl_b32 s54, s54, 2
    s_and_b32 s55, s55, 3
    v_mfma_f32_16x16x32_bf16 v[216:219], a[116:119], a[72:75], v[216:219]
    s_add_u32 s54, s54, s55
    s_mul_i32 s13, s54, 36864
    v_mfma_f32_16x16x32_bf16 v[220:223], a[116:119], a[76:79], v[220:223]
    s_lshl_b32 s101, s64, 5
    s_add_u32 s101, s101, s65
    v_mfma_f32_16x16x32_bf16 v[224:227], a[120:123], a[64:67], v[224:227]
    s_lshl_b32 s99, s101, 2
    s_add_u32 s99, s99, s3
    v_mfma_f32_16x16x32_bf16 v[228:231], a[120:123], a[68:71], v[228:231]
    buffer_load_dwordx4 v43, s[24:27], s61 offen offset:3072 lds
    v_mfma_f32_16x16x32_bf16 v[232:235], a[120:123], a[72:75], v[232:235]
    s_lshl_b32 s99, s99, 14
    s_lshl_b32 s101, s101, 7
    v_mfma_f32_16x16x32_bf16 v[236:239], a[120:123], a[76:79], v[236:239]
    s_add_u32 s101, s101, 62914560
    s_add_u32 s91, s101, 65536
    v_mfma_f32_16x16x32_bf16 v[240:243], a[124:127], a[64:67], v[240:243]
    s_add_u32 s54, s69, 1
    s_and_b32 s54, s54, 3
    v_mfma_f32_16x16x32_bf16 v[244:247], a[124:127], a[68:71], v[244:247]
    s_lshl_b32 s55, s68, 2
    s_add_u32 s54, s54, s55
    v_mfma_f32_16x16x32_bf16 v[248:251], a[124:127], a[72:75], v[248:251]
    s_lshl_b32 s55, s64, 5
    s_add_u32 s54, s54, s55
    v_mfma_f32_16x16x32_bf16 v[252:255], a[124:127], a[76:79], v[252:255]
    s_lshl_b32 s54, s54, 2
    s_add_u32 s54, s54, s3
    s_waitcnt vmcnt(4) lgkmcnt(0)
    s_barrier
    v_mfma_f32_16x16x32_bf16 v[128:131], a[128:131], a[80:83], v[128:131]
    ds_read_b128 a[64:67], v112 offset:0
    ds_read_b64_tr_b16 a[96:97], v114 offset:16384
    v_mfma_f32_16x16x32_bf16 v[132:135], a[128:131], a[84:87], v[132:135]
    s_add_u32 m0, s62, 81920
    s_mov_b32 s60, 640
    buffer_load_dwordx4 v32, s[20:23], s60 offen offset:0 lds
    v_mfma_f32_16x16x32_bf16 v[136:139], a[128:131], a[88:91], v[136:139]
    ds_read_b64_tr_b16 a[98:99], v114 offset:17408
    ds_read_b128 a[68:71], v112 offset:2048
    v_mfma_f32_16x16x32_bf16 v[140:143], a[128:131], a[92:95], v[140:143]
    s_lshl_b32 s96, s54, 14
    s_add_u32 s54, s69, 2
    v_mfma_f32_16x16x32_bf16 v[144:147], a[132:135], a[80:83], v[144:147]
    ds_read_b128 a[72:75], v112 offset:4096
    ds_read_b128 a[76:79], v112 offset:6144
    v_mfma_f32_16x16x32_bf16 v[148:151], a[132:135], a[84:87], v[148:151]
    buffer_load_dwordx4 v33, s[20:23], s60 offen offset:1024 lds
    v_mfma_f32_16x16x32_bf16 v[152:155], a[132:135], a[88:91], v[152:155]
    ds_read_b64_tr_b16 a[100:101], v114 offset:16392
    ds_read_b64_tr_b16 a[102:103], v114 offset:17416
    v_mfma_f32_16x16x32_bf16 v[156:159], a[132:135], a[92:95], v[156:159]
    s_and_b32 s54, s54, 3
    s_lshl_b32 s55, s68, 2
    v_mfma_f32_16x16x32_bf16 v[160:163], a[136:139], a[80:83], v[160:163]
    ds_read_b64_tr_b16 a[104:105], v115 offset:16384
    ds_read_b64_tr_b16 a[106:107], v115 offset:17408
    v_mfma_f32_16x16x32_bf16 v[164:167], a[136:139], a[84:87], v[164:167]
    buffer_load_dwordx4 v34, s[20:23], s60 offen offset:2048 lds
    v_mfma_f32_16x16x32_bf16 v[168:171], a[136:139], a[88:91], v[168:171]
    ds_read_b64_tr_b16 a[108:109], v115 offset:16392
    ds_read_b64_tr_b16 a[110:111], v115 offset:17416
    v_mfma_f32_16x16x32_bf16 v[172:175], a[136:139], a[92:95], v[172:175]
    s_add_u32 s54, s54, s55
    s_lshl_b32 s55, s64, 5
    v_mfma_f32_16x16x32_bf16 v[176:179], a[140:143], a[80:83], v[176:179]
    ds_read_b64_tr_b16 a[112:113], v116 offset:16384
    ds_read_b64_tr_b16 a[114:115], v116 offset:17408
    v_mfma_f32_16x16x32_bf16 v[180:183], a[140:143], a[84:87], v[180:183]
    buffer_load_dwordx4 v35, s[20:23], s60 offen offset:3072 lds
    v_mfma_f32_16x16x32_bf16 v[184:187], a[140:143], a[88:91], v[184:187]
    ds_read_b64_tr_b16 a[116:117], v116 offset:16392
    ds_read_b64_tr_b16 a[118:119], v116 offset:17416
    v_mfma_f32_16x16x32_bf16 v[188:191], a[140:143], a[92:95], v[188:191]
    s_add_u32 s54, s54, s55
    s_lshl_b32 s54, s54, 2
    v_mfma_f32_16x16x32_bf16 v[192:195], a[144:147], a[80:83], v[192:195]
    ds_read_b64_tr_b16 a[120:121], v117 offset:16384
    ds_read_b64_tr_b16 a[122:123], v117 offset:17408
    v_mfma_f32_16x16x32_bf16 v[196:199], a[144:147], a[84:87], v[196:199]
    s_add_u32 m0, s62, 86016
    s_nop 0
    buffer_load_dwordx4 v36, s[20:23], s60 offen offset:0 lds
    v_mfma_f32_16x16x32_bf16 v[200:203], a[144:147], a[88:91], v[200:203]
    ds_read_b64_tr_b16 a[124:125], v117 offset:16392
    ds_read_b64_tr_b16 a[126:127], v117 offset:17416
    v_mfma_f32_16x16x32_bf16 v[204:207], a[144:147], a[92:95], v[204:207]
    s_add_u32 s54, s54, s3
    s_lshl_b32 s97, s54, 14
    v_mfma_f32_16x16x32_bf16 v[208:211], a[148:151], a[80:83], v[208:211]
    s_add_u32 s54, s69, 3
    s_and_b32 s54, s54, 3
    v_mfma_f32_16x16x32_bf16 v[212:215], a[148:151], a[84:87], v[212:215]
    buffer_load_dwordx4 v37, s[20:23], s60 offen offset:1024 lds
    v_mfma_f32_16x16x32_bf16 v[216:219], a[148:151], a[88:91], v[216:219]
    s_lshl_b32 s55, s68, 2
    s_add_u32 s54, s54, s55
    v_mfma_f32_16x16x32_bf16 v[220:223], a[148:151], a[92:95], v[220:223]
    s_lshl_b32 s55, s64, 5
    s_add_u32 s54, s54, s55
    v_mfma_f32_16x16x32_bf16 v[224:227], a[152:155], a[80:83], v[224:227]
    s_lshl_b32 s54, s54, 2
    s_add_u32 s54, s54, s3
    v_mfma_f32_16x16x32_bf16 v[228:231], a[152:155], a[84:87], v[228:231]
    buffer_load_dwordx4 v38, s[20:23], s60 offen offset:2048 lds
    v_mfma_f32_16x16x32_bf16 v[232:235], a[152:155], a[88:91], v[232:235]
    s_lshl_b32 s98, s54, 14
    s_lshl_b32 s54, s64, 2
    v_mfma_f32_16x16x32_bf16 v[236:239], a[152:155], a[92:95], v[236:239]
    s_add_u32 s54, s54, s69
    s_lshl_b32 s54, s54, 3
    v_mfma_f32_16x16x32_bf16 v[240:243], a[156:159], a[80:83], v[240:243]
    s_lshl_b32 s55, s3, 1
    s_add_u32 s55, s54, s55
    v_mfma_f32_16x16x32_bf16 v[244:247], a[156:159], a[84:87], v[244:247]
    buffer_load_dwordx4 v39, s[20:23], s60 offen offset:3072 lds
    v_mfma_f32_16x16x32_bf16 v[248:251], a[156:159], a[88:91], v[248:251]
    s_lshl_b32 s55, s55, 4
    s_add_u32 s55, s55, s68
    v_mfma_f32_16x16x32_bf16 v[252:255], a[156:159], a[92:95], v[252:255]
    s_mul_i32 s100, s55, 5120
    s_add_u32 s100, s100, 16777216
    s_lshl_b32 s57, s64, 5
    v_mov_b32 v6, s57
    v_mov_b32 v7, 1
    s_cmp_eq_u32 s3, 0
    s_cbranch_scc0 L_noreg
    s_mov_b64 exec, 1
    global_atomic_add v6, v7, s[16:17] sc1
    s_mov_b64 exec, -1
L_noreg:
    s_waitcnt lgkmcnt(0)
    v_mfma_f32_16x16x32_bf16 v[128:131], a[96:99], a[64:67], v[128:131]
    ds_read_b128 a[80:83], v113 offset:0
    ds_read_b64_tr_b16 a[128:129], v114 offset:24576
    v_mfma_f32_16x16x32_bf16 v[132:135], a[96:99], a[68:71], v[132:135]
    s_add_u32 m0, s48, 114688
    s_mov_b32 s61, 3145728
    buffer_load_dwordx4 v40, s[24:27], s61 offen offset:0 lds
    v_mfma_f32_16x16x32_bf16 v[136:139], a[96:99], a[72:75], v[136:139]
    ds_read_b64_tr_b16 a[130:131], v114 offset:25600
    ds_read_b128 a[84:87], v113 offset:2048
    v_mfma_f32_16x16x32_bf16 v[140:143], a[96:99], a[76:79], v[140:143]
    s_add_u32 s54, s54, s68
    s_mul_i32 s14, s54, 81920
    v_mfma_f32_16x16x32_bf16 v[144:147], a[100:103], a[64:67], v[144:147]
    ds_read_b128 a[88:91], v113 offset:4096
    ds_read_b128 a[92:95], v113 offset:6144
    v_mfma_f32_16x16x32_bf16 v[148:151], a[100:103], a[68:71], v[148:151]
    s_add_u32 s14, s14, 16777216
    s_lshr_b32 s54, s68, 1
    v_mfma_f32_16x16x32_bf16 v[152:155], a[100:103], a[72:75], v[152:155]
    ds_read_b64_tr_b16 a[132:133], v114 offset:24584
    ds_read_b64_tr_b16 a[134:135], v114 offset:25608
    v_mfma_f32_16x16x32_bf16 v[156:159], a[100:103], a[76:79], v[156:159]
    s_lshl_b32 s54, s54, 2
    s_and_b32 s55, s68, 1
    v_mfma_f32_16x16x32_bf16 v[160:163], a[104:107], a[64:67], v[160:163]
    ds_read_b64_tr_b16 a[136:137], v115 offset:24576
    ds_read_b64_tr_b16 a[138:139], v115 offset:25600
    v_mfma_f32_16x16x32_bf16 v[164:167], a[104:107], a[68:71], v[164:167]
    buffer_load_dwordx4 v41, s[24:27], s61 offen offset:1024 lds
    v_mfma_f32_16x16x32_bf16 v[168:171], a[104:107], a[72:75], v[168:171]
    ds_read_b64_tr_b16 a[140:141], v115 offset:24584
    ds_read_b64_tr_b16 a[142:143], v115 offset:25608
    v_mfma_f32_16x16x32_bf16 v[172:175], a[104:107], a[76:79], v[172:175]
    s_add_u32 s54, s54, s55
    s_lshl_b32 s55, s64, 4
    v_mfma_f32_16x16x32_bf16 v[176:179], a[108:111], a[64:67], v[176:179]
    ds_read_b64_tr_b16 a[144:145], v116 offset:24576
    ds_read_b64_tr_b16 a[146:147], v116 offset:25600
    v_mfma_f32_16x16x32_bf16 v[180:183], a[108:111], a[68:71], v[180:183]
    s_add_u32 s54, s54, s55
    s_mul_i32 s15, s54, 18432
    v_mfma_f32_16x16x32_bf16 v[184:187], a[108:111], a[72:75], v[184:187]
    ds_read_b64_tr_b16 a[148:149], v116 offset:24584
    ds_read_b64_tr_b16 a[150:151], v116 offset:25608
    v_mfma_f32_16x16x32_bf16 v[188:191], a[108:111], a[76:79], v[188:191]
    s_mul_i32 s55, s69, 288
    s_add_u32 s15, s15, s55
    v_mfma_f32_16x16x32_bf16 v[192:195], a[112:115], a[64:67], v[192:195]
    ds_read_b64_tr_b16 a[152:153], v117 offset:24576
    ds_read_b64_tr_b16 a[154:155], v117 offset:25600
    v_mfma_f32_16x16x32_bf16 v[196:199], a[112:115], a[68:71], v[196:199]
    buffer_load_dwordx4 v42, s[24:27], s61 offen offset:2048 lds
    v_mfma_f32_16x16x32_bf16 v[200:203], a[112:115], a[72:75], v[200:203]
    ds_read_b64_tr_b16 a[156:157], v117 offset:24584
    ds_read_b64_tr_b16 a[158:159], v117 offset:25608
    v_mfma_f32_16x16x32_bf16 v[204:207], a[112:115], a[76:79], v[204:207]
    v_mfma_f32_16x16x32_bf16 v[208:211], a[116:119], a[64:67], v[208:211]
    v_mfma_f32_16x16x32_bf16 v[212:215], a[116:119], a[68:71], v[212:215]
    v_mfma_f32_16x16x32_bf16 v[216:219], a[116:119], a[72:75], v[216:219]
    v_mfma_f32_16x16x32_bf16 v[220:223], a[116:119], a[76:79], v[220:223]
    v_mfma_f32_16x16x32_bf16 v[224:227], a[120:123], a[64:67], v[224:227]
    v_mfma_f32_16x16x32_bf16 v[228:231], a[120:123], a[68:71], v[228:231]
    buffer_load_dwordx4 v43, s[24:27], s61 offen offset:3072 lds
    v_mfma_f32_16x16x32_bf16 v[232:235], a[120:123], a[72:75], v[232:235]
    v_mfma_f32_16x16x32_bf16 v[236:239], a[120:123], a[76:79], v[236:239]
    v_mfma_f32_16x16x32_bf16 v[240:243], a[124:127], a[64:67], v[240:243]
    v_mfma_f32_16x16x32_bf16 v[244:247], a[124:127], a[68:71], v[244:247]
    v_mfma_f32_16x16x32_bf16 v[248:251], a[124:127], a[72:75], v[248:251]
    v_mfma_f32_16x16x32_bf16 v[252:255], a[124:127], a[76:79], v[252:255]
    s_waitcnt vmcnt(4) lgkmcnt(0)
    s_barrier
    v_mfma_f32_16x16x32_bf16 v[128:131], a[128:131], a[80:83], v[128:131]
    ds_read_b128 a[64:67], v112 offset:49152
    ds_read_b64_tr_b16 a[96:97], v114 offset:32768
    v_mfma_f32_16x16x32_bf16 v[132:135], a[128:131], a[84:87], v[132:135]
    s_add_u32 m0, s62, 32768
    s_mov_b32 s60, 768
    buffer_load_dwordx4 v32, s[20:23], s60 offen offset:0 lds
    v_mfma_f32_16x16x32_bf16 v[136:139], a[128:131], a[88:91], v[136:139]
    ds_read_b64_tr_b16 a[98:99], v114 offset:33792
    ds_read_b128 a[68:71], v112 offset:51200
    v_mfma_f32_16x16x32_bf16 v[140:143], a[128:131], a[92:95], v[140:143]
    v_mfma_f32_16x16x32_bf16 v[144:147], a[132:135], a[80:83], v[144:147]
    ds_read_b128 a[72:75], v112 offset:53248
    ds_read_b128 a[76:79], v112 offset:55296
    v_mfma_f32_16x16x32_bf16 v[148:151], a[132:135], a[84:87], v[148:151]
    buffer_load_dwordx4 v33, s[20:23], s60 offen offset:1024 lds
    v_mfma_f32_16x16x32_bf16 v[152:155], a[132:135], a[88:91], v[152:155]
    ds_read_b64_tr_b16 a[100:101], v114 offset:32776
    ds_read_b64_tr_b16 a[102:103], v114 offset:33800
    v_mfma_f32_16x16x32_bf16 v[156:159], a[132:135], a[92:95], v[156:159]
    v_mfma_f32_16x16x32_bf16 v[160:163], a[136:139], a[80:83], v[160:163]
    ds_read_b64_tr_b16 a[104:105], v115 offset:32768
    ds_read_b64_tr_b16 a[106:107], v115 offset:33792
    v_mfma_f32_16x16x32_bf16 v[164:167], a[136:139], a[84:87], v[164:167]
    buffer_load_dwordx4 v34, s[20:23], s60 offen offset:2048 lds
    v_mfma_f32_16x16x32_bf16 v[168:171], a[136:139], a[88:91], v[168:171]
    ds_read_b64_tr_b16 a[108:109], v115 offset:32776
    ds_read_b64_tr_b16 a[110:111], v115 offset:33800
    v_mfma_f32_16x16x32_bf16 v[172:175], a[136:139], a[92:95], v[172:175]
    v_mfma_f32_16x16x32_bf16 v[176:179], a[140:143], a[80:83], v[176:179]
    ds_read_b64_tr_b16 a[112:113], v116 offset:32768
    ds_read_b64_tr_b16 a[114:115], v116 offset:33792
    v_mfma_f32_16x16x32_bf16 v[180:183], a[140:143], a[84:87], v[180:183]
    buffer_load_dwordx4 v35, s[20:23], s60 offen offset:3072 lds
    v_mfma_f32_16x16x32_bf16 v[184:187], a[140:143], a[88:91], v[184:187]
    ds_read_b64_tr_b16 a[116:117], v116 offset:32776
    ds_read_b64_tr_b16 a[118:119], v116 offset:33800
    v_mfma_f32_16x16x32_bf16 v[188:191], a[140:143], a[92:95], v[188:191]
    v_mfma_f32_16x16x32_bf16 v[192:195], a[144:147], a[80:83], v[192:195]
    ds_read_b64_tr_b16 a[120:121], v117 offset:32768
    ds_read_b64_tr_b16 a[122:123], v117 offset:33792
    v_mfma_f32_16x16x32_bf16 v[196:199], a[144:147], a[84:87], v[196:199]
    s_add_u32 m0, s62, 36864
    s_nop 0
    buffer_load_dwordx4 v36, s[20:23], s60 offen offset:0 lds
    v_mfma_f32_16x16x32_bf16 v[200:203], a[144:147], a[88:91], v[200:203]
    ds_read_b64_tr_b16 a[124:125], v117 offset:32776
    ds_read_b64_tr_b16 a[126:127], v117 offset:33800
    v_mfma_f32_16x16x32_bf16 v[204:207], a[144:147], a[92:95], v[204:207]
    v_mfma_f32_16x16x32_bf16 v[208:211], a[148:151], a[80:83], v[208:211]
    v_mfma_f32_16x16x32_bf16 v[212:215], a[148:151], a[84:87], v[212:215]
    buffer_load_dwordx4 v37, s[20:23], s60 offen offset:1024 lds
    v_mfma_f32_16x16x32_bf16 v[216:219], a[148:151], a[88:91], v[216:219]
    v_mfma_f32_16x16x32_bf16 v[220:223], a[148:151], a[92:95], v[220:223]
    v_mfma_f32_16x16x32_bf16 v[224:227], a[152:155], a[80:83], v[224:227]
    v_mfma_f32_16x16x32_bf16 v[228:231], a[152:155], a[84:87], v[228:231]
    buffer_load_dwordx4 v38, s[20:23], s60 offen offset:2048 lds
    v_mfma_f32_16x16x32_bf16 v[232:235], a[152:155], a[88:91], v[232:235]
    v_mfma_f32_16x16x32_bf16 v[236:239], a[152:155], a[92:95], v[236:239]
    v_mfma_f32_16x16x32_bf16 v[240:243], a[156:159], a[80:83], v[240:243]
    v_mfma_f32_16x16x32_bf16 v[244:247], a[156:159], a[84:87], v[244:247]
    buffer_load_dwordx4 v39, s[20:23], s60 offen offset:3072 lds
    v_mfma_f32_16x16x32_bf16 v[248:251], a[156:159], a[88:91], v[248:251]
    v_mfma_f32_16x16x32_bf16 v[252:255], a[156:159], a[92:95], v[252:255]
    s_waitcnt lgkmcnt(0)
    v_mfma_f32_16x16x32_bf16 v[128:131], a[96:99], a[64:67], v[128:131]
    ds_read_b128 a[80:83], v113 offset:49152
    ds_read_b64_tr_b16 a[128:129], v114 offset:40960
    v_mfma_f32_16x16x32_bf16 v[132:135], a[96:99], a[68:71], v[132:135]
    s_add_u32 m0, s48, 131072
    s_mov_b32 s61, 3670016
    buffer_load_dwordx4 v40, s[24:27], s61 offen offset:0 lds
    v_mfma_f32_16x16x32_bf16 v[136:139], a[96:99], a[72:75], v[136:139]
    ds_read_b64_tr_b16 a[130:131], v114 offset:41984
    ds_read_b128 a[84:87], v113 offset:51200
    v_mfma_f32_16x16x32_bf16 v[140:143], a[96:99], a[76:79], v[140:143]
    v_mfma_f32_16x16x32_bf16 v[144:147], a[100:103], a[64:67], v[144:147]
    ds_read_b128 a[88:91], v113 offset:53248
    ds_read_b128 a[92:95], v113 offset:55296
    v_mfma_f32_16x16x32_bf16 v[148:151], a[100:103], a[68:71], v[148:151]
    v_mfma_f32_16x16x32_bf16 v[152:155], a[100:103], a[72:75], v[152:155]
    ds_read_b64_tr_b16 a[132:133], v114 offset:40968
    ds_read_b64_tr_b16 a[134:135], v114 offset:41992
    v_mfma_f32_16x16x32_bf16 v[156:159], a[100:103], a[76:79], v[156:159]
    v_mfma_f32_16x16x32_bf16 v[160:163], a[104:107], a[64:67], v[160:163]
    ds_read_b64_tr_b16 a[136:137], v115 offset:40960
    ds_read_b64_tr_b16 a[138:139], v115 offset:41984
    v_mfma_f32_16x16x32_bf16 v[164:167], a[104:107], a[68:71], v[164:167]
    buffer_load_dwordx4 v41, s[24:27], s61 offen offset:1024 lds
    v_mfma_f32_16x16x32_bf16 v[168:171], a[104:107], a[72:75], v[168:171]
    ds_read_b64_tr_b16 a[140:141], v115 offset:40968
    ds_read_b64_tr_b16 a[142:143], v115 offset:41992
    v_mfma_f32_16x16x32_bf16 v[172:175], a[104:107], a[76:79], v[172:175]
    v_mfma_f32_16x16x32_bf16 v[176:179], a[108:111], a[64:67], v[176:179]
    ds_read_b64_tr_b16 a[144:145], v116 offset:40960
    ds_read_b64_tr_b16 a[146:147], v116 offset:41984
    v_mfma_f32_16x16x32_bf16 v[180:183], a[108:111], a[68:71], v[180:183]
    v_mfma_f32_16x16x32_bf16 v[184:187], a[108:111], a[72:75], v[184:187]
    ds_read_b64_tr_b16 a[148:149], v116 offset:40968
    ds_read_b64_tr_b16 a[150:151], v116 offset:41992
    v_mfma_f32_16x16x32_bf16 v[188:191], a[108:111], a[76:79], v[188:191]
    v_mfma_f32_16x16x32_bf16 v[192:195], a[112:115], a[64:67], v[192:195]
    ds_read_b64_tr_b16 a[152:153], v117 offset:40960
    ds_read_b64_tr_b16 a[154:155], v117 offset:41984
    v_mfma_f32_16x16x32_bf16 v[196:199], a[112:115], a[68:71], v[196:199]
    buffer_load_dwordx4 v42, s[24:27], s61 offen offset:2048 lds
    v_mfma_f32_16x16x32_bf16 v[200:203], a[112:115], a[72:75], v[200:203]
    ds_read_b64_tr_b16 a[156:157], v117 offset:40968
    ds_read_b64_tr_b16 a[158:159], v117 offset:41992
    v_mfma_f32_16x16x32_bf16 v[204:207], a[112:115], a[76:79], v[204:207]
    v_mfma_f32_16x16x32_bf16 v[208:211], a[116:119], a[64:67], v[208:211]
    v_mfma_f32_16x16x32_bf16 v[212:215], a[116:119], a[68:71], v[212:215]
    v_mfma_f32_16x16x32_bf16 v[216:219], a[116:119], a[72:75], v[216:219]
    v_mfma_f32_16x16x32_bf16 v[220:223], a[116:119], a[76:79], v[220:223]
    v_mfma_f32_16x16x32_bf16 v[224:227], a[120:123], a[64:67], v[224:227]
    v_mfma_f32_16x16x32_bf16 v[228:231], a[120:123], a[68:71], v[228:231]
    buffer_load_dwordx4 v43, s[24:27], s61 offen offset:3072 lds
    v_mfma_f32_16x16x32_bf16 v[232:235], a[120:123], a[72:75], v[232:235]
    v_mfma_f32_16x16x32_bf16 v[236:239], a[120:123], a[76:79], v[236:239]
    v_mfma_f32_16x16x32_bf16 v[240:243], a[124:127], a[64:67], v[240:243]
    v_mfma_f32_16x16x32_bf16 v[244:247], a[124:127], a[68:71], v[244:247]
    v_mfma_f32_16x16x32_bf16 v[248:251], a[124:127], a[72:75], v[248:251]
    v_mfma_f32_16x16x32_bf16 v[252:255], a[124:127], a[76:79], v[252:255]
    s_waitcnt vmcnt(4) lgkmcnt(0)
    s_barrier
    v_mfma_f32_16x16x32_bf16 v[128:131], a[128:131], a[80:83], v[128:131]
    ds_read_b128 a[64:67], v112 offset:0
    ds_read_b64_tr_b16 a[96:97], v114 offset:0
    v_mfma_f32_16x16x32_bf16 v[132:135], a[128:131], a[84:87], v[132:135]
    s_add_u32 m0, s62, 81920
    s_mov_b32 s60, 896
    buffer_load_dwordx4 v32, s[20:23], s60 offen offset:0 lds
    v_mfma_f32_16x16x32_bf16 v[136:139], a[128:131], a[88:91], v[136:139]
    ds_read_b64_tr_b16 a[98:99], v114 offset:1024
    ds_read_b128 a[68:71], v112 offset:2048
    v_mfma_f32_16x16x32_bf16 v[140:143], a[128:131], a[92:95], v[140:143]
    v_mfma_f32_16x16x32_bf16 v[144:147], a[132:135], a[80:83], v[144:147]
    ds_read_b128 a[72:75], v112 offset:4096
    ds_read_b128 a[76:79], v112 offset:6144
    v_mfma_f32_16x16x32_bf16 v[148:151], a[132:135], a[84:87], v[148:151]
    buffer_load_dwordx4 v33, s[20:23], s60 offen offset:1024 lds
    v_mfma_f32_16x16x32_bf16 v[152:155], a[132:135], a[88:91], v[152:155]
    ds_read_b64_tr_b16 a[100:101], v114 offset:8
    ds_read_b64_tr_b16 a[102:103], v114 offset:1032
    v_mfma_f32_16x16x32_bf16 v[156:159], a[132:135], a[92:95], v[156:159]
    v_mfma_f32_16x16x32_bf16 v[160:163], a[136:139], a[80:83], v[160:163]
    ds_read_b64_tr_b16 a[104:105], v115 offset:0
    ds_read_b64_tr_b16 a[106:107], v115 offset:1024
    v_mfma_f32_16x16x32_bf16 v[164:167], a[136:139], a[84:87], v[164:167]
    buffer_load_dwordx4 v34, s[20:23], s60 offen offset:2048 lds
    v_mfma_f32_16x16x32_bf16 v[168:171], a[136:139], a[88:91], v[168:171]
    ds_read_b64_tr_b16 a[108:109], v115 offset:8
    ds_read_b64_tr_b16 a[110:111], v115 offset:1032
    v_mfma_f32_16x16x32_bf16 v[172:175], a[136:139], a[92:95], v[172:175]
    v_mfma_f32_16x16x32_bf16 v[176:179], a[140:143], a[80:83], v[176:179]
    ds_read_b64_tr_b16 a[112:113], v116 offset:0
    ds_read_b64_tr_b16 a[114:115], v116 offset:1024
    v_mfma_f32_16x16x32_bf16 v[180:183], a[140:143], a[84:87], v[180:183]
    buffer_load_dwordx4 v35, s[20:23], s60 offen offset:3072 lds
    v_mfma_f32_16x16x32_bf16 v[184:187], a[140:143], a[88:91], v[184:187]
    ds_read_b64_tr_b16 a[116:117], v116 offset:8
    ds_read_b64_tr_b16 a[118:119], v116 offset:1032
    v_mfma_f32_16x16x32_bf16 v[188:191], a[140:143], a[92:95], v[188:191]
    v_mfma_f32_16x16x32_bf16 v[192:195], a[144:147], a[80:83], v[192:195]
    ds_read_b64_tr_b16 a[120:121], v117 offset:0
    ds_read_b64_tr_b16 a[122:123], v117 offset:1024
    v_mfma_f32_16x16x32_bf16 v[196:199], a[144:147], a[84:87], v[196:199]
    s_add_u32 m0, s62, 86016
    s_nop 0
    buffer_load_dwordx4 v36, s[20:23], s60 offen offset:0 lds
    v_mfma_f32_16x16x32_bf16 v[200:203], a[144:147], a[88:91], v[200:203]
    ds_read_b64_tr_b16 a[124:125], v117 offset:8
    ds_read_b64_tr_b16 a[126:127], v117 offset:1032
    v_mfma_f32_16x16x32_bf16 v[204:207], a[144:147], a[92:95], v[204:207]
    v_mfma_f32_16x16x32_bf16 v[208:211], a[148:151], a[80:83], v[208:211]
    v_mfma_f32_16x16x32_bf16 v[212:215], a[148:151], a[84:87], v[212:215]
    buffer_load_dwordx4 v37, s[20:23], s60 offen offset:1024 lds
    v_mfma_f32_16x16x32_bf16 v[216:219], a[148:151], a[88:91], v[216:219]
    v_mfma_f32_16x16x32_bf16 v[220:223], a[148:151], a[92:95], v[220:223]
    v_mfma_f32_16x16x32_bf16 v[224:227], a[152:155], a[80:83], v[224:227]
    v_mfma_f32_16x16x32_bf16 v[228:231], a[152:155], a[84:87], v[228:231]
    buffer_load_dwordx4 v38, s[20:23], s60 offen offset:2048 lds
    v_mfma_f32_16x16x32_bf16 v[232:235], a[152:155], a[88:91], v[232:235]
    v_mfma_f32_16x16x32_bf16 v[236:239], a[152:155], a[92:95], v[236:239]
    v_mfma_f32_16x16x32_bf16 v[240:243], a[156:159], a[80:83], v[240:243]
    v_mfma_f32_16x16x32_bf16 v[244:247], a[156:159], a[84:87], v[244:247]
    buffer_load_dwordx4 v39, s[20:23], s60 offen offset:3072 lds
    v_mfma_f32_16x16x32_bf16 v[248:251], a[156:159], a[88:91], v[248:251]
    v_mfma_f32_16x16x32_bf16 v[252:255], a[156:159], a[92:95], v[252:255]
    s_waitcnt lgkmcnt(0)
    v_mfma_f32_16x16x32_bf16 v[128:131], a[96:99], a[64:67], v[128:131]
    ds_read_b128 a[80:83], v113 offset:0
    ds_read_b64_tr_b16 a[128:129], v114 offset:8192
    v_mfma_f32_16x16x32_bf16 v[132:135], a[96:99], a[68:71], v[132:135]
    s_add_u32 m0, s48, 147456
    s_mov_b32 s61, 4194304
    buffer_load_dwordx4 v40, s[24:27], s61 offen offset:0 lds
    v_mfma_f32_16x16x32_bf16 v[136:139], a[96:99], a[72:75], v[136:139]
    ds_read_b64_tr_b16 a[130:131], v114 offset:9216
    ds_read_b128 a[84:87], v113 offset:2048
    v_mfma_f32_16x16x32_bf16 v[140:143], a[96:99], a[76:79], v[140:143]
    v_mfma_f32_16x16x32_bf16 v[144:147], a[100:103], a[64:67], v[144:147]
    ds_read_b128 a[88:91], v113 offset:4096
    ds_read_b128 a[92:95], v113 offset:6144
    v_mfma_f32_16x16x32_bf16 v[148:151], a[100:103], a[68:71], v[148:151]
    v_mfma_f32_16x16x32_bf16 v[152:155], a[100:103], a[72:75], v[152:155]
    ds_read_b64_tr_b16 a[132:133], v114 offset:8200
    ds_read_b64_tr_b16 a[134:135], v114 offset:9224
    v_mfma_f32_16x16x32_bf16 v[156:159], a[100:103], a[76:79], v[156:159]
    v_mfma_f32_16x16x32_bf16 v[160:163], a[104:107], a[64:67], v[160:163]
    ds_read_b64_tr_b16 a[136:137], v115 offset:8192
    ds_read_b64_tr_b16 a[138:139], v115 offset:9216
    v_mfma_f32_16x16x32_bf16 v[164:167], a[104:107], a[68:71], v[164:167]
    buffer_load_dwordx4 v41, s[24:27], s61 offen offset:1024 lds
    v_mfma_f32_16x16x32_bf16 v[168:171], a[104:107], a[72:75], v[168:171]
    ds_read_b64_tr_b16 a[140:141], v115 offset:8200
    ds_read_b64_tr_b16 a[142:143], v115 offset:9224
    v_mfma_f32_16x16x32_bf16 v[172:175], a[104:107], a[76:79], v[172:175]
    v_mfma_f32_16x16x32_bf16 v[176:179], a[108:111], a[64:67], v[176:179]
    ds_read_b64_tr_b16 a[144:145], v116 offset:8192
    ds_read_b64_tr_b16 a[146:147], v116 offset:9216
    v_mfma_f32_16x16x32_bf16 v[180:183], a[108:111], a[68:71], v[180:183]
    v_mfma_f32_16x16x32_bf16 v[184:187], a[108:111], a[72:75], v[184:187]
    ds_read_b64_tr_b16 a[148:149], v116 offset:8200
    ds_read_b64_tr_b16 a[150:151], v116 offset:9224
    v_mfma_f32_16x16x32_bf16 v[188:191], a[108:111], a[76:79], v[188:191]
    v_mfma_f32_16x16x32_bf16 v[192:195], a[112:115], a[64:67], v[192:195]
    ds_read_b64_tr_b16 a[152:153], v117 offset:8192
    ds_read_b64_tr_b16 a[154:155], v117 offset:9216
    v_mfma_f32_16x16x32_bf16 v[196:199], a[112:115], a[68:71], v[196:199]
    buffer_load_dwordx4 v42, s[24:27], s61 offen offset:2048 lds
    v_mfma_f32_16x16x32_bf16 v[200:203], a[112:115], a[72:75], v[200:203]
    ds_read_b64_tr_b16 a[156:157], v117 offset:8200
    ds_read_b64_tr_b16 a[158:159], v117 offset:9224
    v_mfma_f32_16x16x32_bf16 v[204:207], a[112:115], a[76:79], v[204:207]
    v_mfma_f32_16x16x32_bf16 v[208:211], a[116:119], a[64:67], v[208:211]
    v_mfma_f32_16x16x32_bf16 v[212:215], a[116:119], a[68:71], v[212:215]
    v_mfma_f32_16x16x32_bf16 v[216:219], a[116:119], a[72:75], v[216:219]
    v_mfma_f32_16x16x32_bf16 v[220:223], a[116:119], a[76:79], v[220:223]
    v_mfma_f32_16x16x32_bf16 v[224:227], a[120:123], a[64:67], v[224:227]
    v_mfma_f32_16x16x32_bf16 v[228:231], a[120:123], a[68:71], v[228:231]
    buffer_load_dwordx4 v43, s[24:27], s61 offen offset:3072 lds
    v_mfma_f32_16x16x32_bf16 v[232:235], a[120:123], a[72:75], v[232:235]
    v_mfma_f32_16x16x32_bf16 v[236:239], a[120:123], a[76:79], v[236:239]
    v_mfma_f32_16x16x32_bf16 v[240:243], a[124:127], a[64:67], v[240:243]
    v_mfma_f32_16x16x32_bf16 v[244:247], a[124:127], a[68:71], v[244:247]
    v_mfma_f32_16x16x32_bf16 v[248:251], a[124:127], a[72:75], v[248:251]
    v_mfma_f32_16x16x32_bf16 v[252:255], a[124:127], a[76:79], v[252:255]
    s_waitcnt vmcnt(4) lgkmcnt(0)
    s_barrier
    v_mfma_f32_16x16x32_bf16 v[128:131], a[128:131], a[80:83], v[128:131]
    ds_read_b128 a[64:67], v112 offset:49152
    ds_read_b64_tr_b16 a[96:97], v114 offset:16384
    v_mfma_f32_16x16x32_bf16 v[132:135], a[128:131], a[84:87], v[132:135]
    s_add_u32 m0, s62, 32768
    s_mov_b32 s60, 1024
    buffer_load_dwordx4 v32, s[20:23], s60 offen offset:0 lds
    v_mfma_f32_16x16x32_bf16 v[136:139], a[128:131], a[88:91], v[136:139]
    ds_read_b64_tr_b16 a[98:99], v114 offset:17408
    ds_read_b128 a[68:71], v112 offset:51200
    v_mfma_f32_16x16x32_bf16 v[140:143], a[128:131], a[92:95], v[140:143]
    buffer_load_dwordx4 v33, s[20:23], s60 offen offset:1024 lds
    v_mfma_f32_16x16x32_bf16 v[144:147], a[132:135], a[80:83], v[144:147]
    ds_read_b128 a[72:75], v112 offset:53248
    ds_read_b128 a[76:79], v112 offset:55296
    v_mfma_f32_16x16x32_bf16 v[148:151], a[132:135], a[84:87], v[148:151]
    buffer_load_dwordx4 v34, s[20:23], s60 offen offset:2048 lds
    v_mfma_f32_16x16x32_bf16 v[152:155], a[132:135], a[88:91], v[152:155]
    ds_read_b64_tr_b16 a[100:101], v114 offset:16392
    ds_read_b64_tr_b16 a[102:103], v114 offset:17416
    v_mfma_f32_16x16x32_bf16 v[156:159], a[132:135], a[92:95], v[156:159]
    buffer_load_dwordx4 v35, s[20:23], s60 offen offset:3072 lds
    v_mfma_f32_16x16x32_bf16 v[160:163], a[136:139], a[80:83], v[160:163]
    ds_read_b64_tr_b16 a[104:105], v115 offset:16384
    ds_read_b64_tr_b16 a[106:107], v115 offset:17408
    v_mfma_f32_16x16x32_bf16 v[164:167], a[136:139], a[84:87], v[164:167]
    s_add_u32 m0, s62, 36864
    s_nop 0
    buffer_load_dwordx4 v36, s[20:23], s60 offen offset:0 lds
    v_mfma_f32_16x16x32_bf16 v[168:171], a[136:139], a[88:91], v[168:171]
    ds_read_b64_tr_b16 a[108:109], v115 offset:16392
    ds_read_b64_tr_b16 a[110:111], v115 offset:17416
    v_mfma_f32_16x16x32_bf16 v[172:175], a[136:139], a[92:95], v[172:175]
    buffer_load_dwordx4 v37, s[20:23], s60 offen offset:1024 lds
    v_mfma_f32_16x16x32_bf16 v[176:179], a[140:143], a[80:83], v[176:179]
    ds_read_b64_tr_b16 a[112:113], v116 offset:16384
    ds_read_b64_tr_b16 a[114:115], v116 offset:17408
    v_mfma_f32_16x16x32_bf16 v[180:183], a[140:143], a[84:87], v[180:183]
    buffer_load_dwordx4 v38, s[20:23], s60 offen offset:2048 lds
    v_mfma_f32_16x16x32_bf16 v[184:187], a[140:143], a[88:91], v[184:187]
    ds_read_b64_tr_b16 a[116:117], v116 offset:16392
    ds_read_b64_tr_b16 a[118:119], v116 offset:17416
    v_mfma_f32_16x16x32_bf16 v[188:191], a[140:143], a[92:95], v[188:191]
    v_mfma_f32_16x16x32_bf16 v[192:195], a[144:147], a[80:83], v[192:195]
    ds_read_b64_tr_b16 a[120:121], v117 offset:16384
    ds_read_b64_tr_b16 a[122:123], v117 offset:17408
    v_mfma_f32_16x16x32_bf16 v[196:199], a[144:147], a[84:87], v[196:199]
    buffer_load_dwordx4 v39, s[20:23], s60 offen offset:3072 lds
    v_mfma_f32_16x16x32_bf16 v[200:203], a[144:147], a[88:91], v[200:203]
    ds_read_b64_tr_b16 a[124:125], v117 offset:16392
    ds_read_b64_tr_b16 a[126:127], v117 offset:17416
    v_mfma_f32_16x16x32_bf16 v[204:207], a[144:147], a[92:95], v[204:207]
    s_mov_b32 m0, s48
    s_mov_b32 s49, s70
    buffer_load_dwordx4 v20, s[28:31], s49 offen offset:0 nt lds
    v_mfma_f32_16x16x32_bf16 v[208:211], a[148:151], a[80:83], v[208:211]
    v_mfma_f32_16x16x32_bf16 v[212:215], a[148:151], a[84:87], v[212:215]
    buffer_load_dwordx4 v21, s[28:31], s49 offen offset:1024 nt lds
    v_mfma_f32_16x16x32_bf16 v[216:219], a[148:151], a[88:91], v[216:219]
    v_mfma_f32_16x16x32_bf16 v[220:223], a[148:151], a[92:95], v[220:223]
    buffer_load_dwordx4 v22, s[28:31], s49 offen offset:2048 nt lds
    v_mfma_f32_16x16x32_bf16 v[224:227], a[152:155], a[80:83], v[224:227]
    v_mfma_f32_16x16x32_bf16 v[228:231], a[152:155], a[84:87], v[228:231]
    buffer_load_dwordx4 v23, s[28:31], s49 offen offset:3072 nt lds
    v_mfma_f32_16x16x32_bf16 v[232:235], a[152:155], a[88:91], v[232:235]
    v_mfma_f32_16x16x32_bf16 v[236:239], a[152:155], a[92:95], v[236:239]
    s_lshl_b32 s56, s3, 11
    s_add_u32 m0, s56, 73728
    s_sub_u32 s56, s70, s56
    buffer_load_dwordx4 v24, s[32:35], s56 offen offset:0 nt lds
    v_mfma_f32_16x16x32_bf16 v[240:243], a[156:159], a[80:83], v[240:243]
    v_mfma_f32_16x16x32_bf16 v[244:247], a[156:159], a[84:87], v[244:247]
    buffer_load_dwordx4 v25, s[32:35], s56 offen offset:1024 nt lds
    v_mfma_f32_16x16x32_bf16 v[248:251], a[156:159], a[88:91], v[248:251]
    v_mfma_f32_16x16x32_bf16 v[252:255], a[156:159], a[92:95], v[252:255]
    s_waitcnt lgkmcnt(0)
    v_mfma_f32_16x16x32_bf16 v[128:131], a[96:99], a[64:67], v[128:131]
    ds_read_b128 a[80:83], v113 offset:49152
    ds_read_b64_tr_b16 a[128:129], v114 offset:24576
    v_mfma_f32_16x16x32_bf16 v[132:135], a[96:99], a[68:71], v[132:135]
    v_mfma_f32_16x16x32_bf16 v[136:139], a[96:99], a[72:75], v[136:139]
    ds_read_b64_tr_b16 a[130:131], v114 offset:25600
    ds_read_b128 a[84:87], v113 offset:51200
    v_mfma_f32_16x16x32_bf16 v[140:143], a[96:99], a[76:79], v[140:143]
    v_mfma_f32_16x16x32_bf16 v[144:147], a[100:103], a[64:67], v[144:147]
    ds_read_b128 a[88:91], v113 offset:53248
    ds_read_b128 a[92:95], v113 offset:55296
    v_mfma_f32_16x16x32_bf16 v[148:151], a[100:103], a[68:71], v[148:151]
    v_mfma_f32_16x16x32_bf16 v[152:155], a[100:103], a[72:75], v[152:155]
    ds_read_b64_tr_b16 a[132:133], v114 offset:24584
    ds_read_b64_tr_b16 a[134:135], v114 offset:25608
    v_mfma_f32_16x16x32_bf16 v[156:159], a[100:103], a[76:79], v[156:159]
    v_mfma_f32_16x16x32_bf16 v[160:163], a[104:107], a[64:67], v[160:163]
    ds_read_b64_tr_b16 a[136:137], v115 offset:24576
    ds_read_b64_tr_b16 a[138:139], v115 offset:25600
    v_mfma_f32_16x16x32_bf16 v[164:167], a[104:107], a[68:71], v[164:167]
    v_mfma_f32_16x16x32_bf16 v[168:171], a[104:107], a[72:75], v[168:171]
    ds_read_b64_tr_b16 a[140:141], v115 offset:24584
    ds_read_b64_tr_b16 a[142:143], v115 offset:25608
    v_mfma_f32_16x16x32_bf16 v[172:175], a[104:107], a[76:79], v[172:175]
    v_mfma_f32_16x16x32_bf16 v[176:179], a[108:111], a[64:67], v[176:179]
    ds_read_b64_tr_b16 a[144:145], v116 offset:24576
    ds_read_b64_tr_b16 a[146:147], v116 offset:25600
    v_mfma_f32_16x16x32_bf16 v[180:183], a[108:111], a[68:71], v[180:183]
    v_mfma_f32_16x16x32_bf16 v[184:187], a[108:111], a[72:75], v[184:187]
    ds_read_b64_tr_b16 a[148:149], v116 offset:24584
    ds_read_b64_tr_b16 a[150:151], v116 offset:25608
    v_mfma_f32_16x16x32_bf16 v[188:191], a[108:111], a[76:79], v[188:191]
    v_mfma_f32_16x16x32_bf16 v[192:195], a[112:115], a[64:67], v[192:195]
    ds_read_b64_tr_b16 a[152:153], v117 offset:24576
    ds_read_b64_tr_b16 a[154:155], v117 offset:25600
    v_mfma_f32_16x16x32_bf16 v[196:199], a[112:115], a[68:71], v[196:199]
    v_mfma_f32_16x16x32_bf16 v[200:203], a[112:115], a[72:75], v[200:203]
    ds_read_b64_tr_b16 a[156:157], v117 offset:24584
    ds_read_b64_tr_b16 a[158:159], v117 offset:25608
    v_mfma_f32_16x16x32_bf16 v[204:207], a[112:115], a[76:79], v[204:207]
    v_mfma_f32_16x16x32_bf16 v[208:211], a[116:119], a[64:67], v[208:211]
    v_mfma_f32_16x16x32_bf16 v[212:215], a[116:119], a[68:71], v[212:215]
    v_mfma_f32_16x16x32_bf16 v[216:219], a[116:119], a[72:75], v[216:219]
    v_mfma_f32_16x16x32_bf16 v[220:223], a[116:119], a[76:79], v[220:223]
    v_mfma_f32_16x16x32_bf16 v[224:227], a[120:123], a[64:67], v[224:227]
    v_mfma_f32_16x16x32_bf16 v[228:231], a[120:123], a[68:71], v[228:231]
    v_mfma_f32_16x16x32_bf16 v[232:235], a[120:123], a[72:75], v[232:235]
    v_mfma_f32_16x16x32_bf16 v[236:239], a[120:123], a[76:79], v[236:239]
    v_mfma_f32_16x16x32_bf16 v[240:243], a[124:127], a[64:67], v[240:243]
    v_mfma_f32_16x16x32_bf16 v[244:247], a[124:127], a[68:71], v[244:247]
    v_mfma_f32_16x16x32_bf16 v[248:251], a[124:127], a[72:75], v[248:251]
    v_mfma_f32_16x16x32_bf16 v[252:255], a[124:127], a[76:79], v[252:255]
    s_waitcnt vmcnt(6) lgkmcnt(0)
    s_barrier
    v_mfma_f32_16x16x32_bf16 v[128:131], a[128:131], a[80:83], v[128:131]
    ds_read_b128 a[64:67], v112 offset:0
    ds_read_b64_tr_b16 a[96:97], v114 offset:32768
    v_mfma_f32_16x16x32_bf16 v[132:135], a[128:131], a[84:87], v[132:135]
    s_add_u32 m0, s48, 16384
    s_add_u32 s49, s70, 16384
    s_and_b32 s49, s49, 0x3ffff
    buffer_load_dwordx4 v20, s[28:31], s49 offen offset:0 nt lds
    v_mfma_f32_16x16x32_bf16 v[136:139], a[128:131], a[88:91], v[136:139]
    ds_read_b64_tr_b16 a[98:99], v114 offset:33792
    ds_read_b128 a[68:71], v112 offset:2048
    v_mfma_f32_16x16x32_bf16 v[140:143], a[128:131], a[92:95], v[140:143]
    v_mfma_f32_16x16x32_bf16 v[144:147], a[132:135], a[80:83], v[144:147]
    ds_read_b128 a[72:75], v112 offset:4096
    ds_read_b128 a[76:79], v112 offset:6144
    v_mfma_f32_16x16x32_bf16 v[148:151], a[132:135], a[84:87], v[148:151]
    v_mfma_f32_16x16x32_bf16 v[152:155], a[132:135], a[88:91], v[152:155]
    ds_read_b64_tr_b16 a[100:101], v114 offset:32776
    ds_read_b64_tr_b16 a[102:103], v114 offset:33800
    v_mfma_f32_16x16x32_bf16 v[156:159], a[132:135], a[92:95], v[156:159]
    v_mfma_f32_16x16x32_bf16 v[160:163], a[136:139], a[80:83], v[160:163]
    ds_read_b64_tr_b16 a[104:105], v115 offset:32768
    ds_read_b64_tr_b16 a[106:107], v115 offset:33792
    v_mfma_f32_16x16x32_bf16 v[164:167], a[136:139], a[84:87], v[164:167]
    buffer_load_dwordx4 v21, s[28:31], s49 offen offset:1024 nt lds
    v_mfma_f32_16x16x32_bf16 v[168:171], a[136:139], a[88:91], v[168:171]
    ds_read_b64_tr_b16 a[108:109], v115 offset:32776
    ds_read_b64_tr_b16 a[110:111], v115 offset:33800
    v_mfma_f32_16x16x32_bf16 v[172:175], a[136:139], a[92:95], v[172:175]
    v_mfma_f32_16x16x32_bf16 v[176:179], a[140:143], a[80:83], v[176:179]
    ds_read_b64_tr_b16 a[112:113], v116 offset:32768
    ds_read_b64_tr_b16 a[114:115], v116 offset:33792
    v_mfma_f32_16x16x32_bf16 v[180:183], a[140:143], a[84:87], v[180:183]
    v_mfma_f32_16x16x32_bf16 v[184:187], a[140:143], a[88:91], v[184:187]
    ds_read_b64_tr_b16 a[116:117], v116 offset:32776
    ds_read_b64_tr_b16 a[118:119], v116 offset:33800
    v_mfma_f32_16x16x32_bf16 v[188:191], a[140:143], a[92:95], v[188:191]
    v_mfma_f32_16x16x32_bf16 v[192:195], a[144:147], a[80:83], v[192:195]
    ds_read_b64_tr_b16 a[120:121], v117 offset:32768
    ds_read_b64_tr_b16 a[122:123], v117 offset:33792
    v_mfma_f32_16x16x32_bf16 v[196:199], a[144:147], a[84:87], v[196:199]
    buffer_load_dwordx4 v22, s[28:31], s49 offen offset:2048 nt lds
    v_mfma_f32_16x16x32_bf16 v[200:203], a[144:147], a[88:91], v[200:203]
    ds_read_b64_tr_b16 a[124:125], v117 offset:32776
    ds_read_b64_tr_b16 a[126:127], v117 offset:33800
    v_mfma_f32_16x16x32_bf16 v[204:207], a[144:147], a[92:95], v[204:207]
    v_mfma_f32_16x16x32_bf16 v[208:211], a[148:151], a[80:83], v[208:211]
    v_mfma_f32_16x16x32_bf16 v[212:215], a[148:151], a[84:87], v[212:215]
    v_mfma_f32_16x16x32_bf16 v[216:219], a[148:151], a[88:91], v[216:219]
    v_mfma_f32_16x16x32_bf16 v[220:223], a[148:151], a[92:95], v[220:223]
    v_mfma_f32_16x16x32_bf16 v[224:227], a[152:155], a[80:83], v[224:227]
    v_mfma_f32_16x16x32_bf16 v[228:231], a[152:155], a[84:87], v[228:231]
    buffer_load_dwordx4 v23, s[28:31], s49 offen offset:3072 nt lds
    v_mfma_f32_16x16x32_bf16 v[232:235], a[152:155], a[88:91], v[232:235]
    v_mfma_f32_16x16x32_bf16 v[236:239], a[152:155], a[92:95], v[236:239]
    v_mfma_f32_16x16x32_bf16 v[240:243], a[156:159], a[80:83], v[240:243]
    v_mfma_f32_16x16x32_bf16 v[244:247], a[156:159], a[84:87], v[244:247]
    v_mfma_f32_16x16x32_bf16 v[248:251], a[156:159], a[88:91], v[248:251]
    v_mfma_f32_16x16x32_bf16 v[252:255], a[156:159], a[92:95], v[252:255]
    s_waitcnt lgkmcnt(0)
    v_mfma_f32_16x16x32_bf16 v[128:131], a[96:99], a[64:67], v[128:131]
    ds_read_b128 a[80:83], v113 offset:0
    ds_read_b64_tr_b16 a[128:129], v114 offset:40960
    v_mfma_f32_16x16x32_bf16 v[132:135], a[96:99], a[68:71], v[132:135]
    s_add_u32 m0, s48, 81920
    s_add_u32 s50, s70, 8192
    s_and_b32 s50, s50, 0x3ffff
    buffer_load_dwordx4 v24, s[32:35], s50 offen offset:0 nt lds
    v_mfma_f32_16x16x32_bf16 v[136:139], a[96:99], a[72:75], v[136:139]
    ds_read_b64_tr_b16 a[130:131], v114 offset:41984
    ds_read_b128 a[84:87], v113 offset:2048
    v_mfma_f32_16x16x32_bf16 v[140:143], a[96:99], a[76:79], v[140:143]
    v_mfma_f32_16x16x32_bf16 v[144:147], a[100:103], a[64:67], v[144:147]
    ds_read_b128 a[88:91], v113 offset:4096
    ds_read_b128 a[92:95], v113 offset:6144
    v_mfma_f32_16x16x32_bf16 v[148:151], a[100:103], a[68:71], v[148:151]
    v_mfma_f32_16x16x32_bf16 v[152:155], a[100:103], a[72:75], v[152:155]
    ds_read_b64_tr_b16 a[132:133], v114 offset:40968
    ds_read_b64_tr_b16 a[134:135], v114 offset:41992
    v_mfma_f32_16x16x32_bf16 v[156:159], a[100:103], a[76:79], v[156:159]
    v_mfma_f32_16x16x32_bf16 v[160:163], a[104:107], a[64:67], v[160:163]
    ds_read_b64_tr_b16 a[136:137], v115 offset:40960
    ds_read_b64_tr_b16 a[138:139], v115 offset:41984
    v_mfma_f32_16x16x32_bf16 v[164:167], a[104:107], a[68:71], v[164:167]
    buffer_load_dwordx4 v25, s[32:35], s50 offen offset:1024 nt lds
    v_mfma_f32_16x16x32_bf16 v[168:171], a[104:107], a[72:75], v[168:171]
    ds_read_b64_tr_b16 a[140:141], v115 offset:40968
    ds_read_b64_tr_b16 a[142:143], v115 offset:41992
    v_mfma_f32_16x16x32_bf16 v[172:175], a[104:107], a[76:79], v[172:175]
    v_mfma_f32_16x16x32_bf16 v[176:179], a[108:111], a[64:67], v[176:179]
    ds_read_b64_tr_b16 a[144:145], v116 offset:40960
    ds_read_b64_tr_b16 a[146:147], v116 offset:41984
    v_mfma_f32_16x16x32_bf16 v[180:183], a[108:111], a[68:71], v[180:183]
    v_mfma_f32_16x16x32_bf16 v[184:187], a[108:111], a[72:75], v[184:187]
    ds_read_b64_tr_b16 a[148:149], v116 offset:40968
    ds_read_b64_tr_b16 a[150:151], v116 offset:41992
    v_mfma_f32_16x16x32_bf16 v[188:191], a[108:111], a[76:79], v[188:191]
    v_mfma_f32_16x16x32_bf16 v[192:195], a[112:115], a[64:67], v[192:195]
    ds_read_b64_tr_b16 a[152:153], v117 offset:40960
    ds_read_b64_tr_b16 a[154:155], v117 offset:41984
    v_mfma_f32_16x16x32_bf16 v[196:199], a[112:115], a[68:71], v[196:199]
    buffer_load_dwordx4 v24, s[32:35], s50 offen offset:2048 nt lds
    v_mfma_f32_16x16x32_bf16 v[200:203], a[112:115], a[72:75], v[200:203]
    ds_read_b64_tr_b16 a[156:157], v117 offset:40968
    ds_read_b64_tr_b16 a[158:159], v117 offset:41992
    v_mfma_f32_16x16x32_bf16 v[204:207], a[112:115], a[76:79], v[204:207]
    v_mfma_f32_16x16x32_bf16 v[208:211], a[116:119], a[64:67], v[208:211]
    v_mfma_f32_16x16x32_bf16 v[212:215], a[116:119], a[68:71], v[212:215]
    v_mfma_f32_16x16x32_bf16 v[216:219], a[116:119], a[72:75], v[216:219]
    v_mfma_f32_16x16x32_bf16 v[220:223], a[116:119], a[76:79], v[220:223]
    v_mfma_f32_16x16x32_bf16 v[224:227], a[120:123], a[64:67], v[224:227]
    v_mfma_f32_16x16x32_bf16 v[228:231], a[120:123], a[68:71], v[228:231]
    buffer_load_dwordx4 v25, s[32:35], s50 offen offset:3072 nt lds
    v_mfma_f32_16x16x32_bf16 v[232:235], a[120:123], a[72:75], v[232:235]
    v_mfma_f32_16x16x32_bf16 v[236:239], a[120:123], a[76:79], v[236:239]
    v_mfma_f32_16x16x32_bf16 v[240:243], a[124:127], a[64:67], v[240:243]
    v_mfma_f32_16x16x32_bf16 v[244:247], a[124:127], a[68:71], v[244:247]
    v_mfma_f32_16x16x32_bf16 v[248:251], a[124:127], a[72:75], v[248:251]
    v_mfma_f32_16x16x32_bf16 v[252:255], a[124:127], a[76:79], v[252:255]
    s_waitcnt vmcnt(8) lgkmcnt(0)
    s_barrier
    v_mfma_f32_16x16x32_bf16 v[128:131], a[128:131], a[80:83], v[128:131]
    ds_read_b128 a[64:67], v8 offset:0
    ds_read_b128 a[68:71], v8 offset:4096
    v_mfma_f32_16x16x32_bf16 v[144:147], a[132:135], a[80:83], v[144:147]
    s_add_u32 m0, s48, 98304
    s_add_u32 s50, s70, 24576
    s_and_b32 s50, s50, 0x3ffff
    buffer_load_dwordx4 v24, s[32:35], s50 offen offset:0 nt lds
    v_mfma_f32_16x16x32_bf16 v[160:163], a[136:139], a[80:83], v[160:163]
    ds_read_b128 a[72:75], v9 offset:0
    ds_read_b128 a[76:79], v9 offset:4096
    v_mfma_f32_16x16x32_bf16 v[176:179], a[140:143], a[80:83], v[176:179]
    v_mfma_f32_16x16x32_bf16 v[192:195], a[144:147], a[80:83], v[192:195]
    ds_read_b64_tr_b16 a[96:97], v12 offset:8192
    ds_read_b64_tr_b16 a[98:99], v12 offset:12288
    v_mfma_f32_16x16x32_bf16 v[208:211], a[148:151], a[80:83], v[208:211]
    v_mfma_f32_16x16x32_bf16 v[224:227], a[152:155], a[80:83], v[224:227]
    ds_read_b64_tr_b16 a[100:101], v13 offset:8192
    ds_read_b64_tr_b16 a[102:103], v13 offset:12288
    v_mfma_f32_16x16x32_bf16 v[240:243], a[156:159], a[80:83], v[240:243]
    v_mfma_f32_16x16x32_bf16 v[132:135], a[128:131], a[84:87], v[132:135]
    ds_read_b64_tr_b16 a[104:105], v14 offset:8192
    ds_read_b64_tr_b16 a[106:107], v14 offset:12288
    v_mfma_f32_16x16x32_bf16 v[148:151], a[132:135], a[84:87], v[148:151]
    buffer_load_dwordx4 v25, s[32:35], s50 offen offset:1024 nt lds
    v_mfma_f32_16x16x32_bf16 v[164:167], a[136:139], a[84:87], v[164:167]
    ds_read_b64_tr_b16 a[108:109], v15 offset:8192
    ds_read_b64_tr_b16 a[110:111], v15 offset:12288
    v_pk_mul_f32 v[128:129], v[128:129], s[58:59]
    v_mfma_f32_16x16x32_bf16 v[180:183], a[140:143], a[84:87], v[180:183]
    v_pk_mul_f32 v[130:131], v[130:131], s[58:59]
    v_pk_mul_f32 v[144:145], v[144:145], s[58:59]
    v_pk_mul_f32 v[146:147], v[146:147], s[58:59]
    v_mfma_f32_16x16x32_bf16 v[196:199], a[144:147], a[84:87], v[196:199]
    ds_read_b64_tr_b16 a[112:113], v16 offset:8192
    ds_read_b64_tr_b16 a[114:115], v16 offset:12288
    v_cvt_pk_bf16_f32 v64, v128, v129
    v_mfma_f32_16x16x32_bf16 v[212:215], a[148:151], a[84:87], v[212:215]
    v_cvt_pk_bf16_f32 v65, v130, v131
    v_cvt_pk_bf16_f32 v66, v144, v145
    v_cvt_pk_bf16_f32 v67, v146, v147
    v_mfma_f32_16x16x32_bf16 v[228:231], a[152:155], a[84:87], v[228:231]
    ds_read_b64_tr_b16 a[116:117], v17 offset:8192
    ds_read_b64_tr_b16 a[118:119], v17 offset:12288
    v_accvgpr_write_b32 a0, v64
    v_mfma_f32_16x16x32_bf16 v[244:247], a[156:159], a[84:87], v[244:247]
    v_accvgpr_write_b32 a1, v65
    v_accvgpr_write_b32 a2, v66
    v_accvgpr_write_b32 a3, v67
    v_mfma_f32_16x16x32_bf16 v[136:139], a[128:131], a[88:91], v[136:139]
    ds_read_b64_tr_b16 a[120:121], v18 offset:8192
    ds_read_b64_tr_b16 a[122:123], v18 offset:12288
    v_pk_mul_f32 v[160:161], v[160:161], s[58:59]
    v_mfma_f32_16x16x32_bf16 v[152:155], a[132:135], a[88:91], v[152:155]
    v_pk_mul_f32 v[162:163], v[162:163], s[58:59]
    v_pk_mul_f32 v[176:177], v[176:177], s[58:59]
    v_pk_mul_f32 v[178:179], v[178:179], s[58:59]
    buffer_load_dwordx4 v24, s[32:35], s50 offen offset:2048 nt lds
    v_mfma_f32_16x16x32_bf16 v[168:171], a[136:139], a[88:91], v[168:171]
    ds_read_b64_tr_b16 a[124:125], v19 offset:8192
    ds_read_b64_tr_b16 a[126:127], v19 offset:12288
    v_cvt_pk_bf16_f32 v68, v160, v161
    v_mfma_f32_16x16x32_bf16 v[184:187], a[140:143], a[88:91], v[184:187]
    v_cvt_pk_bf16_f32 v69, v162, v163
    v_cvt_pk_bf16_f32 v70, v176, v177
    v_cvt_pk_bf16_f32 v71, v178, v179
    v_mfma_f32_16x16x32_bf16 v[200:203], a[144:147], a[88:91], v[200:203]
    v_accvgpr_write_b32 a4, v68
    v_accvgpr_write_b32 a5, v69
    v_accvgpr_write_b32 a6, v70
    v_mfma_f32_16x16x32_bf16 v[216:219], a[148:151], a[88:91], v[216:219]
    v_accvgpr_write_b32 a7, v71
    v_pk_mul_f32 v[192:193], v[192:193], s[58:59]
    v_pk_mul_f32 v[194:195], v[194:195], s[58:59]
    v_mfma_f32_16x16x32_bf16 v[232:235], a[152:155], a[88:91], v[232:235]
    v_pk_mul_f32 v[208:209], v[208:209], s[58:59]
    v_pk_mul_f32 v[210:211], v[210:211], s[58:59]
    v_cvt_pk_bf16_f32 v64, v192, v193
    v_mfma_f32_16x16x32_bf16 v[248:251], a[156:159], a[88:91], v[248:251]
    v_cvt_pk_bf16_f32 v65, v194, v195
    v_cvt_pk_bf16_f32 v66, v208, v209
    v_cvt_pk_bf16_f32 v67, v210, v211
    v_mfma_f32_16x16x32_bf16 v[140:143], a[128:131], a[92:95], v[140:143]
    v_accvgpr_write_b32 a8, v64
    v_accvgpr_write_b32 a9, v65
    v_accvgpr_write_b32 a10, v66
    v_mfma_f32_16x16x32_bf16 v[156:159], a[132:135], a[92:95], v[156:159]
    v_accvgpr_write_b32 a11, v67
    v_pk_mul_f32 v[224:225], v[224:225], s[58:59]
    v_pk_mul_f32 v[226:227], v[226:227], s[58:59]
    buffer_load_dwordx4 v25, s[32:35], s50 offen offset:3072 nt lds
    v_mfma_f32_16x16x32_bf16 v[172:175], a[136:139], a[92:95], v[172:175]
    v_pk_mul_f32 v[240:241], v[240:241], s[58:59]
    v_pk_mul_f32 v[242:243], v[242:243], s[58:59]
    v_cvt_pk_bf16_f32 v68, v224, v225
    v_mfma_f32_16x16x32_bf16 v[188:191], a[140:143], a[92:95], v[188:191]
    v_cvt_pk_bf16_f32 v69, v226, v227
    v_cvt_pk_bf16_f32 v70, v240, v241
    v_cvt_pk_bf16_f32 v71, v242, v243
    v_mfma_f32_16x16x32_bf16 v[204:207], a[144:147], a[92:95], v[204:207]
    v_accvgpr_write_b32 a12, v68
    v_accvgpr_write_b32 a13, v69
    v_accvgpr_write_b32 a14, v70
    v_mfma_f32_16x16x32_bf16 v[220:223], a[148:151], a[92:95], v[220:223]
    v_accvgpr_write_b32 a15, v71
    v_mfma_f32_16x16x32_bf16 v[236:239], a[152:155], a[92:95], v[236:239]
    v_mfma_f32_16x16x32_bf16 v[252:255], a[156:159], a[92:95], v[252:255]
    ds_read_b128 a[80:83], v10 offset:0
    ds_read_b128 a[84:87], v10 offset:4096
    ds_read_b128 a[88:91], v11 offset:0
    ds_read_b128 a[92:95], v11 offset:4096
    s_nop 1
    v_pk_mul_f32 v[132:133], v[132:133], s[58:59]
    v_pk_mul_f32 v[134:135], v[134:135], s[58:59]
    v_pk_mul_f32 v[148:149], v[148:149], s[58:59]
    v_pk_mul_f32 v[150:151], v[150:151], s[58:59]
    v_cvt_pk_bf16_f32 v64, v132, v133
    v_cvt_pk_bf16_f32 v65, v134, v135
    v_cvt_pk_bf16_f32 v66, v148, v149
    v_cvt_pk_bf16_f32 v67, v150, v151
    s_waitcnt lgkmcnt(0)
    v_accvgpr_write_b32 a16, v64
    v_accvgpr_write_b32 a17, v65
    v_accvgpr_write_b32 a18, v66
    v_mfma_f32_16x16x32_bf16 v[32:35], a[64:67], a[0:3], 0
    v_accvgpr_write_b32 a19, v67
    v_pk_mul_f32 v[164:165], v[164:165], s[58:59]
    v_pk_mul_f32 v[166:167], v[166:167], s[58:59]
    v_pk_mul_f32 v[180:181], v[180:181], s[58:59]
    v_mfma_f32_16x16x32_bf16 v[36:39], a[68:71], a[0:3], 0
    v_pk_mul_f32 v[182:183], v[182:183], s[58:59]
    v_cvt_pk_bf16_f32 v68, v164, v165
    v_cvt_pk_bf16_f32 v69, v166, v167
    v_cvt_pk_bf16_f32 v70, v180, v181
    v_mfma_f32_16x16x32_bf16 v[32:35], a[72:75], a[4:7], v[32:35]
    v_cvt_pk_bf16_f32 v71, v182, v183
    v_accvgpr_write_b32 a20, v68
    v_accvgpr_write_b32 a21, v69
    v_accvgpr_write_b32 a22, v70
    v_mfma_f32_16x16x32_bf16 v[36:39], a[76:79], a[4:7], v[36:39]
    v_accvgpr_write_b32 a23, v71
    v_pk_mul_f32 v[196:197], v[196:197], s[58:59]
    v_pk_mul_f32 v[198:199], v[198:199], s[58:59]
    v_pk_mul_f32 v[212:213], v[212:213], s[58:59]
    v_mfma_f32_16x16x32_bf16 v[32:35], a[80:83], a[8:11], v[32:35]
    v_pk_mul_f32 v[214:215], v[214:215], s[58:59]
    v_cvt_pk_bf16_f32 v64, v196, v197
    v_cvt_pk_bf16_f32 v65, v198, v199
    v_cvt_pk_bf16_f32 v66, v212, v213
    v_mfma_f32_16x16x32_bf16 v[36:39], a[84:87], a[8:11], v[36:39]
    v_cvt_pk_bf16_f32 v67, v214, v215
    v_accvgpr_write_b32 a24, v64
    v_accvgpr_write_b32 a25, v65
    v_accvgpr_write_b32 a26, v66
    v_mfma_f32_16x16x32_bf16 v[32:35], a[88:91], a[12:15], v[32:35]
    v_accvgpr_write_b32 a27, v67
    v_pk_mul_f32 v[228:229], v[228:229], s[58:59]
    v_pk_mul_f32 v[230:231], v[230:231], s[58:59]
    v_pk_mul_f32 v[244:245], v[244:245], s[58:59]
    v_mfma_f32_16x16x32_bf16 v[36:39], a[92:95], a[12:15], v[36:39]
    v_pk_mul_f32 v[246:247], v[246:247], s[58:59]
    v_cvt_pk_bf16_f32 v68, v228, v229
    v_cvt_pk_bf16_f32 v69, v230, v231
    v_cvt_pk_bf16_f32 v70, v244, v245
    v_cvt_pk_bf16_f32 v71, v246, v247
    v_accvgpr_write_b32 a28, v68
    v_accvgpr_write_b32 a29, v69
    v_accvgpr_write_b32 a30, v70
    v_accvgpr_write_b32 a31, v71
    v_pk_mul_f32 v[136:137], v[136:137], s[58:59]
    v_pk_mul_f32 v[138:139], v[138:139], s[58:59]
    v_pk_mul_f32 v[152:153], v[152:153], s[58:59]
    v_mfma_f32_16x16x32_bf16 v[40:43], a[64:67], a[16:19], 0
    v_pk_mul_f32 v[154:155], v[154:155], s[58:59]
    v_cvt_pk_bf16_f32 v64, v136, v137
    v_cvt_pk_bf16_f32 v65, v138, v139
    v_cvt_pk_bf16_f32 v66, v152, v153
    v_mfma_f32_16x16x32_bf16 v[44:47], a[68:71], a[16:19], 0
    v_cvt_pk_bf16_f32 v67, v154, v155
    v_accvgpr_write_b32 a32, v64
    v_accvgpr_write_b32 a33, v65
    v_accvgpr_write_b32 a34, v66
    v_mfma_f32_16x16x32_bf16 v[40:43], a[72:75], a[20:23], v[40:43]
    v_accvgpr_write_b32 a35, v67
    v_pk_mul_f32 v[168:169], v[168:169], s[58:59]
    v_pk_mul_f32 v[170:171], v[170:171], s[58:59]
    v_pk_mul_f32 v[184:185], v[184:185], s[58:59]
    v_mfma_f32_16x16x32_bf16 v[44:47], a[76:79], a[20:23], v[44:47]
    v_pk_mul_f32 v[186:187], v[186:187], s[58:59]
    v_cvt_pk_bf16_f32 v68, v168, v169
    v_cvt_pk_bf16_f32 v69, v170, v171
    v_cvt_pk_bf16_f32 v70, v184, v185
    v_mfma_f32_16x16x32_bf16 v[40:43], a[80:83], a[24:27], v[40:43]
    v_cvt_pk_bf16_f32 v71, v186, v187
    v_accvgpr_write_b32 a36, v68
    v_accvgpr_write_b32 a37, v69
    v_accvgpr_write_b32 a38, v70
    v_mfma_f32_16x16x32_bf16 v[44:47], a[84:87], a[24:27], v[44:47]
    v_accvgpr_write_b32 a39, v71
    v_pk_mul_f32 v[200:201], v[200:201], s[58:59]
    v_pk_mul_f32 v[202:203], v[202:203], s[58:59]
    v_pk_mul_f32 v[216:217], v[216:217], s[58:59]
    v_mfma_f32_16x16x32_bf16 v[40:43], a[88:91], a[28:31], v[40:43]
    v_pk_mul_f32 v[218:219], v[218:219], s[58:59]
    v_cvt_pk_bf16_f32 v64, v200, v201
    v_cvt_pk_bf16_f32 v65, v202, v203
    v_cvt_pk_bf16_f32 v66, v216, v217
    v_mfma_f32_16x16x32_bf16 v[44:47], a[92:95], a[28:31], v[44:47]
    v_cvt_pk_bf16_f32 v67, v218, v219
    v_accvgpr_write_b32 a40, v64
    v_accvgpr_write_b32 a41, v65
    v_accvgpr_write_b32 a42, v66
    s_add_u32 m0, s48, 32768
    s_add_u32 s49, s70, 32768
    s_and_b32 s49, s49, 0x3ffff
    buffer_load_dwordx4 v20, s[28:31], s49 offen offset:0 nt lds
    v_accvgpr_write_b32 a43, v67
    v_pk_mul_f32 v[232:233], v[232:233], s[58:59]
    v_pk_mul_f32 v[234:235], v[234:235], s[58:59]
    v_pk_mul_f32 v[248:249], v[248:249], s[58:59]
    buffer_load_dwordx4 v21, s[28:31], s49 offen offset:1024 nt lds
    v_pk_mul_f32 v[250:251], v[250:251], s[58:59]
    v_cvt_pk_bf16_f32 v68, v232, v233
    v_cvt_pk_bf16_f32 v69, v234, v235
    v_cvt_pk_bf16_f32 v70, v248, v249
    v_cvt_pk_bf16_f32 v71, v250, v251
    v_accvgpr_write_b32 a44, v68
    v_accvgpr_write_b32 a45, v69
    v_accvgpr_write_b32 a46, v70
    v_accvgpr_write_b32 a47, v71
    v_pk_mul_f32 v[140:141], v[140:141], s[58:59]
    v_pk_mul_f32 v[142:143], v[142:143], s[58:59]
    v_pk_mul_f32 v[156:157], v[156:157], s[58:59]
    v_mfma_f32_16x16x32_bf16 v[48:51], a[64:67], a[32:35], 0
    v_pk_mul_f32 v[158:159], v[158:159], s[58:59]
    v_cvt_pk_bf16_f32 v64, v140, v141
    v_cvt_pk_bf16_f32 v65, v142, v143
    v_cvt_pk_bf16_f32 v66, v156, v157
    v_mfma_f32_16x16x32_bf16 v[52:55], a[68:71], a[32:35], 0
    v_cvt_pk_bf16_f32 v67, v158, v159
    v_accvgpr_write_b32 a48, v64
    v_accvgpr_write_b32 a49, v65
    v_accvgpr_write_b32 a50, v66
    v_mfma_f32_16x16x32_bf16 v[48:51], a[72:75], a[36:39], v[48:51]
    v_accvgpr_write_b32 a51, v67
    v_pk_mul_f32 v[172:173], v[172:173], s[58:59]
    v_pk_mul_f32 v[174:175], v[174:175], s[58:59]
    v_pk_mul_f32 v[188:189], v[188:189], s[58:59]
    v_mfma_f32_16x16x32_bf16 v[52:55], a[76:79], a[36:39], v[52:55]
    v_pk_mul_f32 v[190:191], v[190:191], s[58:59]
    v_cvt_pk_bf16_f32 v68, v172, v173
    v_cvt_pk_bf16_f32 v69, v174, v175
    v_cvt_pk_bf16_f32 v70, v188, v189
    v_mfma_f32_16x16x32_bf16 v[48:51], a[80:83], a[40:43], v[48:51]
    v_cvt_pk_bf16_f32 v71, v190, v191
    v_accvgpr_write_b32 a52, v68
    v_accvgpr_write_b32 a53, v69
    v_accvgpr_write_b32 a54, v70
    v_mfma_f32_16x16x32_bf16 v[52:55], a[84:87], a[40:43], v[52:55]
    v_accvgpr_write_b32 a55, v71
    v_pk_mul_f32 v[204:205], v[204:205], s[58:59]
    v_pk_mul_f32 v[206:207], v[206:207], s[58:59]
    v_pk_mul_f32 v[220:221], v[220:221], s[58:59]
    v_mfma_f32_16x16x32_bf16 v[48:51], a[88:91], a[44:47], v[48:51]
    v_pk_mul_f32 v[222:223], v[222:223], s[58:59]
    v_cvt_pk_bf16_f32 v64, v204, v205
    v_cvt_pk_bf16_f32 v65, v206, v207
    v_cvt_pk_bf16_f32 v66, v220, v221
    v_mfma_f32_16x16x32_bf16 v[52:55], a[92:95], a[44:47], v[52:55]
    v_cvt_pk_bf16_f32 v67, v222, v223
    v_accvgpr_write_b32 a56, v64
    v_accvgpr_write_b32 a57, v65
    v_accvgpr_write_b32 a58, v66
    buffer_load_dwordx4 v22, s[28:31], s49 offen offset:2048 nt lds
    v_accvgpr_write_b32 a59, v67
    v_pk_mul_f32 v[236:237], v[236:237], s[58:59]
    v_pk_mul_f32 v[238:239], v[238:239], s[58:59]
    v_pk_mul_f32 v[252:253], v[252:253], s[58:59]
    buffer_load_dwordx4 v23, s[28:31], s49 offen offset:3072 nt lds
    v_pk_mul_f32 v[254:255], v[254:255], s[58:59]
    v_cvt_pk_bf16_f32 v68, v236, v237
    v_cvt_pk_bf16_f32 v69, v238, v239
    v_cvt_pk_bf16_f32 v70, v252, v253
    v_cvt_pk_bf16_f32 v71, v254, v255
    v_accvgpr_write_b32 a60, v68
    v_accvgpr_write_b32 a61, v69
    v_accvgpr_write_b32 a62, v70
    v_accvgpr_write_b32 a63, v71
    s_branch L_p2q3
L_p2start:
    s_waitcnt vmcnt(12)
    s_barrier
    ds_read_b128 a[64:67], v8 offset:0
    ds_read_b128 a[68:71], v8 offset:4096
    ds_read_b128 a[72:75], v9 offset:0
    ds_read_b128 a[76:79], v9 offset:4096
    ds_read_b128 a[80:83], v10 offset:0
    ds_read_b128 a[84:87], v10 offset:4096
    ds_read_b128 a[88:91], v11 offset:0
    ds_read_b128 a[92:95], v11 offset:4096
    ds_read_b64_tr_b16 a[96:97], v12 offset:8192
    ds_read_b64_tr_b16 a[98:99], v12 offset:12288
    ds_read_b64_tr_b16 a[100:101], v13 offset:8192
    ds_read_b64_tr_b16 a[102:103], v13 offset:12288
    ds_read_b64_tr_b16 a[104:105], v14 offset:8192
    ds_read_b64_tr_b16 a[106:107], v14 offset:12288
    ds_read_b64_tr_b16 a[108:109], v15 offset:8192
    ds_read_b64_tr_b16 a[110:111], v15 offset:12288
    ds_read_b64_tr_b16 a[112:113], v16 offset:8192
    ds_read_b64_tr_b16 a[114:115], v16 offset:12288
    ds_read_b64_tr_b16 a[116:117], v17 offset:8192
    ds_read_b64_tr_b16 a[118:119], v17 offset:12288
    ds_read_b64_tr_b16 a[120:121], v18 offset:8192
    ds_read_b64_tr_b16 a[122:123], v18 offset:12288
    ds_read_b64_tr_b16 a[124:125], v19 offset:8192
    ds_read_b64_tr_b16 a[126:127], v19 offset:12288
    s_waitcnt lgkmcnt(0)
    v_mfma_f32_16x16x32_bf16 v[32:35], a[64:67], a[0:3], 0
    v_mfma_f32_16x16x32_bf16 v[36:39], a[68:71], a[0:3], 0
    v_mfma_f32_16x16x32_bf16 v[32:35], a[72:75], a[4:7], v[32:35]
    v_mfma_f32_16x16x32_bf16 v[36:39], a[76:79], a[4:7], v[36:39]
    v_mfma_f32_16x16x32_bf16 v[32:35], a[80:83], a[8:11], v[32:35]
    v_mfma_f32_16x16x32_bf16 v[36:39], a[84:87], a[8:11], v[36:39]
    v_mfma_f32_16x16x32_bf16 v[32:35], a[88:91], a[12:15], v[32:35]
    v_mfma_f32_16x16x32_bf16 v[36:39], a[92:95], a[12:15], v[36:39]
    v_mfma_f32_16x16x32_bf16 v[40:43], a[64:67], a[16:19], 0
    v_mfma_f32_16x16x32_bf16 v[44:47], a[68:71], a[16:19], 0
    v_mfma_f32_16x16x32_bf16 v[40:43], a[72:75], a[20:23], v[40:43]
    v_mfma_f32_16x16x32_bf16 v[44:47], a[76:79], a[20:23], v[44:47]
    v_mfma_f32_16x16x32_bf16 v[40:43], a[80:83], a[24:27], v[40:43]
    v_mfma_f32_16x16x32_bf16 v[44:47], a[84:87], a[24:27], v[44:47]
    v_mfma_f32_16x16x32_bf16 v[40:43], a[88:91], a[28:31], v[40:43]
    v_mfma_f32_16x16x32_bf16 v[44:47], a[92:95], a[28:31], v[44:47]
    v_mfma_f32_16x16x32_bf16 v[48:51], a[64:67], a[32:35], 0
    v_mfma_f32_16x16x32_bf16 v[52:55], a[68:71], a[32:35], 0
    v_mfma_f32_16x16x32_bf16 v[48:51], a[72:75], a[36:39], v[48:51]
    v_mfma_f32_16x16x32_bf16 v[52:55], a[76:79], a[36:39], v[52:55]
    v_mfma_f32_16x16x32_bf16 v[48:51], a[80:83], a[40:43], v[48:51]
    v_mfma_f32_16x16x32_bf16 v[52:55], a[84:87], a[40:43], v[52:55]
    v_mfma_f32_16x16x32_bf16 v[48:51], a[88:91], a[44:47], v[48:51]
    v_mfma_f32_16x16x32_bf16 v[52:55], a[92:95], a[44:47], v[52:55]
L_p2q3:
    s_nop 1
    v_mfma_f32_16x16x32_bf16 v[56:59], a[64:67], a[48:51], 0
    ds_read_b128 a[64:67], v8 offset:8192
    v_mfma_f32_16x16x32_bf16 v[136:139], a[188:191], a[188:191], 0
    v_mfma_f32_16x16x32_bf16 v[152:155], a[188:191], a[188:191], 0
    v_mfma_f32_16x16x32_bf16 v[60:63], a[68:71], a[48:51], 0
    ds_read_b128 a[68:71], v8 offset:12288
    v_mfma_f32_16x16x32_bf16 v[168:171], a[188:191], a[188:191], 0
    v_mfma_f32_16x16x32_bf16 v[184:187], a[188:191], a[188:191], 0
    v_mfma_f32_16x16x32_bf16 v[56:59], a[72:75], a[52:55], v[56:59]
    ds_read_b128 a[72:75], v9 offset:8192
    v_mfma_f32_16x16x32_bf16 v[200:203], a[188:191], a[188:191], 0
    v_mfma_f32_16x16x32_bf16 v[216:219], a[188:191], a[188:191], 0
    v_mfma_f32_16x16x32_bf16 v[60:63], a[76:79], a[52:55], v[60:63]
    ds_read_b128 a[76:79], v9 offset:12288
    v_mfma_f32_16x16x32_bf16 v[232:235], a[188:191], a[188:191], 0
    v_mfma_f32_16x16x32_bf16 v[248:251], a[188:191], a[188:191], 0
    v_mfma_f32_16x16x32_bf16 v[56:59], a[80:83], a[56:59], v[56:59]
    ds_read_b128 a[80:83], v10 offset:8192
    v_mfma_f32_16x16x32_bf16 v[104:107], a[188:191], a[188:191], 0
    v_mfma_f32_16x16x32_bf16 v[140:143], a[188:191], a[188:191], 0
    v_mfma_f32_16x16x32_bf16 v[60:63], a[84:87], a[56:59], v[60:63]
    ds_read_b128 a[84:87], v10 offset:12288
    v_mfma_f32_16x16x32_bf16 v[156:159], a[188:191], a[188:191], 0
    v_mfma_f32_16x16x32_bf16 v[172:175], a[188:191], a[188:191], 0
    v_mfma_f32_16x16x32_bf16 v[56:59], a[88:91], a[60:63], v[56:59]
    ds_read_b128 a[88:91], v11 offset:8192
    v_mfma_f32_16x16x32_bf16 v[188:191], a[188:191], a[188:191], 0
    v_mfma_f32_16x16x32_bf16 v[204:207], a[188:191], a[188:191], 0
    v_mfma_f32_16x16x32_bf16 v[60:63], a[92:95], a[60:63], v[60:63]
    ds_read_b128 a[92:95], v11 offset:12288
    v_mfma_f32_16x16x32_bf16 v[220:223], a[188:191], a[188:191], 0
    v_mfma_f32_16x16x32_bf16 v[236:239], a[188:191], a[188:191], 0
    v_mfma_f32_16x16x32_bf16 v[252:255], a[188:191], a[188:191], 0
    v_mfma_f32_16x16x32_bf16 v[108:111], a[188:191], a[188:191], 0
    v_max3_f32 v2, v32, v33, v26
    v_max3_f32 v2, v2, v34, v35
    v_max3_f32 v2, v2, v36, v37
    v_max3_f32 v2, v2, v38, v39
    v_max3_f32 v3, v40, v41, v27
    v_max3_f32 v3, v3, v42, v43
    v_max3_f32 v3, v3, v44, v45
    v_max3_f32 v3, v3, v46, v47
    v_max3_f32 v4, v48, v49, v28
    v_max3_f32 v4, v4, v50, v51
    v_max3_f32 v4, v4, v52, v53
    v_max3_f32 v4, v4, v54, v55
    v_max3_f32 v5, v56, v57, v29
    v_max3_f32 v5, v5, v58, v59
    v_max3_f32 v5, v5, v60, v61
    v_max3_f32 v5, v5, v62, v63
    v_mov_b32 v64, v2
    v_mov_b32 v65, v3
    v_mov_b32 v66, v4
    v_mov_b32 v67, v5
    s_nop 0
    v_permlane32_swap_b32 v2, v64
    v_permlane32_swap_b32 v3, v65
    v_permlane32_swap_b32 v4, v66
    v_permlane32_swap_b32 v5, v67
    v_max_f32 v2, v2, v64
    v_max_f32 v3, v3, v65
    v_max_f32 v4, v4, v66
    v_max_f32 v5, v5, v67
    v_mov_b32 v64, v2
    v_mov_b32 v65, v3
    v_mov_b32 v66, v4
    v_mov_b32 v67, v5
    s_nop 0
    v_permlane16_swap_b32 v2, v64
    v_permlane16_swap_b32 v3, v65
    v_permlane16_swap_b32 v4, v66
    v_permlane16_swap_b32 v5, v67
    v_max_f32 v2, v2, v64
    v_max_f32 v3, v3, v65
    v_max_f32 v4, v4, v66
    v_max_f32 v5, v5, v67
    v_sub_f32 v64, 0, v2
    v_sub_f32 v68, 0, v3
    v_sub_f32 v72, 0, v4
    v_sub_f32 v76, 0, v5
    v_add_f32 v32, v32, v64
    v_add_f32 v33, v33, v64
    v_add_f32 v34, v34, v64
    v_add_f32 v35, v35, v64
    v_add_f32 v36, v36, v64
    v_add_f32 v37, v37, v64
    v_add_f32 v38, v38, v64
    v_add_f32 v39, v39, v64
    v_exp_f32 v32, v32
    v_exp_f32 v33, v33
    v_exp_f32 v34, v34
    v_exp_f32 v35, v35
    v_exp_f32 v36, v36
    v_exp_f32 v37, v37
    v_exp_f32 v38, v38
    v_exp_f32 v39, v39
    v_add_f32 v40, v40, v68
    v_add_f32 v41, v41, v68
    v_add_f32 v42, v42, v68
    v_add_f32 v43, v43, v68
    v_add_f32 v44, v44, v68
    v_add_f32 v45, v45, v68
    v_add_f32 v46, v46, v68
    v_add_f32 v47, v47, v68
    v_cvt_pk_bf16_f32 v80, v32, v33
    v_cvt_pk_bf16_f32 v81, v34, v35
    v_cvt_pk_bf16_f32 v82, v36, v37
    v_cvt_pk_bf16_f32 v83, v38, v39
    s_waitcnt lgkmcnt(0)
    v_exp_f32 v40, v40
    v_mfma_f32_16x16x32_bf16 v[128:131], a[96:99], v[80:83], 0
    v_exp_f32 v41, v41
    v_exp_f32 v42, v42
    v_exp_f32 v43, v43
    v_mfma_f32_16x16x32_bf16 v[144:147], a[100:103], v[80:83], 0
    v_exp_f32 v44, v44
    v_exp_f32 v45, v45
    v_exp_f32 v46, v46
    v_mfma_f32_16x16x32_bf16 v[160:163], a[104:107], v[80:83], 0
    v_exp_f32 v47, v47
    v_add_f32 v48, v48, v72
    v_add_f32 v49, v49, v72
    v_mfma_f32_16x16x32_bf16 v[176:179], a[108:111], v[80:83], 0
    v_add_f32 v50, v50, v72
    v_add_f32 v51, v51, v72
    v_add_f32 v52, v52, v72
    v_mfma_f32_16x16x32_bf16 v[192:195], a[112:115], v[80:83], 0
    v_add_f32 v53, v53, v72
    v_add_f32 v54, v54, v72
    v_add_f32 v55, v55, v72
    v_mfma_f32_16x16x32_bf16 v[208:211], a[116:119], v[80:83], 0
    v_cvt_pk_bf16_f32 v84, v40, v41
    v_cvt_pk_bf16_f32 v85, v42, v43
    v_cvt_pk_bf16_f32 v86, v44, v45
    v_mfma_f32_16x16x32_bf16 v[224:227], a[120:123], v[80:83], 0
    v_cvt_pk_bf16_f32 v87, v46, v47
    v_add_f32 v56, v56, v76
    v_add_f32 v57, v57, v76
    v_mfma_f32_16x16x32_bf16 v[240:243], a[124:127], v[80:83], 0
    v_add_f32 v58, v58, v76
    v_add_f32 v59, v59, v76
    v_add_f32 v60, v60, v76
    v_mfma_f32_16x16x32_bf16 v[96:99], a[252:255], v[80:83], 0
    v_add_f32 v61, v61, v76
    v_add_f32 v62, v62, v76
    v_add_f32 v63, v63, v76
    v_exp_f32 v48, v48
    v_exp_f32 v49, v49
    v_mfma_f32_16x16x32_bf16 v[132:135], a[96:99], v[84:87], 0
    v_exp_f32 v50, v50
    v_exp_f32 v51, v51
    v_exp_f32 v52, v52
    v_mfma_f32_16x16x32_bf16 v[148:151], a[100:103], v[84:87], 0
    v_exp_f32 v53, v53
    v_exp_f32 v54, v54
    v_exp_f32 v55, v55
    v_mfma_f32_16x16x32_bf16 v[164:167], a[104:107], v[84:87], 0
    v_exp_f32 v56, v56
    v_exp_f32 v57, v57
    v_exp_f32 v58, v58
    v_mfma_f32_16x16x32_bf16 v[180:183], a[108:111], v[84:87], 0
    v_mov_b32 v65, v64
    v_mov_b32 v66, v64
    v_cvt_pk_bf16_f32 v88, v48, v49
    v_mfma_f32_16x16x32_bf16 v[196:199], a[112:115], v[84:87], 0
    v_cvt_pk_bf16_f32 v89, v50, v51
    v_cvt_pk_bf16_f32 v90, v52, v53
    v_cvt_pk_bf16_f32 v91, v54, v55
    v_mfma_f32_16x16x32_bf16 v[212:215], a[116:119], v[84:87], 0
    v_cvt_pk_bf16_f32 v92, v56, v57
    v_mov_b32 v67, v64
    v_mov_b32 v69, v68
    v_mfma_f32_16x16x32_bf16 v[228:231], a[120:123], v[84:87], 0
    v_mov_b32 v70, v68
    v_mov_b32 v71, v68
    v_mov_b32 v73, v72
    v_mfma_f32_16x16x32_bf16 v[244:247], a[124:127], v[84:87], 0
    v_mov_b32 v74, v72
    v_mov_b32 v75, v72
    v_mov_b32 v77, v76
    v_mfma_f32_16x16x32_bf16 v[100:103], a[252:255], v[84:87], 0
    v_mov_b32 v78, v76
    v_mov_b32 v79, v76
    s_mov_b32 s52, 0x4000
    s_add_u32 s51, s48, 49152
    s_add_u32 s49, s70, 49152
    s_and_b32 s49, s49, 0x3ffff
    s_add_u32 s50, s70, 40960
    s_and_b32 s50, s50, 0x3ffff
    s_mov_b32 s53, 0
.p2align 3
L_p2:
    v_mfma_f32_16x16x32_bf16 v[32:35], a[64:67], a[0:3], v[64:67]
    s_waitcnt vmcnt(8)
    s_barrier
    v_mfma_f32_16x16x32_bf16 v[36:39], a[68:71], a[0:3], v[64:67]
    v_exp_f32 v59, v59
    v_mfma_f32_16x16x32_bf16 v[32:35], a[72:75], a[4:7], v[32:35]
    v_cvt_pk_bf16_f32 v93, v58, v59
    v_xor_b32 v12, s52, v12
    v_mfma_f32_16x16x32_bf16 v[36:39], a[76:79], a[4:7], v[36:39]
    v_exp_f32 v60, v60
    v_mfma_f32_16x16x32_bf16 v[32:35], a[80:83], a[8:11], v[32:35]
    v_xor_b32 v13, s52, v13
    v_xor_b32 v14, s52, v14
    v_mfma_f32_16x16x32_bf16 v[36:39], a[84:87], a[8:11], v[36:39]
    v_exp_f32 v61, v61
    v_mfma_f32_16x16x32_bf16 v[32:35], a[88:91], a[12:15], v[32:35]
    v_cvt_pk_bf16_f32 v94, v60, v61
    v_xor_b32 v15, s52, v15
    v_mfma_f32_16x16x32_bf16 v[36:39], a[92:95], a[12:15], v[36:39]
    v_exp_f32 v62, v62
    v_mfma_f32_16x16x32_bf16 v[136:139], a[96:99], v[88:91], v[136:139]
    v_xor_b32 v16, s52, v16
    v_xor_b32 v17, s52, v17
    v_mfma_f32_16x16x32_bf16 v[152:155], a[100:103], v[88:91], v[152:155]
    v_exp_f32 v63, v63
    v_mfma_f32_16x16x32_bf16 v[168:171], a[104:107], v[88:91], v[168:171]
    v_cvt_pk_bf16_f32 v95, v62, v63
    v_xor_b32 v18, s52, v18
    v_mfma_f32_16x16x32_bf16 v[184:187], a[108:111], v[88:91], v[184:187]
    v_exp_f32 v32, v32
    v_mfma_f32_16x16x32_bf16 v[200:203], a[112:115], v[88:91], v[200:203]
    s_mov_b32 m0, s51
    v_mfma_f32_16x16x32_bf16 v[216:219], a[116:119], v[88:91], v[216:219]
    v_exp_f32 v33, v33
    v_mfma_f32_16x16x32_bf16 v[232:235], a[120:123], v[88:91], v[232:235]
    v_cvt_pk_bf16_f32 v80, v32, v33
    v_xor_b32 v19, s52, v19
    v_mfma_f32_16x16x32_bf16 v[248:251], a[124:127], v[88:91], v[248:251]
    v_exp_f32 v34, v34
    v_mfma_f32_16x16x32_bf16 v[104:107], a[252:255], v[88:91], v[104:107]
    buffer_load_dwordx4 v20, s[28:31], s49 offen offset:0 nt lds
    v_mfma_f32_16x16x32_bf16 v[40:43], a[64:67], a[16:19], v[68:71]
    v_exp_f32 v35, v35
    v_mfma_f32_16x16x32_bf16 v[44:47], a[68:71], a[16:19], v[68:71]
    v_cvt_pk_bf16_f32 v81, v34, v35
    v_xor_b32 v8, s52, v8
    v_mfma_f32_16x16x32_bf16 v[40:43], a[72:75], a[20:23], v[40:43]
    v_exp_f32 v36, v36
    v_mfma_f32_16x16x32_bf16 v[44:47], a[76:79], a[20:23], v[44:47]
    v_xor_b32 v9, s52, v9
    v_xor_b32 v10, s52, v10
    v_mfma_f32_16x16x32_bf16 v[40:43], a[80:83], a[24:27], v[40:43]
    v_exp_f32 v37, v37
    v_mfma_f32_16x16x32_bf16 v[44:47], a[84:87], a[24:27], v[44:47]
    v_cvt_pk_bf16_f32 v82, v36, v37
    v_xor_b32 v11, s52, v11
    v_mfma_f32_16x16x32_bf16 v[40:43], a[88:91], a[28:31], v[40:43]
    v_exp_f32 v38, v38
    v_mfma_f32_16x16x32_bf16 v[44:47], a[92:95], a[28:31], v[44:47]
    buffer_load_dwordx4 v21, s[28:31], s49 offen offset:1024 nt lds
    v_mfma_f32_16x16x32_bf16 v[140:143], a[96:99], v[92:95], v[140:143]
    v_exp_f32 v39, v39
    v_mfma_f32_16x16x32_bf16 v[156:159], a[100:103], v[92:95], v[156:159]
    ds_read_b64_tr_b16 a[96:97], v12 offset:0
    v_cvt_pk_bf16_f32 v83, v38, v39
    v_mfma_f32_16x16x32_bf16 v[172:175], a[104:107], v[92:95], v[172:175]
    ds_read_b64_tr_b16 a[98:99], v12 offset:4096
    ds_read_b64_tr_b16 a[100:101], v13 offset:0
    v_mfma_f32_16x16x32_bf16 v[188:191], a[108:111], v[92:95], v[188:191]
    ds_read_b64_tr_b16 a[102:103], v13 offset:4096
    ds_read_b64_tr_b16 a[104:105], v14 offset:0
    v_mfma_f32_16x16x32_bf16 v[204:207], a[112:115], v[92:95], v[204:207]
    v_exp_f32 v40, v40
    v_mfma_f32_16x16x32_bf16 v[220:223], a[116:119], v[92:95], v[220:223]
    ds_read_b64_tr_b16 a[106:107], v14 offset:4096
    ds_read_b64_tr_b16 a[108:109], v15 offset:0
    v_mfma_f32_16x16x32_bf16 v[236:239], a[120:123], v[92:95], v[236:239]
    v_exp_f32 v41, v41
    v_mfma_f32_16x16x32_bf16 v[252:255], a[124:127], v[92:95], v[252:255]
    ds_read_b64_tr_b16 a[110:111], v15 offset:4096
    v_cvt_pk_bf16_f32 v84, v40, v41
    v_mfma_f32_16x16x32_bf16 v[108:111], a[252:255], v[92:95], v[108:111]
    v_exp_f32 v42, v42
    v_mfma_f32_16x16x32_bf16 v[48:51], a[64:67], a[32:35], v[72:75]
    ds_read_b64_tr_b16 a[112:113], v16 offset:0
    ds_read_b64_tr_b16 a[114:115], v16 offset:4096
    v_mfma_f32_16x16x32_bf16 v[52:55], a[68:71], a[32:35], v[72:75]
    v_exp_f32 v43, v43
    v_mfma_f32_16x16x32_bf16 v[48:51], a[72:75], a[36:39], v[48:51]
    ds_read_b64_tr_b16 a[116:117], v17 offset:0
    v_cvt_pk_bf16_f32 v85, v42, v43
    v_mfma_f32_16x16x32_bf16 v[52:55], a[76:79], a[36:39], v[52:55]
    v_exp_f32 v44, v44
    v_mfma_f32_16x16x32_bf16 v[48:51], a[80:83], a[40:43], v[48:51]
    ds_read_b64_tr_b16 a[118:119], v17 offset:4096
    ds_read_b64_tr_b16 a[120:121], v18 offset:0
    v_mfma_f32_16x16x32_bf16 v[52:55], a[84:87], a[40:43], v[52:55]
    v_exp_f32 v45, v45
    v_mfma_f32_16x16x32_bf16 v[48:51], a[88:91], a[44:47], v[48:51]
    ds_read_b64_tr_b16 a[122:123], v18 offset:4096
    v_cvt_pk_bf16_f32 v86, v44, v45
    v_mfma_f32_16x16x32_bf16 v[52:55], a[92:95], a[44:47], v[52:55]
    v_exp_f32 v46, v46
    v_mfma_f32_16x16x32_bf16 v[56:59], a[64:67], a[48:51], v[76:79]
    ds_read_b64_tr_b16 a[124:125], v19 offset:0
    ds_read_b64_tr_b16 a[126:127], v19 offset:4096
    v_mfma_f32_16x16x32_bf16 v[60:63], a[68:71], a[48:51], v[76:79]
    v_exp_f32 v47, v47
    v_mfma_f32_16x16x32_bf16 v[56:59], a[72:75], a[52:55], v[56:59]
    ds_read_b128 a[64:67], v8 offset:0
    v_cvt_pk_bf16_f32 v87, v46, v47
    v_mfma_f32_16x16x32_bf16 v[60:63], a[76:79], a[52:55], v[60:63]
    v_exp_f32 v48, v48
    v_mfma_f32_16x16x32_bf16 v[56:59], a[80:83], a[56:59], v[56:59]
    ds_read_b128 a[68:71], v8 offset:4096
    ds_read_b128 a[72:75], v9 offset:0
    v_mfma_f32_16x16x32_bf16 v[60:63], a[84:87], a[56:59], v[60:63]
    v_exp_f32 v49, v49
    v_mfma_f32_16x16x32_bf16 v[56:59], a[88:91], a[60:63], v[56:59]
    v_cvt_pk_bf16_f32 v88, v48, v49
    s_waitcnt lgkmcnt(3)
    v_mfma_f32_16x16x32_bf16 v[60:63], a[92:95], a[60:63], v[60:63]
    v_exp_f32 v50, v50
    v_mfma_f32_16x16x32_bf16 v[128:131], a[96:99], v[80:83], v[128:131]
    ds_read_b128 a[76:79], v9 offset:4096
    ds_read_b128 a[80:83], v10 offset:0
    v_mfma_f32_16x16x32_bf16 v[144:147], a[100:103], v[80:83], v[144:147]
    v_exp_f32 v51, v51
    v_mfma_f32_16x16x32_bf16 v[160:163], a[104:107], v[80:83], v[160:163]
    ds_read_b128 a[84:87], v10 offset:4096
    v_cvt_pk_bf16_f32 v89, v50, v51
    v_mfma_f32_16x16x32_bf16 v[176:179], a[108:111], v[80:83], v[176:179]
    v_exp_f32 v52, v52
    v_mfma_f32_16x16x32_bf16 v[192:195], a[112:115], v[80:83], v[192:195]
    ds_read_b128 a[88:91], v11 offset:0
    ds_read_b128 a[92:95], v11 offset:4096
    v_mfma_f32_16x16x32_bf16 v[208:211], a[116:119], v[80:83], v[208:211]
    v_exp_f32 v53, v53
    v_mfma_f32_16x16x32_bf16 v[224:227], a[120:123], v[80:83], v[224:227]
    v_cvt_pk_bf16_f32 v90, v52, v53
    v_mfma_f32_16x16x32_bf16 v[240:243], a[124:127], v[80:83], v[240:243]
    v_exp_f32 v54, v54
    v_mfma_f32_16x16x32_bf16 v[96:99], a[252:255], v[80:83], v[96:99]
    buffer_load_dwordx4 v22, s[28:31], s49 offen offset:2048 nt lds
    v_mfma_f32_16x16x32_bf16 v[132:135], a[96:99], v[84:87], v[132:135]
    v_exp_f32 v55, v55
    v_mfma_f32_16x16x32_bf16 v[148:151], a[100:103], v[84:87], v[148:151]
    v_cvt_pk_bf16_f32 v91, v54, v55
    v_mfma_f32_16x16x32_bf16 v[164:167], a[104:107], v[84:87], v[164:167]
    s_and_b32 s50, s50, 0x3ffff
    v_mfma_f32_16x16x32_bf16 v[180:183], a[108:111], v[84:87], v[180:183]
    v_mfma_f32_16x16x32_bf16 v[196:199], a[112:115], v[84:87], v[196:199]
    v_exp_f32 v56, v56
    v_mfma_f32_16x16x32_bf16 v[212:215], a[116:119], v[84:87], v[212:215]
    buffer_load_dwordx4 v23, s[28:31], s49 offen offset:3072 nt lds
    s_add_u32 s49, s49, 16384
    v_mfma_f32_16x16x32_bf16 v[228:231], a[120:123], v[84:87], v[228:231]
    v_exp_f32 v57, v57
    v_mfma_f32_16x16x32_bf16 v[244:247], a[124:127], v[84:87], v[244:247]
    v_cvt_pk_bf16_f32 v92, v56, v57
    s_waitcnt lgkmcnt(0)
    v_mfma_f32_16x16x32_bf16 v[100:103], a[252:255], v[84:87], v[100:103]
    v_exp_f32 v58, v58
    v_mfma_f32_16x16x32_bf16 v[32:35], a[64:67], a[0:3], v[64:67]
    s_add_u32 s54, s51, 65536
    v_mfma_f32_16x16x32_bf16 v[36:39], a[68:71], a[0:3], v[64:67]
    v_exp_f32 v59, v59
    v_mfma_f32_16x16x32_bf16 v[32:35], a[72:75], a[4:7], v[32:35]
    v_cvt_pk_bf16_f32 v93, v58, v59
    v_mfma_f32_16x16x32_bf16 v[36:39], a[76:79], a[4:7], v[36:39]
    v_exp_f32 v60, v60
    v_mfma_f32_16x16x32_bf16 v[32:35], a[80:83], a[8:11], v[32:35]
    s_mov_b32 m0, s54
    v_mfma_f32_16x16x32_bf16 v[36:39], a[84:87], a[8:11], v[36:39]
    v_exp_f32 v61, v61
    v_mfma_f32_16x16x32_bf16 v[32:35], a[88:91], a[12:15], v[32:35]
    v_cvt_pk_bf16_f32 v94, v60, v61
    v_mfma_f32_16x16x32_bf16 v[36:39], a[92:95], a[12:15], v[36:39]
    v_exp_f32 v62, v62
    v_mfma_f32_16x16x32_bf16 v[136:139], a[96:99], v[88:91], v[136:139]
    buffer_load_dwordx4 v24, s[32:35], s50 offen offset:0 nt lds
    v_mfma_f32_16x16x32_bf16 v[152:155], a[100:103], v[88:91], v[152:155]
    v_exp_f32 v63, v63
    v_mfma_f32_16x16x32_bf16 v[168:171], a[104:107], v[88:91], v[168:171]
    v_cvt_pk_bf16_f32 v95, v62, v63
    v_mfma_f32_16x16x32_bf16 v[184:187], a[108:111], v[88:91], v[184:187]
    v_exp_f32 v32, v32
    v_mfma_f32_16x16x32_bf16 v[200:203], a[112:115], v[88:91], v[200:203]
    s_and_b32 s49, s49, 0x3ffff
    v_mfma_f32_16x16x32_bf16 v[216:219], a[116:119], v[88:91], v[216:219]
    v_exp_f32 v33, v33
    v_mfma_f32_16x16x32_bf16 v[232:235], a[120:123], v[88:91], v[232:235]
    v_cvt_pk_bf16_f32 v80, v32, v33
    v_mfma_f32_16x16x32_bf16 v[248:251], a[124:127], v[88:91], v[248:251]
    v_exp_f32 v34, v34
    v_mfma_f32_16x16x32_bf16 v[104:107], a[252:255], v[88:91], v[104:107]
    v_mfma_f32_16x16x32_bf16 v[40:43], a[64:67], a[16:19], v[68:71]
    v_exp_f32 v35, v35
    v_mfma_f32_16x16x32_bf16 v[44:47], a[68:71], a[16:19], v[68:71]
    v_cvt_pk_bf16_f32 v81, v34, v35
    v_mfma_f32_16x16x32_bf16 v[40:43], a[72:75], a[20:23], v[40:43]
    v_exp_f32 v36, v36
    v_mfma_f32_16x16x32_bf16 v[44:47], a[76:79], a[20:23], v[44:47]
    buffer_load_dwordx4 v25, s[32:35], s50 offen offset:1024 nt lds
    v_mfma_f32_16x16x32_bf16 v[40:43], a[80:83], a[24:27], v[40:43]
    v_exp_f32 v37, v37
    v_mfma_f32_16x16x32_bf16 v[44:47], a[84:87], a[24:27], v[44:47]
    v_cvt_pk_bf16_f32 v82, v36, v37
    v_mfma_f32_16x16x32_bf16 v[40:43], a[88:91], a[28:31], v[40:43]
    v_exp_f32 v38, v38
    v_mfma_f32_16x16x32_bf16 v[44:47], a[92:95], a[28:31], v[44:47]
    v_mfma_f32_16x16x32_bf16 v[140:143], a[96:99], v[92:95], v[140:143]
    v_exp_f32 v39, v39
    v_mfma_f32_16x16x32_bf16 v[156:159], a[100:103], v[92:95], v[156:159]
    ds_read_b64_tr_b16 a[96:97], v12 offset:8192
    v_cvt_pk_bf16_f32 v83, v38, v39
    v_mfma_f32_16x16x32_bf16 v[172:175], a[104:107], v[92:95], v[172:175]
    ds_read_b64_tr_b16 a[98:99], v12 offset:12288
    ds_read_b64_tr_b16 a[100:101], v13 offset:8192
    v_mfma_f32_16x16x32_bf16 v[188:191], a[108:111], v[92:95], v[188:191]
    ds_read_b64_tr_b16 a[102:103], v13 offset:12288
    ds_read_b64_tr_b16 a[104:105], v14 offset:8192
    v_mfma_f32_16x16x32_bf16 v[204:207], a[112:115], v[92:95], v[204:207]
    v_exp_f32 v40, v40
    v_mfma_f32_16x16x32_bf16 v[220:223], a[116:119], v[92:95], v[220:223]
    ds_read_b64_tr_b16 a[106:107], v14 offset:12288
    ds_read_b64_tr_b16 a[108:109], v15 offset:8192
    v_mfma_f32_16x16x32_bf16 v[236:239], a[120:123], v[92:95], v[236:239]
    v_exp_f32 v41, v41
    v_mfma_f32_16x16x32_bf16 v[252:255], a[124:127], v[92:95], v[252:255]
    ds_read_b64_tr_b16 a[110:111], v15 offset:12288
    v_cvt_pk_bf16_f32 v84, v40, v41
    v_mfma_f32_16x16x32_bf16 v[108:111], a[252:255], v[92:95], v[108:111]
    v_exp_f32 v42, v42
    v_mfma_f32_16x16x32_bf16 v[48:51], a[64:67], a[32:35], v[72:75]
    ds_read_b64_tr_b16 a[112:113], v16 offset:8192
    ds_read_b64_tr_b16 a[114:115], v16 offset:12288
    v_mfma_f32_16x16x32_bf16 v[52:55], a[68:71], a[32:35], v[72:75]
    v_exp_f32 v43, v43
    v_mfma_f32_16x16x32_bf16 v[48:51], a[72:75], a[36:39], v[48:51]
    ds_read_b64_tr_b16 a[116:117], v17 offset:8192
    v_cvt_pk_bf16_f32 v85, v42, v43
    v_mfma_f32_16x16x32_bf16 v[52:55], a[76:79], a[36:39], v[52:55]
    v_exp_f32 v44, v44
    v_mfma_f32_16x16x32_bf16 v[48:51], a[80:83], a[40:43], v[48:51]
    ds_read_b64_tr_b16 a[118:119], v17 offset:12288
    ds_read_b64_tr_b16 a[120:121], v18 offset:8192
    v_mfma_f32_16x16x32_bf16 v[52:55], a[84:87], a[40:43], v[52:55]
    v_exp_f32 v45, v45
    v_mfma_f32_16x16x32_bf16 v[48:51], a[88:91], a[44:47], v[48:51]
    ds_read_b64_tr_b16 a[122:123], v18 offset:12288
    v_cvt_pk_bf16_f32 v86, v44, v45
    v_mfma_f32_16x16x32_bf16 v[52:55], a[92:95], a[44:47], v[52:55]
    v_exp_f32 v46, v46
    v_mfma_f32_16x16x32_bf16 v[56:59], a[64:67], a[48:51], v[76:79]
    ds_read_b64_tr_b16 a[124:125], v19 offset:8192
    ds_read_b64_tr_b16 a[126:127], v19 offset:12288
    v_mfma_f32_16x16x32_bf16 v[60:63], a[68:71], a[48:51], v[76:79]
    v_exp_f32 v47, v47
    v_mfma_f32_16x16x32_bf16 v[56:59], a[72:75], a[52:55], v[56:59]
    ds_read_b128 a[64:67], v8 offset:8192
    v_cvt_pk_bf16_f32 v87, v46, v47
    v_mfma_f32_16x16x32_bf16 v[60:63], a[76:79], a[52:55], v[60:63]
    v_exp_f32 v48, v48
    v_mfma_f32_16x16x32_bf16 v[56:59], a[80:83], a[56:59], v[56:59]
    ds_read_b128 a[68:71], v8 offset:12288
    ds_read_b128 a[72:75], v9 offset:8192
    v_mfma_f32_16x16x32_bf16 v[60:63], a[84:87], a[56:59], v[60:63]
    v_exp_f32 v49, v49
    v_mfma_f32_16x16x32_bf16 v[56:59], a[88:91], a[60:63], v[56:59]
    v_cvt_pk_bf16_f32 v88, v48, v49
    s_waitcnt lgkmcnt(3)
    v_mfma_f32_16x16x32_bf16 v[60:63], a[92:95], a[60:63], v[60:63]
    v_exp_f32 v50, v50
    v_mfma_f32_16x16x32_bf16 v[128:131], a[96:99], v[80:83], v[128:131]
    ds_read_b128 a[76:79], v9 offset:12288
    ds_read_b128 a[80:83], v10 offset:8192
    v_mfma_f32_16x16x32_bf16 v[144:147], a[100:103], v[80:83], v[144:147]
    v_exp_f32 v51, v51
    v_mfma_f32_16x16x32_bf16 v[160:163], a[104:107], v[80:83], v[160:163]
    ds_read_b128 a[84:87], v10 offset:12288
    v_cvt_pk_bf16_f32 v89, v50, v51
    v_mfma_f32_16x16x32_bf16 v[176:179], a[108:111], v[80:83], v[176:179]
    v_exp_f32 v52, v52
    v_mfma_f32_16x16x32_bf16 v[192:195], a[112:115], v[80:83], v[192:195]
    ds_read_b128 a[88:91], v11 offset:8192
    ds_read_b128 a[92:95], v11 offset:12288
    v_mfma_f32_16x16x32_bf16 v[208:211], a[116:119], v[80:83], v[208:211]
    v_exp_f32 v53, v53
    v_mfma_f32_16x16x32_bf16 v[224:227], a[120:123], v[80:83], v[224:227]
    v_cvt_pk_bf16_f32 v90, v52, v53
    v_mfma_f32_16x16x32_bf16 v[240:243], a[124:127], v[80:83], v[240:243]
    v_exp_f32 v54, v54
    v_mfma_f32_16x16x32_bf16 v[96:99], a[252:255], v[80:83], v[96:99]
    buffer_load_dwordx4 v24, s[32:35], s50 offen offset:2048 nt lds
    v_mfma_f32_16x16x32_bf16 v[132:135], a[96:99], v[84:87], v[132:135]
    v_exp_f32 v55, v55
    v_mfma_f32_16x16x32_bf16 v[148:151], a[100:103], v[84:87], v[148:151]
    v_cvt_pk_bf16_f32 v91, v54, v55
    v_mfma_f32_16x16x32_bf16 v[164:167], a[104:107], v[84:87], v[164:167]
    s_xor_b32 s52, s52, 0x8000
    v_mfma_f32_16x16x32_bf16 v[180:183], a[108:111], v[84:87], v[180:183]
    s_xor_b32 s51, s51, s52
    s_add_u32 s53, s53, 1
    v_mfma_f32_16x16x32_bf16 v[196:199], a[112:115], v[84:87], v[196:199]
    v_exp_f32 v56, v56
    v_mfma_f32_16x16x32_bf16 v[212:215], a[116:119], v[84:87], v[212:215]
    buffer_load_dwordx4 v25, s[32:35], s50 offen offset:3072 nt lds
    s_add_u32 s50, s50, 16384
    v_mfma_f32_16x16x32_bf16 v[228:231], a[120:123], v[84:87], v[228:231]
    v_exp_f32 v57, v57
    v_mfma_f32_16x16x32_bf16 v[244:247], a[124:127], v[84:87], v[244:247]
    v_cvt_pk_bf16_f32 v92, v56, v57
    s_waitcnt lgkmcnt(0)
    v_mfma_f32_16x16x32_bf16 v[100:103], a[252:255], v[84:87], v[100:103]
    v_exp_f32 v58, v58
    s_cmp_lt_u32 s53, 12
    s_cbranch_scc1 L_p2
    s_cmp_eq_u32 s3, 3
    s_cselect_b64 vcc, -1, 0
    v_mfma_f32_16x16x32_bf16 v[32:35], a[64:67], a[0:3], v[64:67]
    s_waitcnt vmcnt(8)
    s_barrier
    v_mfma_f32_16x16x32_bf16 v[36:39], a[68:71], a[0:3], v[64:67]
    v_exp_f32 v59, v59
    v_mfma_f32_16x16x32_bf16 v[32:35], a[72:75], a[4:7], v[32:35]
    v_accvgpr_read_b32 v112, a240
    v_cvt_pk_bf16_f32 v93, v58, v59
    v_xor_b32 v12, s52, v12
    v_mfma_f32_16x16x32_bf16 v[36:39], a[76:79], a[4:7], v[36:39]
    v_exp_f32 v60, v60
    v_mfma_f32_16x16x32_bf16 v[32:35], a[80:83], a[8:11], v[32:35]
    s_mov_b32 m0, s51
    v_xor_b32 v13, s52, v13
    v_xor_b32 v14, s52, v14
    v_mfma_f32_16x16x32_bf16 v[36:39], a[84:87], a[8:11], v[36:39]
    v_exp_f32 v61, v61
    v_mfma_f32_16x16x32_bf16 v[32:35], a[88:91], a[12:15], v[32:35]
    v_accvgpr_read_b32 v113, a241
    v_cvt_pk_bf16_f32 v94, v60, v61
    v_xor_b32 v15, s52, v15
    v_mfma_f32_16x16x32_bf16 v[36:39], a[92:95], a[12:15], v[36:39]
    v_exp_f32 v62, v62
    v_mfma_f32_16x16x32_bf16 v[136:139], a[96:99], v[88:91], v[136:139]
    v_xor_b32 v16, s52, v16
    v_xor_b32 v17, s52, v17
    v_mfma_f32_16x16x32_bf16 v[152:155], a[100:103], v[88:91], v[152:155]
    v_exp_f32 v63, v63
    v_mfma_f32_16x16x32_bf16 v[168:171], a[104:107], v[88:91], v[168:171]
    v_cvt_pk_bf16_f32 v95, v62, v63
    v_xor_b32 v18, s52, v18
    v_mfma_f32_16x16x32_bf16 v[184:187], a[108:111], v[88:91], v[184:187]
    v_exp_f32 v32, v32
    v_mfma_f32_16x16x32_bf16 v[200:203], a[112:115], v[88:91], v[200:203]
    buffer_load_dwordx4 v20, s[28:31], s49 offen offset:0 nt lds
    v_accvgpr_read_b32 v114, a242
    v_mfma_f32_16x16x32_bf16 v[216:219], a[116:119], v[88:91], v[216:219]
    v_exp_f32 v33, v33
    v_mfma_f32_16x16x32_bf16 v[232:235], a[120:123], v[88:91], v[232:235]
    v_cvt_pk_bf16_f32 v80, v32, v33
    v_xor_b32 v19, s52, v19
    v_mfma_f32_16x16x32_bf16 v[248:251], a[124:127], v[88:91], v[248:251]
    v_exp_f32 v34, v34
    v_mfma_f32_16x16x32_bf16 v[104:107], a[252:255], v[88:91], v[104:107]
    buffer_load_dwordx4 v21, s[28:31], s49 offen offset:1024 nt lds
    v_accvgpr_read_b32 v115, a243
    v_mfma_f32_16x16x32_bf16 v[40:43], a[64:67], a[16:19], v[68:71]
    v_exp_f32 v35, v35
    v_mfma_f32_16x16x32_bf16 v[44:47], a[68:71], a[16:19], v[68:71]
    v_cvt_pk_bf16_f32 v81, v34, v35
    v_xor_b32 v8, s52, v8
    v_mfma_f32_16x16x32_bf16 v[40:43], a[72:75], a[20:23], v[40:43]
    v_exp_f32 v36, v36
    v_mfma_f32_16x16x32_bf16 v[44:47], a[76:79], a[20:23], v[44:47]
    v_xor_b32 v9, s52, v9
    v_xor_b32 v10, s52, v10
    v_mfma_f32_16x16x32_bf16 v[40:43], a[80:83], a[24:27], v[40:43]
    v_exp_f32 v37, v37
    v_mfma_f32_16x16x32_bf16 v[44:47], a[84:87], a[24:27], v[44:47]
    v_cvt_pk_bf16_f32 v82, v36, v37
    v_xor_b32 v11, s52, v11
    v_mfma_f32_16x16x32_bf16 v[40:43], a[88:91], a[28:31], v[40:43]
    v_exp_f32 v38, v38
    v_mfma_f32_16x16x32_bf16 v[44:47], a[92:95], a[28:31], v[44:47]
    buffer_load_dwordx4 v22, s[28:31], s49 offen offset:2048 nt lds
    v_mfma_f32_16x16x32_bf16 v[140:143], a[96:99], v[92:95], v[140:143]
    v_exp_f32 v39, v39
    v_mfma_f32_16x16x32_bf16 v[156:159], a[100:103], v[92:95], v[156:159]
    ds_read_b64_tr_b16 a[96:97], v12 offset:0
    v_cvt_pk_bf16_f32 v83, v38, v39
    v_mfma_f32_16x16x32_bf16 v[172:175], a[104:107], v[92:95], v[172:175]
    ds_read_b64_tr_b16 a[98:99], v12 offset:4096
    ds_read_b64_tr_b16 a[100:101], v13 offset:0
    v_mfma_f32_16x16x32_bf16 v[188:191], a[108:111], v[92:95], v[188:191]
    ds_read_b64_tr_b16 a[102:103], v13 offset:4096
    ds_read_b64_tr_b16 a[104:105], v14 offset:0
    v_mfma_f32_16x16x32_bf16 v[204:207], a[112:115], v[92:95], v[204:207]
    v_exp_f32 v40, v40
    v_mfma_f32_16x16x32_bf16 v[220:223], a[116:119], v[92:95], v[220:223]
    ds_read_b64_tr_b16 a[106:107], v14 offset:4096
    ds_read_b64_tr_b16 a[108:109], v15 offset:0
    v_mfma_f32_16x16x32_bf16 v[236:239], a[120:123], v[92:95], v[236:239]
    v_exp_f32 v41, v41
    v_mfma_f32_16x16x32_bf16 v[252:255], a[124:127], v[92:95], v[252:255]
    ds_read_b64_tr_b16 a[110:111], v15 offset:4096
    v_cvt_pk_bf16_f32 v84, v40, v41
    v_mfma_f32_16x16x32_bf16 v[108:111], a[252:255], v[92:95], v[108:111]
    v_exp_f32 v42, v42
    v_mfma_f32_16x16x32_bf16 v[48:51], a[64:67], a[32:35], v[72:75]
    ds_read_b64_tr_b16 a[112:113], v16 offset:0
    ds_read_b64_tr_b16 a[114:115], v16 offset:4096
    v_mfma_f32_16x16x32_bf16 v[52:55], a[68:71], a[32:35], v[72:75]
    v_exp_f32 v43, v43
    v_mfma_f32_16x16x32_bf16 v[48:51], a[72:75], a[36:39], v[48:51]
    ds_read_b64_tr_b16 a[116:117], v17 offset:0
    v_cvt_pk_bf16_f32 v85, v42, v43
    v_mfma_f32_16x16x32_bf16 v[52:55], a[76:79], a[36:39], v[52:55]
    v_exp_f32 v44, v44
    v_mfma_f32_16x16x32_bf16 v[48:51], a[80:83], a[40:43], v[48:51]
    ds_read_b64_tr_b16 a[118:119], v17 offset:4096
    ds_read_b64_tr_b16 a[120:121], v18 offset:0
    v_mfma_f32_16x16x32_bf16 v[52:55], a[84:87], a[40:43], v[52:55]
    v_exp_f32 v45, v45
    v_mfma_f32_16x16x32_bf16 v[48:51], a[88:91], a[44:47], v[48:51]
    ds_read_b64_tr_b16 a[122:123], v18 offset:4096
    v_cvt_pk_bf16_f32 v86, v44, v45
    v_mfma_f32_16x16x32_bf16 v[52:55], a[92:95], a[44:47], v[52:55]
    v_exp_f32 v46, v46
    v_mfma_f32_16x16x32_bf16 v[56:59], a[64:67], a[48:51], v[76:79]
    ds_read_b64_tr_b16 a[124:125], v19 offset:0
    ds_read_b64_tr_b16 a[126:127], v19 offset:4096
    v_mfma_f32_16x16x32_bf16 v[60:63], a[68:71], a[48:51], v[76:79]
    v_exp_f32 v47, v47
    v_mfma_f32_16x16x32_bf16 v[56:59], a[72:75], a[52:55], v[56:59]
    ds_read_b128 a[64:67], v8 offset:0
    v_cvt_pk_bf16_f32 v87, v46, v47
    v_mfma_f32_16x16x32_bf16 v[60:63], a[76:79], a[52:55], v[60:63]
    v_exp_f32 v48, v48
    v_mfma_f32_16x16x32_bf16 v[56:59], a[80:83], a[56:59], v[56:59]
    ds_read_b128 a[68:71], v8 offset:4096
    ds_read_b128 a[72:75], v9 offset:0
    v_mfma_f32_16x16x32_bf16 v[60:63], a[84:87], a[56:59], v[60:63]
    v_exp_f32 v49, v49
    v_mfma_f32_16x16x32_bf16 v[56:59], a[88:91], a[60:63], v[56:59]
    v_cvt_pk_bf16_f32 v88, v48, v49
    s_waitcnt lgkmcnt(3)
    v_mfma_f32_16x16x32_bf16 v[60:63], a[92:95], a[60:63], v[60:63]
    v_exp_f32 v50, v50
    v_mfma_f32_16x16x32_bf16 v[128:131], a[96:99], v[80:83], v[128:131]
    ds_read_b128 a[76:79], v9 offset:4096
    ds_read_b128 a[80:83], v10 offset:0
    v_mfma_f32_16x16x32_bf16 v[144:147], a[100:103], v[80:83], v[144:147]
    v_exp_f32 v51, v51
    v_mfma_f32_16x16x32_bf16 v[160:163], a[104:107], v[80:83], v[160:163]
    ds_read_b128 a[84:87], v10 offset:4096
    v_cvt_pk_bf16_f32 v89, v50, v51
    v_mfma_f32_16x16x32_bf16 v[176:179], a[108:111], v[80:83], v[176:179]
    v_exp_f32 v52, v52
    v_mfma_f32_16x16x32_bf16 v[192:195], a[112:115], v[80:83], v[192:195]
    ds_read_b128 a[88:91], v11 offset:0
    ds_read_b128 a[92:95], v11 offset:4096
    v_mfma_f32_16x16x32_bf16 v[208:211], a[116:119], v[80:83], v[208:211]
    v_exp_f32 v53, v53
    v_mfma_f32_16x16x32_bf16 v[224:227], a[120:123], v[80:83], v[224:227]
    buffer_load_dwordx4 v23, s[28:31], s49 offen offset:3072 nt lds
    v_cvt_pk_bf16_f32 v90, v52, v53
    v_mfma_f32_16x16x32_bf16 v[240:243], a[124:127], v[80:83], v[240:243]
    v_exp_f32 v54, v54
    v_mfma_f32_16x16x32_bf16 v[96:99], a[252:255], v[80:83], v[96:99]
    v_accvgpr_read_b32 v116, a244
    v_accvgpr_read_b32 v117, a245
    v_mfma_f32_16x16x32_bf16 v[132:135], a[96:99], v[84:87], v[132:135]
    v_exp_f32 v55, v55
    v_mfma_f32_16x16x32_bf16 v[148:151], a[100:103], v[84:87], v[148:151]
    v_accvgpr_read_b32 v118, a246
    v_cvt_pk_bf16_f32 v91, v54, v55
    v_mfma_f32_16x16x32_bf16 v[164:167], a[104:107], v[84:87], v[164:167]
    v_accvgpr_read_b32 v119, a247
    v_accvgpr_read_b32 v120, a248
    v_mfma_f32_16x16x32_bf16 v[180:183], a[108:111], v[84:87], v[180:183]
    s_and_b32 s50, s50, 0x3ffff
    v_mfma_f32_16x16x32_bf16 v[196:199], a[112:115], v[84:87], v[196:199]
    v_exp_f32 v56, v56
    v_mfma_f32_16x16x32_bf16 v[212:215], a[116:119], v[84:87], v[212:215]
    v_mfma_f32_16x16x32_bf16 v[228:231], a[120:123], v[84:87], v[228:231]
    v_exp_f32 v57, v57
    v_mfma_f32_16x16x32_bf16 v[244:247], a[124:127], v[84:87], v[244:247]
    v_cvt_pk_bf16_f32 v92, v56, v57
    s_waitcnt lgkmcnt(0)
    v_mfma_f32_16x16x32_bf16 v[100:103], a[252:255], v[84:87], v[100:103]
    v_exp_f32 v58, v58
    v_mfma_f32_16x16x32_bf16 v[32:35], a[64:67], a[0:3], v[64:67]
    s_add_u32 m0, s51, 65536
    v_mfma_f32_16x16x32_bf16 v[36:39], a[68:71], a[0:3], v[64:67]
    v_exp_f32 v59, v59
    v_mfma_f32_16x16x32_bf16 v[32:35], a[72:75], a[4:7], v[32:35]
    buffer_load_dwordx4 v24, s[32:35], s50 offen offset:0 nt lds
    v_cvt_pk_bf16_f32 v93, v58, v59
    v_mfma_f32_16x16x32_bf16 v[36:39], a[76:79], a[4:7], v[36:39]
    v_exp_f32 v60, v60
    v_mfma_f32_16x16x32_bf16 v[32:35], a[80:83], a[8:11], v[32:35]
    buffer_load_dwordx4 v25, s[32:35], s50 offen offset:1024 nt lds
    v_mfma_f32_16x16x32_bf16 v[36:39], a[84:87], a[8:11], v[36:39]
    v_exp_f32 v61, v61
    v_mfma_f32_16x16x32_bf16 v[32:35], a[88:91], a[12:15], v[32:35]
    buffer_load_dwordx4 v24, s[32:35], s50 offen offset:2048 nt lds
    v_cvt_pk_bf16_f32 v94, v60, v61
    v_mfma_f32_16x16x32_bf16 v[36:39], a[92:95], a[12:15], v[36:39]
    v_exp_f32 v62, v62
    v_mfma_f32_16x16x32_bf16 v[136:139], a[96:99], v[88:91], v[136:139]
    buffer_load_dwordx4 v25, s[32:35], s50 offen offset:3072 nt lds
    v_mfma_f32_16x16x32_bf16 v[152:155], a[100:103], v[88:91], v[152:155]
    v_exp_f32 v63, v63
    v_mfma_f32_16x16x32_bf16 v[168:171], a[104:107], v[88:91], v[168:171]
    s_add_u32 s50, s50, 16384
    v_cvt_pk_bf16_f32 v95, v62, v63
    v_mfma_f32_16x16x32_bf16 v[184:187], a[108:111], v[88:91], v[184:187]
    v_exp_f32 v32, v32
    v_mfma_f32_16x16x32_bf16 v[200:203], a[112:115], v[88:91], v[200:203]
    s_add_u32 m0, s4, 0
    s_cbranch_vccnz L_wsk1
    buffer_load_dwordx4 v112, s[40:43], s9 offen offset:0 lds
L_wsk1:
    v_mfma_f32_16x16x32_bf16 v[216:219], a[116:119], v[88:91], v[216:219]
    v_exp_f32 v33, v33
    v_mfma_f32_16x16x32_bf16 v[232:235], a[120:123], v[88:91], v[232:235]
    v_cvt_pk_bf16_f32 v80, v32, v33
    v_mfma_f32_16x16x32_bf16 v[248:251], a[124:127], v[88:91], v[248:251]
    v_exp_f32 v34, v34
    v_mfma_f32_16x16x32_bf16 v[104:107], a[252:255], v[88:91], v[104:107]
    s_cbranch_vccnz L_wsk2
    buffer_load_dwordx4 v113, s[40:43], s9 offen offset:1024 lds
L_wsk2:
    v_mfma_f32_16x16x32_bf16 v[40:43], a[64:67], a[16:19], v[68:71]
    v_exp_f32 v35, v35
    v_mfma_f32_16x16x32_bf16 v[44:47], a[68:71], a[16:19], v[68:71]
    v_cvt_pk_bf16_f32 v81, v34, v35
    v_mfma_f32_16x16x32_bf16 v[40:43], a[72:75], a[20:23], v[40:43]
    v_exp_f32 v36, v36
    v_mfma_f32_16x16x32_bf16 v[44:47], a[76:79], a[20:23], v[44:47]
    s_cbranch_vccnz L_wsk3
    buffer_load_dwordx4 v114, s[40:43], s9 offen offset:2048 lds
L_wsk3:
    v_mfma_f32_16x16x32_bf16 v[40:43], a[80:83], a[24:27], v[40:43]
    v_exp_f32 v37, v37
    v_mfma_f32_16x16x32_bf16 v[44:47], a[84:87], a[24:27], v[44:47]
    v_cvt_pk_bf16_f32 v82, v36, v37
    v_mfma_f32_16x16x32_bf16 v[40:43], a[88:91], a[28:31], v[40:43]
    v_exp_f32 v38, v38
    v_mfma_f32_16x16x32_bf16 v[44:47], a[92:95], a[28:31], v[44:47]
    s_cbranch_vccnz L_wsk4
    buffer_load_dwordx4 v115, s[40:43], s9 offen offset:3072 lds
L_wsk4:
    v_mfma_f32_16x16x32_bf16 v[140:143], a[96:99], v[92:95], v[140:143]
    v_exp_f32 v39, v39
    v_mfma_f32_16x16x32_bf16 v[156:159], a[100:103], v[92:95], v[156:159]
    ds_read_b64_tr_b16 a[96:97], v12 offset:8192
    v_cvt_pk_bf16_f32 v83, v38, v39
    v_mfma_f32_16x16x32_bf16 v[172:175], a[104:107], v[92:95], v[172:175]
    ds_read_b64_tr_b16 a[98:99], v12 offset:12288
    ds_read_b64_tr_b16 a[100:101], v13 offset:8192
    v_mfma_f32_16x16x32_bf16 v[188:191], a[108:111], v[92:95], v[188:191]
    ds_read_b64_tr_b16 a[102:103], v13 offset:12288
    ds_read_b64_tr_b16 a[104:105], v14 offset:8192
    v_mfma_f32_16x16x32_bf16 v[204:207], a[112:115], v[92:95], v[204:207]
    v_exp_f32 v40, v40
    v_mfma_f32_16x16x32_bf16 v[220:223], a[116:119], v[92:95], v[220:223]
    ds_read_b64_tr_b16 a[106:107], v14 offset:12288
    ds_read_b64_tr_b16 a[108:109], v15 offset:8192
    v_mfma_f32_16x16x32_bf16 v[236:239], a[120:123], v[92:95], v[236:239]
    v_exp_f32 v41, v41
    v_mfma_f32_16x16x32_bf16 v[252:255], a[124:127], v[92:95], v[252:255]
    ds_read_b64_tr_b16 a[110:111], v15 offset:12288
    v_cvt_pk_bf16_f32 v84, v40, v41
    v_mfma_f32_16x16x32_bf16 v[108:111], a[252:255], v[92:95], v[108:111]
    v_exp_f32 v42, v42
    v_mfma_f32_16x16x32_bf16 v[48:51], a[64:67], a[32:35], v[72:75]
    ds_read_b64_tr_b16 a[112:113], v16 offset:8192
    ds_read_b64_tr_b16 a[114:115], v16 offset:12288
    v_mfma_f32_16x16x32_bf16 v[52:55], a[68:71], a[32:35], v[72:75]
    v_exp_f32 v43, v43
    v_mfma_f32_16x16x32_bf16 v[48:51], a[72:75], a[36:39], v[48:51]
    ds_read_b64_tr_b16 a[116:117], v17 offset:8192
    v_cvt_pk_bf16_f32 v85, v42, v43
    v_mfma_f32_16x16x32_bf16 v[52:55], a[76:79], a[36:39], v[52:55]
    v_exp_f32 v44, v44
    v_mfma_f32_16x16x32_bf16 v[48:51], a[80:83], a[40:43], v[48:51]
    ds_read_b64_tr_b16 a[118:119], v17 offset:12288
    ds_read_b64_tr_b16 a[120:121], v18 offset:8192
    v_mfma_f32_16x16x32_bf16 v[52:55], a[84:87], a[40:43], v[52:55]
    v_exp_f32 v45, v45
    v_mfma_f32_16x16x32_bf16 v[48:51], a[88:91], a[44:47], v[48:51]
    ds_read_b64_tr_b16 a[122:123], v18 offset:12288
    v_cvt_pk_bf16_f32 v86, v44, v45
    v_mfma_f32_16x16x32_bf16 v[52:55], a[92:95], a[44:47], v[52:55]
    v_exp_f32 v46, v46
    v_mfma_f32_16x16x32_bf16 v[56:59], a[64:67], a[48:51], v[76:79]
    ds_read_b64_tr_b16 a[124:125], v19 offset:8192
    ds_read_b64_tr_b16 a[126:127], v19 offset:12288
    v_mfma_f32_16x16x32_bf16 v[60:63], a[68:71], a[48:51], v[76:79]
    v_exp_f32 v47, v47
    v_mfma_f32_16x16x32_bf16 v[56:59], a[72:75], a[52:55], v[56:59]
    ds_read_b128 a[64:67], v8 offset:8192
    s_add_u32 m0, s4, 4096
    s_cbranch_vccnz L_wsk5
    buffer_load_dwordx4 v116, s[40:43], s9 offen offset:0 lds
L_wsk5:
    v_cvt_pk_bf16_f32 v87, v46, v47
    v_mfma_f32_16x16x32_bf16 v[60:63], a[76:79], a[52:55], v[60:63]
    v_exp_f32 v48, v48
    v_mfma_f32_16x16x32_bf16 v[56:59], a[80:83], a[56:59], v[56:59]
    ds_read_b128 a[68:71], v8 offset:12288
    ds_read_b128 a[72:75], v9 offset:8192
    v_mfma_f32_16x16x32_bf16 v[60:63], a[84:87], a[56:59], v[60:63]
    v_exp_f32 v49, v49
    v_mfma_f32_16x16x32_bf16 v[56:59], a[88:91], a[60:63], v[56:59]
    s_cbranch_vccnz L_wsk6
    buffer_load_dwordx4 v117, s[40:43], s9 offen offset:1024 lds
L_wsk6:
    v_cvt_pk_bf16_f32 v88, v48, v49
    s_waitcnt lgkmcnt(3)
    v_mfma_f32_16x16x32_bf16 v[60:63], a[92:95], a[60:63], v[60:63]
    v_exp_f32 v50, v50
    v_mfma_f32_16x16x32_bf16 v[128:131], a[96:99], v[80:83], v[128:131]
    ds_read_b128 a[76:79], v9 offset:12288
    ds_read_b128 a[80:83], v10 offset:8192
    v_mfma_f32_16x16x32_bf16 v[144:147], a[100:103], v[80:83], v[144:147]
    v_exp_f32 v51, v51
    v_mfma_f32_16x16x32_bf16 v[160:163], a[104:107], v[80:83], v[160:163]
    ds_read_b128 a[84:87], v10 offset:12288
    v_cvt_pk_bf16_f32 v89, v50, v51
    v_mfma_f32_16x16x32_bf16 v[176:179], a[108:111], v[80:83], v[176:179]
    v_exp_f32 v52, v52
    v_mfma_f32_16x16x32_bf16 v[192:195], a[112:115], v[80:83], v[192:195]
    ds_read_b128 a[88:91], v11 offset:8192
    ds_read_b128 a[92:95], v11 offset:12288
    v_mfma_f32_16x16x32_bf16 v[208:211], a[116:119], v[80:83], v[208:211]
    v_exp_f32 v53, v53
    v_mfma_f32_16x16x32_bf16 v[224:227], a[120:123], v[80:83], v[224:227]
    s_cbranch_vccnz L_wsk7
    buffer_load_dwordx4 v118, s[40:43], s9 offen offset:2048 lds
L_wsk7:
    v_cvt_pk_bf16_f32 v90, v52, v53
    v_mfma_f32_16x16x32_bf16 v[240:243], a[124:127], v[80:83], v[240:243]
    v_exp_f32 v54, v54
    v_mfma_f32_16x16x32_bf16 v[96:99], a[252:255], v[80:83], v[96:99]
    s_cbranch_vccnz L_wsk8
    buffer_load_dwordx4 v119, s[40:43], s9 offen offset:3072 lds
L_wsk8:
    v_mfma_f32_16x16x32_bf16 v[132:135], a[96:99], v[84:87], v[132:135]
    v_exp_f32 v55, v55
    v_mfma_f32_16x16x32_bf16 v[148:151], a[100:103], v[84:87], v[148:151]
    s_lshl_b32 s54, s64, 5
    v_cvt_pk_bf16_f32 v91, v54, v55
    v_mfma_f32_16x16x32_bf16 v[164:167], a[104:107], v[84:87], v[164:167]
    s_xor_b32 s52, s52, 0x8000
    v_mfma_f32_16x16x32_bf16 v[180:183], a[108:111], v[84:87], v[180:183]
    s_xor_b32 s51, s51, s52
    v_mfma_f32_16x16x32_bf16 v[196:199], a[112:115], v[84:87], v[196:199]
    v_exp_f32 v56, v56
    v_mfma_f32_16x16x32_bf16 v[212:215], a[116:119], v[84:87], v[212:215]
    s_add_u32 m0, s4, 8192
    s_cbranch_vccnz L_wsk9
    buffer_load_dwordx4 v120, s[40:43], s9 offen offset:0 lds
L_wsk9:
    v_mfma_f32_16x16x32_bf16 v[228:231], a[120:123], v[84:87], v[228:231]
    v_exp_f32 v57, v57
    v_mfma_f32_16x16x32_bf16 v[244:247], a[124:127], v[84:87], v[244:247]
    v_cvt_pk_bf16_f32 v92, v56, v57
    s_waitcnt lgkmcnt(0)
    v_mfma_f32_16x16x32_bf16 v[100:103], a[252:255], v[84:87], v[100:103]
    v_exp_f32 v58, v58
    v_mov_b32 v30, s54
    global_load_dword v30, v30, s[16:17] sc1
    v_mfma_f32_16x16x32_bf16 v[32:35], a[64:67], a[0:3], v[64:67]
    s_cbranch_vccnz L_vwa1
    s_waitcnt vmcnt(18)
    s_branch L_vwb1
L_vwa1:
    s_waitcnt vmcnt(9)
L_vwb1:
    s_barrier
    v_mfma_f32_16x16x32_bf16 v[36:39], a[68:71], a[0:3], v[64:67]
    v_exp_f32 v59, v59
    v_mfma_f32_16x16x32_bf16 v[32:35], a[72:75], a[4:7], v[32:35]
    s_and_b32 s50, s50, 0x3ffff
    v_cvt_pk_bf16_f32 v93, v58, v59
    v_xor_b32 v12, s52, v12
    v_mfma_f32_16x16x32_bf16 v[36:39], a[76:79], a[4:7], v[36:39]
    v_exp_f32 v60, v60
    v_mfma_f32_16x16x32_bf16 v[32:35], a[80:83], a[8:11], v[32:35]
    s_add_u32 m0, s51, 65536
    v_xor_b32 v13, s52, v13
    v_xor_b32 v14, s52, v14
    v_mfma_f32_16x16x32_bf16 v[36:39], a[84:87], a[8:11], v[36:39]
    v_exp_f32 v61, v61
    v_mfma_f32_16x16x32_bf16 v[32:35], a[88:91], a[12:15], v[32:35]
    v_cvt_pk_bf16_f32 v94, v60, v61
    v_xor_b32 v15, s52, v15
    v_mfma_f32_16x16x32_bf16 v[36:39], a[92:95], a[12:15], v[36:39]
    v_exp_f32 v62, v62
    v_mfma_f32_16x16x32_bf16 v[136:139], a[96:99], v[88:91], v[136:139]
    v_xor_b32 v16, s52, v16
    v_xor_b32 v17, s52, v17
    v_mfma_f32_16x16x32_bf16 v[152:155], a[100:103], v[88:91], v[152:155]
    v_exp_f32 v63, v63
    v_mfma_f32_16x16x32_bf16 v[168:171], a[104:107], v[88:91], v[168:171]
    v_cvt_pk_bf16_f32 v95, v62, v63
    v_xor_b32 v18, s52, v18
    v_mfma_f32_16x16x32_bf16 v[184:187], a[108:111], v[88:91], v[184:187]
    v_exp_f32 v32, v32
    v_mfma_f32_16x16x32_bf16 v[200:203], a[112:115], v[88:91], v[200:203]
    buffer_load_dwordx4 v24, s[32:35], s50 offen offset:0 nt lds
    v_mfma_f32_16x16x32_bf16 v[216:219], a[116:119], v[88:91], v[216:219]
    v_exp_f32 v33, v33
    v_mfma_f32_16x16x32_bf16 v[232:235], a[120:123], v[88:91], v[232:235]
    v_cvt_pk_bf16_f32 v80, v32, v33
    v_xor_b32 v19, s52, v19
    v_mfma_f32_16x16x32_bf16 v[248:251], a[124:127], v[88:91], v[248:251]
    v_exp_f32 v34, v34
    v_mfma_f32_16x16x32_bf16 v[104:107], a[252:255], v[88:91], v[104:107]
    buffer_load_dwordx4 v25, s[32:35], s50 offen offset:1024 nt lds
    v_mfma_f32_16x16x32_bf16 v[40:43], a[64:67], a[16:19], v[68:71]
    v_exp_f32 v35, v35
    v_mfma_f32_16x16x32_bf16 v[44:47], a[68:71], a[16:19], v[68:71]
    v_cvt_pk_bf16_f32 v81, v34, v35
    v_xor_b32 v8, s52, v8
    v_mfma_f32_16x16x32_bf16 v[40:43], a[72:75], a[20:23], v[40:43]
    v_exp_f32 v36, v36
    v_mfma_f32_16x16x32_bf16 v[44:47], a[76:79], a[20:23], v[44:47]
    v_xor_b32 v9, s52, v9
    v_xor_b32 v10, s52, v10
    v_mfma_f32_16x16x32_bf16 v[40:43], a[80:83], a[24:27], v[40:43]
    v_exp_f32 v37, v37
    v_mfma_f32_16x16x32_bf16 v[44:47], a[84:87], a[24:27], v[44:47]
    v_cvt_pk_bf16_f32 v82, v36, v37
    v_xor_b32 v11, s52, v11
    v_mfma_f32_16x16x32_bf16 v[40:43], a[88:91], a[28:31], v[40:43]
    v_exp_f32 v38, v38
    v_mfma_f32_16x16x32_bf16 v[44:47], a[92:95], a[28:31], v[44:47]
    buffer_load_dwordx4 v24, s[32:35], s50 offen offset:2048 nt lds
    v_mfma_f32_16x16x32_bf16 v[140:143], a[96:99], v[92:95], v[140:143]
    v_exp_f32 v39, v39
    v_mfma_f32_16x16x32_bf16 v[156:159], a[100:103], v[92:95], v[156:159]
    ds_read_b64_tr_b16 a[96:97], v12 offset:0
    v_cvt_pk_bf16_f32 v83, v38, v39
    v_mfma_f32_16x16x32_bf16 v[172:175], a[104:107], v[92:95], v[172:175]
    ds_read_b64_tr_b16 a[98:99], v12 offset:4096
    ds_read_b64_tr_b16 a[100:101], v13 offset:0
    v_mfma_f32_16x16x32_bf16 v[188:191], a[108:111], v[92:95], v[188:191]
    ds_read_b64_tr_b16 a[102:103], v13 offset:4096
    ds_read_b64_tr_b16 a[104:105], v14 offset:0
    v_mfma_f32_16x16x32_bf16 v[204:207], a[112:115], v[92:95], v[204:207]
    v_exp_f32 v40, v40
    v_mfma_f32_16x16x32_bf16 v[220:223], a[116:119], v[92:95], v[220:223]
    ds_read_b64_tr_b16 a[106:107], v14 offset:4096
    ds_read_b64_tr_b16 a[108:109], v15 offset:0
    v_mfma_f32_16x16x32_bf16 v[236:239], a[120:123], v[92:95], v[236:239]
    v_exp_f32 v41, v41
    v_mfma_f32_16x16x32_bf16 v[252:255], a[124:127], v[92:95], v[252:255]
    ds_read_b64_tr_b16 a[110:111], v15 offset:4096
    v_cvt_pk_bf16_f32 v84, v40, v41
    v_mfma_f32_16x16x32_bf16 v[108:111], a[252:255], v[92:95], v[108:111]
    v_exp_f32 v42, v42
    v_mfma_f32_16x16x32_bf16 v[48:51], a[64:67], a[32:35], v[72:75]
    ds_read_b64_tr_b16 a[112:113], v16 offset:0
    ds_read_b64_tr_b16 a[114:115], v16 offset:4096
    v_mfma_f32_16x16x32_bf16 v[52:55], a[68:71], a[32:35], v[72:75]
    v_exp_f32 v43, v43
    v_mfma_f32_16x16x32_bf16 v[48:51], a[72:75], a[36:39], v[48:51]
    ds_read_b64_tr_b16 a[116:117], v17 offset:0
    v_cvt_pk_bf16_f32 v85, v42, v43
    v_mfma_f32_16x16x32_bf16 v[52:55], a[76:79], a[36:39], v[52:55]
    v_exp_f32 v44, v44
    v_mfma_f32_16x16x32_bf16 v[48:51], a[80:83], a[40:43], v[48:51]
    ds_read_b64_tr_b16 a[118:119], v17 offset:4096
    ds_read_b64_tr_b16 a[120:121], v18 offset:0
    v_mfma_f32_16x16x32_bf16 v[52:55], a[84:87], a[40:43], v[52:55]
    v_exp_f32 v45, v45
    v_mfma_f32_16x16x32_bf16 v[48:51], a[88:91], a[44:47], v[48:51]
    ds_read_b64_tr_b16 a[122:123], v18 offset:4096
    v_cvt_pk_bf16_f32 v86, v44, v45
    v_mfma_f32_16x16x32_bf16 v[52:55], a[92:95], a[44:47], v[52:55]
    v_exp_f32 v46, v46
    v_mfma_f32_16x16x32_bf16 v[56:59], a[64:67], a[48:51], v[76:79]
    ds_read_b64_tr_b16 a[124:125], v19 offset:0
    ds_read_b64_tr_b16 a[126:127], v19 offset:4096
    v_mfma_f32_16x16x32_bf16 v[60:63], a[68:71], a[48:51], v[76:79]
    v_exp_f32 v47, v47
    v_mfma_f32_16x16x32_bf16 v[56:59], a[72:75], a[52:55], v[56:59]
    ds_read_b128 a[64:67], v8 offset:0
    v_cvt_pk_bf16_f32 v87, v46, v47
    v_mfma_f32_16x16x32_bf16 v[60:63], a[76:79], a[52:55], v[60:63]
    v_exp_f32 v48, v48
    v_mfma_f32_16x16x32_bf16 v[56:59], a[80:83], a[56:59], v[56:59]
    ds_read_b128 a[68:71], v8 offset:4096
    ds_read_b128 a[72:75], v9 offset:0
    v_mfma_f32_16x16x32_bf16 v[60:63], a[84:87], a[56:59], v[60:63]
    v_exp_f32 v49, v49
    v_mfma_f32_16x16x32_bf16 v[56:59], a[88:91], a[60:63], v[56:59]
    v_cvt_pk_bf16_f32 v88, v48, v49
    s_waitcnt lgkmcnt(3)
    v_mfma_f32_16x16x32_bf16 v[60:63], a[92:95], a[60:63], v[60:63]
    v_exp_f32 v50, v50
    v_mfma_f32_16x16x32_bf16 v[128:131], a[96:99], v[80:83], v[128:131]
    ds_read_b128 a[76:79], v9 offset:4096
    ds_read_b128 a[80:83], v10 offset:0
    v_mfma_f32_16x16x32_bf16 v[144:147], a[100:103], v[80:83], v[144:147]
    v_exp_f32 v51, v51
    v_mfma_f32_16x16x32_bf16 v[160:163], a[104:107], v[80:83], v[160:163]
    ds_read_b128 a[84:87], v10 offset:4096
    v_cvt_pk_bf16_f32 v89, v50, v51
    v_mfma_f32_16x16x32_bf16 v[176:179], a[108:111], v[80:83], v[176:179]
    v_exp_f32 v52, v52
    v_mfma_f32_16x16x32_bf16 v[192:195], a[112:115], v[80:83], v[192:195]
    ds_read_b128 a[88:91], v11 offset:0
    ds_read_b128 a[92:95], v11 offset:4096
    v_mfma_f32_16x16x32_bf16 v[208:211], a[116:119], v[80:83], v[208:211]
    v_exp_f32 v53, v53
    v_mfma_f32_16x16x32_bf16 v[224:227], a[120:123], v[80:83], v[224:227]
    buffer_load_dwordx4 v25, s[32:35], s50 offen offset:3072 nt lds
    v_cvt_pk_bf16_f32 v90, v52, v53
    v_mfma_f32_16x16x32_bf16 v[240:243], a[124:127], v[80:83], v[240:243]
    v_exp_f32 v54, v54
    v_mfma_f32_16x16x32_bf16 v[96:99], a[252:255], v[80:83], v[96:99]
    v_mfma_f32_16x16x32_bf16 v[132:135], a[96:99], v[84:87], v[132:135]
    v_exp_f32 v55, v55
    v_mfma_f32_16x16x32_bf16 v[148:151], a[100:103], v[84:87], v[148:151]
    s_add_u32 m0, s5, 0
    s_cbranch_vccnz L_wsk10
    buffer_load_dwordx4 v112, s[40:43], s10 offen offset:0 lds
L_wsk10:
    v_cvt_pk_bf16_f32 v91, v54, v55
    v_mfma_f32_16x16x32_bf16 v[164:167], a[104:107], v[84:87], v[164:167]
    v_mfma_f32_16x16x32_bf16 v[180:183], a[108:111], v[84:87], v[180:183]
    v_mfma_f32_16x16x32_bf16 v[196:199], a[112:115], v[84:87], v[196:199]
    v_exp_f32 v56, v56
    v_mfma_f32_16x16x32_bf16 v[212:215], a[116:119], v[84:87], v[212:215]
    s_cbranch_vccnz L_wsk11
    buffer_load_dwordx4 v113, s[40:43], s10 offen offset:1024 lds
L_wsk11:
    v_mfma_f32_16x16x32_bf16 v[228:231], a[120:123], v[84:87], v[228:231]
    v_exp_f32 v57, v57
    v_mfma_f32_16x16x32_bf16 v[244:247], a[124:127], v[84:87], v[244:247]
    v_cvt_pk_bf16_f32 v92, v56, v57
    s_waitcnt lgkmcnt(0)
    v_mfma_f32_16x16x32_bf16 v[100:103], a[252:255], v[84:87], v[100:103]
    v_exp_f32 v58, v58
    v_mfma_f32_16x16x32_bf16 v[32:35], a[64:67], a[0:3], v[64:67]
    s_cbranch_vccnz L_wsk12
    buffer_load_dwordx4 v114, s[40:43], s10 offen offset:2048 lds
L_wsk12:
    v_mfma_f32_16x16x32_bf16 v[36:39], a[68:71], a[0:3], v[64:67]
    v_exp_f32 v59, v59
    v_mfma_f32_16x16x32_bf16 v[32:35], a[72:75], a[4:7], v[32:35]
    v_cvt_pk_bf16_f32 v93, v58, v59
    v_mfma_f32_16x16x32_bf16 v[36:39], a[76:79], a[4:7], v[36:39]
    v_exp_f32 v60, v60
    v_mfma_f32_16x16x32_bf16 v[32:35], a[80:83], a[8:11], v[32:35]
    v_mfma_f32_16x16x32_bf16 v[36:39], a[84:87], a[8:11], v[36:39]
    v_exp_f32 v61, v61
    v_mfma_f32_16x16x32_bf16 v[32:35], a[88:91], a[12:15], v[32:35]
    v_cvt_pk_bf16_f32 v94, v60, v61
    v_mfma_f32_16x16x32_bf16 v[36:39], a[92:95], a[12:15], v[36:39]
    v_exp_f32 v62, v62
    v_mfma_f32_16x16x32_bf16 v[136:139], a[96:99], v[88:91], v[136:139]
    s_cbranch_vccnz L_wsk13
    buffer_load_dwordx4 v115, s[40:43], s10 offen offset:3072 lds
L_wsk13:
    v_mfma_f32_16x16x32_bf16 v[152:155], a[100:103], v[88:91], v[152:155]
    v_exp_f32 v63, v63
    v_mfma_f32_16x16x32_bf16 v[168:171], a[104:107], v[88:91], v[168:171]
    v_cvt_pk_bf16_f32 v95, v62, v63
    v_mfma_f32_16x16x32_bf16 v[184:187], a[108:111], v[88:91], v[184:187]
    v_exp_f32 v32, v32
    v_mfma_f32_16x16x32_bf16 v[200:203], a[112:115], v[88:91], v[200:203]
    v_mfma_f32_16x16x32_bf16 v[216:219], a[116:119], v[88:91], v[216:219]
    v_exp_f32 v33, v33
    v_mfma_f32_16x16x32_bf16 v[232:235], a[120:123], v[88:91], v[232:235]
    v_cvt_pk_bf16_f32 v80, v32, v33
    v_mfma_f32_16x16x32_bf16 v[248:251], a[124:127], v[88:91], v[248:251]
    v_exp_f32 v34, v34
    v_mfma_f32_16x16x32_bf16 v[104:107], a[252:255], v[88:91], v[104:107]
    s_add_u32 m0, s5, 4096
    s_cbranch_vccnz L_wsk14
    buffer_load_dwordx4 v116, s[40:43], s10 offen offset:0 lds
L_wsk14:
    v_mfma_f32_16x16x32_bf16 v[40:43], a[64:67], a[16:19], v[68:71]
    v_exp_f32 v35, v35
    v_mfma_f32_16x16x32_bf16 v[44:47], a[68:71], a[16:19], v[68:71]
    v_cvt_pk_bf16_f32 v81, v34, v35
    v_mfma_f32_16x16x32_bf16 v[40:43], a[72:75], a[20:23], v[40:43]
    v_exp_f32 v36, v36
    v_mfma_f32_16x16x32_bf16 v[44:47], a[76:79], a[20:23], v[44:47]
    v_mfma_f32_16x16x32_bf16 v[40:43], a[80:83], a[24:27], v[40:43]
    v_exp_f32 v37, v37
    v_mfma_f32_16x16x32_bf16 v[44:47], a[84:87], a[24:27], v[44:47]
    v_cvt_pk_bf16_f32 v82, v36, v37
    v_mfma_f32_16x16x32_bf16 v[40:43], a[88:91], a[28:31], v[40:43]
    v_exp_f32 v38, v38
    v_mfma_f32_16x16x32_bf16 v[44:47], a[92:95], a[28:31], v[44:47]
    s_cbranch_vccnz L_wsk15
    buffer_load_dwordx4 v117, s[40:43], s10 offen offset:1024 lds
L_wsk15:
    v_mfma_f32_16x16x32_bf16 v[140:143], a[96:99], v[92:95], v[140:143]
    v_exp_f32 v39, v39
    v_mfma_f32_16x16x32_bf16 v[156:159], a[100:103], v[92:95], v[156:159]
    ds_read_b64_tr_b16 a[96:97], v12 offset:8192
    v_cvt_pk_bf16_f32 v83, v38, v39
    v_mfma_f32_16x16x32_bf16 v[172:175], a[104:107], v[92:95], v[172:175]
    ds_read_b64_tr_b16 a[98:99], v12 offset:12288
    ds_read_b64_tr_b16 a[100:101], v13 offset:8192
    v_mfma_f32_16x16x32_bf16 v[188:191], a[108:111], v[92:95], v[188:191]
    ds_read_b64_tr_b16 a[102:103], v13 offset:12288
    ds_read_b64_tr_b16 a[104:105], v14 offset:8192
    v_mfma_f32_16x16x32_bf16 v[204:207], a[112:115], v[92:95], v[204:207]
    v_exp_f32 v40, v40
    v_mfma_f32_16x16x32_bf16 v[220:223], a[116:119], v[92:95], v[220:223]
    ds_read_b64_tr_b16 a[106:107], v14 offset:12288
    ds_read_b64_tr_b16 a[108:109], v15 offset:8192
    v_mfma_f32_16x16x32_bf16 v[236:239], a[120:123], v[92:95], v[236:239]
    v_exp_f32 v41, v41
    v_mfma_f32_16x16x32_bf16 v[252:255], a[124:127], v[92:95], v[252:255]
    ds_read_b64_tr_b16 a[110:111], v15 offset:12288
    v_cvt_pk_bf16_f32 v84, v40, v41
    v_mfma_f32_16x16x32_bf16 v[108:111], a[252:255], v[92:95], v[108:111]
    v_exp_f32 v42, v42
    v_mfma_f32_16x16x32_bf16 v[48:51], a[64:67], a[32:35], v[72:75]
    ds_read_b64_tr_b16 a[112:113], v16 offset:8192
    ds_read_b64_tr_b16 a[114:115], v16 offset:12288
    v_mfma_f32_16x16x32_bf16 v[52:55], a[68:71], a[32:35], v[72:75]
    v_exp_f32 v43, v43
    v_mfma_f32_16x16x32_bf16 v[48:51], a[72:75], a[36:39], v[48:51]
    ds_read_b64_tr_b16 a[116:117], v17 offset:8192
    v_cvt_pk_bf16_f32 v85, v42, v43
    v_mfma_f32_16x16x32_bf16 v[52:55], a[76:79], a[36:39], v[52:55]
    v_exp_f32 v44, v44
    v_mfma_f32_16x16x32_bf16 v[48:51], a[80:83], a[40:43], v[48:51]
    ds_read_b64_tr_b16 a[118:119], v17 offset:12288
    ds_read_b64_tr_b16 a[120:121], v18 offset:8192
    v_mfma_f32_16x16x32_bf16 v[52:55], a[84:87], a[40:43], v[52:55]
    v_exp_f32 v45, v45
    v_mfma_f32_16x16x32_bf16 v[48:51], a[88:91], a[44:47], v[48:51]
    ds_read_b64_tr_b16 a[122:123], v18 offset:12288
    v_cvt_pk_bf16_f32 v86, v44, v45
    v_mfma_f32_16x16x32_bf16 v[52:55], a[92:95], a[44:47], v[52:55]
    v_exp_f32 v46, v46
    v_mfma_f32_16x16x32_bf16 v[56:59], a[64:67], a[48:51], v[76:79]
    ds_read_b64_tr_b16 a[124:125], v19 offset:8192
    ds_read_b64_tr_b16 a[126:127], v19 offset:12288
    v_mfma_f32_16x16x32_bf16 v[60:63], a[68:71], a[48:51], v[76:79]
    v_exp_f32 v47, v47
    v_mfma_f32_16x16x32_bf16 v[56:59], a[72:75], a[52:55], v[56:59]
    ds_read_b128 a[64:67], v8 offset:8192
    v_cvt_pk_bf16_f32 v87, v46, v47
    v_mfma_f32_16x16x32_bf16 v[60:63], a[76:79], a[52:55], v[60:63]
    v_exp_f32 v48, v48
    v_mfma_f32_16x16x32_bf16 v[56:59], a[80:83], a[56:59], v[56:59]
    ds_read_b128 a[68:71], v8 offset:12288
    ds_read_b128 a[72:75], v9 offset:8192
    v_mfma_f32_16x16x32_bf16 v[60:63], a[84:87], a[56:59], v[60:63]
    v_exp_f32 v49, v49
    v_mfma_f32_16x16x32_bf16 v[56:59], a[88:91], a[60:63], v[56:59]
    v_cvt_pk_bf16_f32 v88, v48, v49
    s_waitcnt lgkmcnt(3)
    v_mfma_f32_16x16x32_bf16 v[60:63], a[92:95], a[60:63], v[60:63]
    v_exp_f32 v50, v50
    v_mfma_f32_16x16x32_bf16 v[128:131], a[96:99], v[80:83], v[128:131]
    ds_read_b128 a[76:79], v9 offset:12288
    ds_read_b128 a[80:83], v10 offset:8192
    v_mfma_f32_16x16x32_bf16 v[144:147], a[100:103], v[80:83], v[144:147]
    v_exp_f32 v51, v51
    v_mfma_f32_16x16x32_bf16 v[160:163], a[104:107], v[80:83], v[160:163]
    ds_read_b128 a[84:87], v10 offset:12288
    v_cvt_pk_bf16_f32 v89, v50, v51
    v_mfma_f32_16x16x32_bf16 v[176:179], a[108:111], v[80:83], v[176:179]
    v_exp_f32 v52, v52
    v_mfma_f32_16x16x32_bf16 v[192:195], a[112:115], v[80:83], v[192:195]
    ds_read_b128 a[88:91], v11 offset:8192
    ds_read_b128 a[92:95], v11 offset:12288
    v_mfma_f32_16x16x32_bf16 v[208:211], a[116:119], v[80:83], v[208:211]
    v_exp_f32 v53, v53
    v_mfma_f32_16x16x32_bf16 v[224:227], a[120:123], v[80:83], v[224:227]
    s_cbranch_vccnz L_wsk16
    buffer_load_dwordx4 v118, s[40:43], s10 offen offset:2048 lds
L_wsk16:
    v_cvt_pk_bf16_f32 v90, v52, v53
    v_mfma_f32_16x16x32_bf16 v[240:243], a[124:127], v[80:83], v[240:243]
    v_exp_f32 v54, v54
    v_mfma_f32_16x16x32_bf16 v[96:99], a[252:255], v[80:83], v[96:99]
    v_mfma_f32_16x16x32_bf16 v[132:135], a[96:99], v[84:87], v[132:135]
    v_exp_f32 v55, v55
    v_mfma_f32_16x16x32_bf16 v[148:151], a[100:103], v[84:87], v[148:151]
    s_cbranch_vccnz L_wsk17
    buffer_load_dwordx4 v119, s[40:43], s10 offen offset:3072 lds
L_wsk17:
    v_cvt_pk_bf16_f32 v91, v54, v55
    v_mfma_f32_16x16x32_bf16 v[164:167], a[104:107], v[84:87], v[164:167]
    s_xor_b32 s52, s52, 0x8000
    v_mfma_f32_16x16x32_bf16 v[180:183], a[108:111], v[84:87], v[180:183]
    v_mfma_f32_16x16x32_bf16 v[196:199], a[112:115], v[84:87], v[196:199]
    v_exp_f32 v56, v56
    v_mfma_f32_16x16x32_bf16 v[212:215], a[116:119], v[84:87], v[212:215]
    s_add_u32 m0, s5, 8192
    s_cbranch_vccnz L_wsk18
    buffer_load_dwordx4 v120, s[40:43], s10 offen offset:0 lds
L_wsk18:
    v_mfma_f32_16x16x32_bf16 v[228:231], a[120:123], v[84:87], v[228:231]
    v_exp_f32 v57, v57
    v_mfma_f32_16x16x32_bf16 v[244:247], a[124:127], v[84:87], v[244:247]
    v_cvt_pk_bf16_f32 v92, v56, v57
    s_waitcnt lgkmcnt(0)
    v_mfma_f32_16x16x32_bf16 v[100:103], a[252:255], v[84:87], v[100:103]
    v_exp_f32 v58, v58
    v_mfma_f32_16x16x32_bf16 v[32:35], a[64:67], a[0:3], v[64:67]
    s_cbranch_vccnz L_vwa2
    s_waitcnt vmcnt(23)
    s_branch L_vwb2
L_vwa2:
    s_waitcnt vmcnt(5)
L_vwb2:
    s_barrier
    v_mfma_f32_16x16x32_bf16 v[36:39], a[68:71], a[0:3], v[64:67]
    v_exp_f32 v59, v59
    v_mfma_f32_16x16x32_bf16 v[32:35], a[72:75], a[4:7], v[32:35]
    v_cvt_pk_bf16_f32 v93, v58, v59
    v_xor_b32 v12, s52, v12
    v_mfma_f32_16x16x32_bf16 v[36:39], a[76:79], a[4:7], v[36:39]
    v_exp_f32 v60, v60
    v_mfma_f32_16x16x32_bf16 v[32:35], a[80:83], a[8:11], v[32:35]
    v_xor_b32 v13, s52, v13
    v_xor_b32 v14, s52, v14
    v_mfma_f32_16x16x32_bf16 v[36:39], a[84:87], a[8:11], v[36:39]
    v_exp_f32 v61, v61
    v_mfma_f32_16x16x32_bf16 v[32:35], a[88:91], a[12:15], v[32:35]
    v_cvt_pk_bf16_f32 v94, v60, v61
    v_xor_b32 v15, s52, v15
    v_mfma_f32_16x16x32_bf16 v[36:39], a[92:95], a[12:15], v[36:39]
    v_exp_f32 v62, v62
    v_mfma_f32_16x16x32_bf16 v[136:139], a[96:99], v[88:91], v[136:139]
    v_xor_b32 v16, s52, v16
    v_xor_b32 v17, s52, v17
    v_mfma_f32_16x16x32_bf16 v[152:155], a[100:103], v[88:91], v[152:155]
    v_exp_f32 v63, v63
    v_mfma_f32_16x16x32_bf16 v[168:171], a[104:107], v[88:91], v[168:171]
    v_cvt_pk_bf16_f32 v95, v62, v63
    v_xor_b32 v18, s52, v18
    v_mfma_f32_16x16x32_bf16 v[184:187], a[108:111], v[88:91], v[184:187]
    v_exp_f32 v32, v32
    v_mfma_f32_16x16x32_bf16 v[200:203], a[112:115], v[88:91], v[200:203]
    s_add_u32 m0, s6, 0
    s_nop 0
    buffer_load_dwordx4 v112, s[40:43], s11 offen offset:0 lds
    v_mfma_f32_16x16x32_bf16 v[216:219], a[116:119], v[88:91], v[216:219]
    v_exp_f32 v33, v33
    v_mfma_f32_16x16x32_bf16 v[232:235], a[120:123], v[88:91], v[232:235]
    v_cvt_pk_bf16_f32 v80, v32, v33
    v_xor_b32 v19, s52, v19
    v_mfma_f32_16x16x32_bf16 v[248:251], a[124:127], v[88:91], v[248:251]
    v_exp_f32 v34, v34
    v_mfma_f32_16x16x32_bf16 v[104:107], a[252:255], v[88:91], v[104:107]
    v_mfma_f32_16x16x32_bf16 v[40:43], a[64:67], a[16:19], v[68:71]
    v_exp_f32 v35, v35
    v_mfma_f32_16x16x32_bf16 v[44:47], a[68:71], a[16:19], v[68:71]
    v_cvt_pk_bf16_f32 v81, v34, v35
    v_xor_b32 v8, s52, v8
    v_mfma_f32_16x16x32_bf16 v[40:43], a[72:75], a[20:23], v[40:43]
    v_exp_f32 v36, v36
    v_mfma_f32_16x16x32_bf16 v[44:47], a[76:79], a[20:23], v[44:47]
    v_xor_b32 v9, s52, v9
    v_xor_b32 v10, s52, v10
    v_mfma_f32_16x16x32_bf16 v[40:43], a[80:83], a[24:27], v[40:43]
    v_exp_f32 v37, v37
    v_mfma_f32_16x16x32_bf16 v[44:47], a[84:87], a[24:27], v[44:47]
    v_cvt_pk_bf16_f32 v82, v36, v37
    v_xor_b32 v11, s52, v11
    v_mfma_f32_16x16x32_bf16 v[40:43], a[88:91], a[28:31], v[40:43]
    v_exp_f32 v38, v38
    v_mfma_f32_16x16x32_bf16 v[44:47], a[92:95], a[28:31], v[44:47]
    buffer_load_dwordx4 v113, s[40:43], s11 offen offset:1024 lds
    v_mfma_f32_16x16x32_bf16 v[140:143], a[96:99], v[92:95], v[140:143]
    v_exp_f32 v39, v39
    v_mfma_f32_16x16x32_bf16 v[156:159], a[100:103], v[92:95], v[156:159]
    ds_read_b64_tr_b16 a[96:97], v12 offset:0
    v_cvt_pk_bf16_f32 v83, v38, v39
    v_mfma_f32_16x16x32_bf16 v[172:175], a[104:107], v[92:95], v[172:175]
    ds_read_b64_tr_b16 a[98:99], v12 offset:4096
    ds_read_b64_tr_b16 a[100:101], v13 offset:0
    v_mfma_f32_16x16x32_bf16 v[188:191], a[108:111], v[92:95], v[188:191]
    ds_read_b64_tr_b16 a[102:103], v13 offset:4096
    ds_read_b64_tr_b16 a[104:105], v14 offset:0
    v_mfma_f32_16x16x32_bf16 v[204:207], a[112:115], v[92:95], v[204:207]
    v_exp_f32 v40, v40
    v_mfma_f32_16x16x32_bf16 v[220:223], a[116:119], v[92:95], v[220:223]
    ds_read_b64_tr_b16 a[106:107], v14 offset:4096
    ds_read_b64_tr_b16 a[108:109], v15 offset:0
    v_mfma_f32_16x16x32_bf16 v[236:239], a[120:123], v[92:95], v[236:239]
    v_exp_f32 v41, v41
    v_mfma_f32_16x16x32_bf16 v[252:255], a[124:127], v[92:95], v[252:255]
    ds_read_b64_tr_b16 a[110:111], v15 offset:4096
    v_cvt_pk_bf16_f32 v84, v40, v41
    v_mfma_f32_16x16x32_bf16 v[108:111], a[252:255], v[92:95], v[108:111]
    v_exp_f32 v42, v42
    v_mfma_f32_16x16x32_bf16 v[48:51], a[64:67], a[32:35], v[72:75]
    ds_read_b64_tr_b16 a[112:113], v16 offset:0
    ds_read_b64_tr_b16 a[114:115], v16 offset:4096
    v_mfma_f32_16x16x32_bf16 v[52:55], a[68:71], a[32:35], v[72:75]
    v_exp_f32 v43, v43
    v_mfma_f32_16x16x32_bf16 v[48:51], a[72:75], a[36:39], v[48:51]
    ds_read_b64_tr_b16 a[116:117], v17 offset:0
    v_cvt_pk_bf16_f32 v85, v42, v43
    v_mfma_f32_16x16x32_bf16 v[52:55], a[76:79], a[36:39], v[52:55]
    v_exp_f32 v44, v44
    v_mfma_f32_16x16x32_bf16 v[48:51], a[80:83], a[40:43], v[48:51]
    ds_read_b64_tr_b16 a[118:119], v17 offset:4096
    ds_read_b64_tr_b16 a[120:121], v18 offset:0
    v_mfma_f32_16x16x32_bf16 v[52:55], a[84:87], a[40:43], v[52:55]
    v_exp_f32 v45, v45
    v_mfma_f32_16x16x32_bf16 v[48:51], a[88:91], a[44:47], v[48:51]
    ds_read_b64_tr_b16 a[122:123], v18 offset:4096
    v_cvt_pk_bf16_f32 v86, v44, v45
    v_mfma_f32_16x16x32_bf16 v[52:55], a[92:95], a[44:47], v[52:55]
    v_exp_f32 v46, v46
    v_mfma_f32_16x16x32_bf16 v[56:59], a[64:67], a[48:51], v[76:79]
    ds_read_b64_tr_b16 a[124:125], v19 offset:0
    ds_read_b64_tr_b16 a[126:127], v19 offset:4096
    v_mfma_f32_16x16x32_bf16 v[60:63], a[68:71], a[48:51], v[76:79]
    v_exp_f32 v47, v47
    v_mfma_f32_16x16x32_bf16 v[56:59], a[72:75], a[52:55], v[56:59]
    ds_read_b128 a[64:67], v8 offset:0
    v_cvt_pk_bf16_f32 v87, v46, v47
    v_mfma_f32_16x16x32_bf16 v[60:63], a[76:79], a[52:55], v[60:63]
    v_exp_f32 v48, v48
    v_mfma_f32_16x16x32_bf16 v[56:59], a[80:83], a[56:59], v[56:59]
    ds_read_b128 a[68:71], v8 offset:4096
    ds_read_b128 a[72:75], v9 offset:0
    v_mfma_f32_16x16x32_bf16 v[60:63], a[84:87], a[56:59], v[60:63]
    v_exp_f32 v49, v49
    v_mfma_f32_16x16x32_bf16 v[56:59], a[88:91], a[60:63], v[56:59]
    v_cvt_pk_bf16_f32 v88, v48, v49
    s_waitcnt lgkmcnt(3)
    v_mfma_f32_16x16x32_bf16 v[60:63], a[92:95], a[60:63], v[60:63]
    v_exp_f32 v50, v50
    v_mfma_f32_16x16x32_bf16 v[128:131], a[96:99], v[80:83], v[128:131]
    ds_read_b128 a[76:79], v9 offset:4096
    ds_read_b128 a[80:83], v10 offset:0
    v_mfma_f32_16x16x32_bf16 v[144:147], a[100:103], v[80:83], v[144:147]
    v_exp_f32 v51, v51
    v_mfma_f32_16x16x32_bf16 v[160:163], a[104:107], v[80:83], v[160:163]
    ds_read_b128 a[84:87], v10 offset:4096
    v_cvt_pk_bf16_f32 v89, v50, v51
    v_mfma_f32_16x16x32_bf16 v[176:179], a[108:111], v[80:83], v[176:179]
    v_exp_f32 v52, v52
    v_mfma_f32_16x16x32_bf16 v[192:195], a[112:115], v[80:83], v[192:195]
    ds_read_b128 a[88:91], v11 offset:0
    ds_read_b128 a[92:95], v11 offset:4096
    v_mfma_f32_16x16x32_bf16 v[208:211], a[116:119], v[80:83], v[208:211]
    v_exp_f32 v53, v53
    v_mfma_f32_16x16x32_bf16 v[224:227], a[120:123], v[80:83], v[224:227]
    v_cvt_pk_bf16_f32 v90, v52, v53
    v_mfma_f32_16x16x32_bf16 v[240:243], a[124:127], v[80:83], v[240:243]
    v_exp_f32 v54, v54
    v_mfma_f32_16x16x32_bf16 v[96:99], a[252:255], v[80:83], v[96:99]
    buffer_load_dwordx4 v114, s[40:43], s11 offen offset:2048 lds
    v_mfma_f32_16x16x32_bf16 v[132:135], a[96:99], v[84:87], v[132:135]
    v_exp_f32 v55, v55
    v_mfma_f32_16x16x32_bf16 v[148:151], a[100:103], v[84:87], v[148:151]
    v_cvt_pk_bf16_f32 v91, v54, v55
    v_mfma_f32_16x16x32_bf16 v[164:167], a[104:107], v[84:87], v[164:167]
    v_mfma_f32_16x16x32_bf16 v[180:183], a[108:111], v[84:87], v[180:183]
    v_mfma_f32_16x16x32_bf16 v[196:199], a[112:115], v[84:87], v[196:199]
    v_exp_f32 v56, v56
    v_mfma_f32_16x16x32_bf16 v[212:215], a[116:119], v[84:87], v[212:215]
    buffer_load_dwordx4 v115, s[40:43], s11 offen offset:3072 lds
    v_mfma_f32_16x16x32_bf16 v[228:231], a[120:123], v[84:87], v[228:231]
    v_exp_f32 v57, v57
    v_mfma_f32_16x16x32_bf16 v[244:247], a[124:127], v[84:87], v[244:247]
    v_cvt_pk_bf16_f32 v92, v56, v57
    s_waitcnt lgkmcnt(0)
    v_mfma_f32_16x16x32_bf16 v[100:103], a[252:255], v[84:87], v[100:103]
    v_exp_f32 v58, v58
    v_mfma_f32_16x16x32_bf16 v[32:35], a[64:67], a[0:3], v[64:67]
    v_mfma_f32_16x16x32_bf16 v[36:39], a[68:71], a[0:3], v[64:67]
    v_exp_f32 v59, v59
    v_mfma_f32_16x16x32_bf16 v[32:35], a[72:75], a[4:7], v[32:35]
    v_cvt_pk_bf16_f32 v93, v58, v59
    v_mfma_f32_16x16x32_bf16 v[36:39], a[76:79], a[4:7], v[36:39]
    v_exp_f32 v60, v60
    v_mfma_f32_16x16x32_bf16 v[32:35], a[80:83], a[8:11], v[32:35]
    s_add_u32 m0, s6, 4096
    s_nop 0
    buffer_load_dwordx4 v116, s[40:43], s11 offen offset:0 lds
    v_mfma_f32_16x16x32_bf16 v[36:39], a[84:87], a[8:11], v[36:39]
    v_exp_f32 v61, v61
    v_mfma_f32_16x16x32_bf16 v[32:35], a[88:91], a[12:15], v[32:35]
    v_cvt_pk_bf16_f32 v94, v60, v61
    v_mfma_f32_16x16x32_bf16 v[36:39], a[92:95], a[12:15], v[36:39]
    v_exp_f32 v62, v62
    v_mfma_f32_16x16x32_bf16 v[136:139], a[96:99], v[88:91], v[136:139]
    v_mfma_f32_16x16x32_bf16 v[152:155], a[100:103], v[88:91], v[152:155]
    v_exp_f32 v63, v63
    v_mfma_f32_16x16x32_bf16 v[168:171], a[104:107], v[88:91], v[168:171]
    v_cvt_pk_bf16_f32 v95, v62, v63
    v_mfma_f32_16x16x32_bf16 v[184:187], a[108:111], v[88:91], v[184:187]
    v_exp_f32 v32, v32
    v_mfma_f32_16x16x32_bf16 v[200:203], a[112:115], v[88:91], v[200:203]
    buffer_load_dwordx4 v117, s[40:43], s11 offen offset:1024 lds
    v_mfma_f32_16x16x32_bf16 v[216:219], a[116:119], v[88:91], v[216:219]
    v_exp_f32 v33, v33
    v_mfma_f32_16x16x32_bf16 v[232:235], a[120:123], v[88:91], v[232:235]
    v_cvt_pk_bf16_f32 v80, v32, v33
    v_mfma_f32_16x16x32_bf16 v[248:251], a[124:127], v[88:91], v[248:251]
    v_exp_f32 v34, v34
    v_mfma_f32_16x16x32_bf16 v[104:107], a[252:255], v[88:91], v[104:107]
    v_mfma_f32_16x16x32_bf16 v[40:43], a[64:67], a[16:19], v[68:71]
    v_exp_f32 v35, v35
    v_mfma_f32_16x16x32_bf16 v[44:47], a[68:71], a[16:19], v[68:71]
    v_cvt_pk_bf16_f32 v81, v34, v35
    v_mfma_f32_16x16x32_bf16 v[40:43], a[72:75], a[20:23], v[40:43]
    v_exp_f32 v36, v36
    v_mfma_f32_16x16x32_bf16 v[44:47], a[76:79], a[20:23], v[44:47]
    buffer_load_dwordx4 v118, s[40:43], s11 offen offset:2048 lds
    v_mfma_f32_16x16x32_bf16 v[40:43], a[80:83], a[24:27], v[40:43]
    v_exp_f32 v37, v37
    v_mfma_f32_16x16x32_bf16 v[44:47], a[84:87], a[24:27], v[44:47]
    v_cvt_pk_bf16_f32 v82, v36, v37
    v_mfma_f32_16x16x32_bf16 v[40:43], a[88:91], a[28:31], v[40:43]
    v_exp_f32 v38, v38
    v_mfma_f32_16x16x32_bf16 v[44:47], a[92:95], a[28:31], v[44:47]
    v_mfma_f32_16x16x32_bf16 v[140:143], a[96:99], v[92:95], v[140:143]
    v_exp_f32 v39, v39
    v_mfma_f32_16x16x32_bf16 v[156:159], a[100:103], v[92:95], v[156:159]
    ds_read_b64_tr_b16 a[96:97], v12 offset:8192
    v_cvt_pk_bf16_f32 v83, v38, v39
    v_mfma_f32_16x16x32_bf16 v[172:175], a[104:107], v[92:95], v[172:175]
    ds_read_b64_tr_b16 a[98:99], v12 offset:12288
    ds_read_b64_tr_b16 a[100:101], v13 offset:8192
    v_mfma_f32_16x16x32_bf16 v[188:191], a[108:111], v[92:95], v[188:191]
    ds_read_b64_tr_b16 a[102:103], v13 offset:12288
    ds_read_b64_tr_b16 a[104:105], v14 offset:8192
    v_mfma_f32_16x16x32_bf16 v[204:207], a[112:115], v[92:95], v[204:207]
    v_exp_f32 v40, v40
    v_mfma_f32_16x16x32_bf16 v[220:223], a[116:119], v[92:95], v[220:223]
    ds_read_b64_tr_b16 a[106:107], v14 offset:12288
    ds_read_b64_tr_b16 a[108:109], v15 offset:8192
    v_mfma_f32_16x16x32_bf16 v[236:239], a[120:123], v[92:95], v[236:239]
    v_exp_f32 v41, v41
    v_mfma_f32_16x16x32_bf16 v[252:255], a[124:127], v[92:95], v[252:255]
    ds_read_b64_tr_b16 a[110:111], v15 offset:12288
    v_cvt_pk_bf16_f32 v84, v40, v41
    v_mfma_f32_16x16x32_bf16 v[108:111], a[252:255], v[92:95], v[108:111]
    v_exp_f32 v42, v42
    v_mfma_f32_16x16x32_bf16 v[48:51], a[64:67], a[32:35], v[72:75]
    ds_read_b64_tr_b16 a[112:113], v16 offset:8192
    ds_read_b64_tr_b16 a[114:115], v16 offset:12288
    v_mfma_f32_16x16x32_bf16 v[52:55], a[68:71], a[32:35], v[72:75]
    v_exp_f32 v43, v43
    v_mfma_f32_16x16x32_bf16 v[48:51], a[72:75], a[36:39], v[48:51]
    ds_read_b64_tr_b16 a[116:117], v17 offset:8192
    v_cvt_pk_bf16_f32 v85, v42, v43
    v_mfma_f32_16x16x32_bf16 v[52:55], a[76:79], a[36:39], v[52:55]
    v_exp_f32 v44, v44
    v_mfma_f32_16x16x32_bf16 v[48:51], a[80:83], a[40:43], v[48:51]
    ds_read_b64_tr_b16 a[118:119], v17 offset:12288
    ds_read_b64_tr_b16 a[120:121], v18 offset:8192
    v_mfma_f32_16x16x32_bf16 v[52:55], a[84:87], a[40:43], v[52:55]
    v_exp_f32 v45, v45
    v_mfma_f32_16x16x32_bf16 v[48:51], a[88:91], a[44:47], v[48:51]
    ds_read_b64_tr_b16 a[122:123], v18 offset:12288
    v_cvt_pk_bf16_f32 v86, v44, v45
    v_mfma_f32_16x16x32_bf16 v[52:55], a[92:95], a[44:47], v[52:55]
    v_exp_f32 v46, v46
    v_mfma_f32_16x16x32_bf16 v[56:59], a[64:67], a[48:51], v[76:79]
    ds_read_b64_tr_b16 a[124:125], v19 offset:8192
    ds_read_b64_tr_b16 a[126:127], v19 offset:12288
    v_mfma_f32_16x16x32_bf16 v[60:63], a[68:71], a[48:51], v[76:79]
    v_exp_f32 v47, v47
    v_mfma_f32_16x16x32_bf16 v[56:59], a[72:75], a[52:55], v[56:59]
    ds_read_b128 a[64:67], v8 offset:8192
    v_cvt_pk_bf16_f32 v87, v46, v47
    v_mfma_f32_16x16x32_bf16 v[60:63], a[76:79], a[52:55], v[60:63]
    v_exp_f32 v48, v48
    v_mfma_f32_16x16x32_bf16 v[56:59], a[80:83], a[56:59], v[56:59]
    ds_read_b128 a[68:71], v8 offset:12288
    ds_read_b128 a[72:75], v9 offset:8192
    v_mfma_f32_16x16x32_bf16 v[60:63], a[84:87], a[56:59], v[60:63]
    v_exp_f32 v49, v49
    v_mfma_f32_16x16x32_bf16 v[56:59], a[88:91], a[60:63], v[56:59]
    v_cvt_pk_bf16_f32 v88, v48, v49
    s_waitcnt lgkmcnt(3)
    v_mfma_f32_16x16x32_bf16 v[60:63], a[92:95], a[60:63], v[60:63]
    v_exp_f32 v50, v50
    v_mfma_f32_16x16x32_bf16 v[128:131], a[96:99], v[80:83], v[128:131]
    ds_read_b128 a[76:79], v9 offset:12288
    ds_read_b128 a[80:83], v10 offset:8192
    v_mfma_f32_16x16x32_bf16 v[144:147], a[100:103], v[80:83], v[144:147]
    v_exp_f32 v51, v51
    v_mfma_f32_16x16x32_bf16 v[160:163], a[104:107], v[80:83], v[160:163]
    ds_read_b128 a[84:87], v10 offset:12288
    v_cvt_pk_bf16_f32 v89, v50, v51
    v_mfma_f32_16x16x32_bf16 v[176:179], a[108:111], v[80:83], v[176:179]
    v_exp_f32 v52, v52
    v_mfma_f32_16x16x32_bf16 v[192:195], a[112:115], v[80:83], v[192:195]
    ds_read_b128 a[88:91], v11 offset:8192
    ds_read_b128 a[92:95], v11 offset:12288
    v_mfma_f32_16x16x32_bf16 v[208:211], a[116:119], v[80:83], v[208:211]
    v_exp_f32 v53, v53
    v_mfma_f32_16x16x32_bf16 v[224:227], a[120:123], v[80:83], v[224:227]
    v_cvt_pk_bf16_f32 v90, v52, v53
    v_mfma_f32_16x16x32_bf16 v[240:243], a[124:127], v[80:83], v[240:243]
    v_exp_f32 v54, v54
    v_mfma_f32_16x16x32_bf16 v[96:99], a[252:255], v[80:83], v[96:99]
    buffer_load_dwordx4 v119, s[40:43], s11 offen offset:3072 lds
    v_mfma_f32_16x16x32_bf16 v[132:135], a[96:99], v[84:87], v[132:135]
    v_exp_f32 v55, v55
    v_mfma_f32_16x16x32_bf16 v[148:151], a[100:103], v[84:87], v[148:151]
    v_cvt_pk_bf16_f32 v91, v54, v55
    v_mfma_f32_16x16x32_bf16 v[164:167], a[104:107], v[84:87], v[164:167]
    s_xor_b32 s52, s52, 0x8000
    v_mfma_f32_16x16x32_bf16 v[180:183], a[108:111], v[84:87], v[180:183]
    v_mfma_f32_16x16x32_bf16 v[196:199], a[112:115], v[84:87], v[196:199]
    v_exp_f32 v56, v56
    v_mfma_f32_16x16x32_bf16 v[212:215], a[116:119], v[84:87], v[212:215]
    s_add_u32 m0, s6, 8192
    s_nop 0
    buffer_load_dwordx4 v120, s[40:43], s11 offen offset:0 lds
    v_mfma_f32_16x16x32_bf16 v[228:231], a[120:123], v[84:87], v[228:231]
    v_exp_f32 v57, v57
    v_mfma_f32_16x16x32_bf16 v[244:247], a[124:127], v[84:87], v[244:247]
    v_cvt_pk_bf16_f32 v92, v56, v57
    s_waitcnt lgkmcnt(0)
    v_mfma_f32_16x16x32_bf16 v[100:103], a[252:255], v[84:87], v[100:103]
    v_exp_f32 v58, v58
    v_mfma_f32_16x16x32_bf16 v[32:35], a[64:67], a[0:3], v[64:67]
    s_waitcnt vmcnt(9)
    s_barrier
    v_mfma_f32_16x16x32_bf16 v[36:39], a[68:71], a[0:3], v[64:67]
    v_exp_f32 v59, v59
    v_mfma_f32_16x16x32_bf16 v[32:35], a[72:75], a[4:7], v[32:35]
    v_cvt_pk_bf16_f32 v93, v58, v59
    v_xor_b32 v12, s52, v12
    v_mfma_f32_16x16x32_bf16 v[36:39], a[76:79], a[4:7], v[36:39]
    v_exp_f32 v60, v60
    v_mfma_f32_16x16x32_bf16 v[32:35], a[80:83], a[8:11], v[32:35]
    v_xor_b32 v13, s52, v13
    v_xor_b32 v14, s52, v14
    v_mfma_f32_16x16x32_bf16 v[36:39], a[84:87], a[8:11], v[36:39]
    v_exp_f32 v61, v61
    v_mfma_f32_16x16x32_bf16 v[32:35], a[88:91], a[12:15], v[32:35]
    v_cvt_pk_bf16_f32 v94, v60, v61
    v_xor_b32 v15, s52, v15
    v_mfma_f32_16x16x32_bf16 v[36:39], a[92:95], a[12:15], v[36:39]
    v_exp_f32 v62, v62
    v_mfma_f32_16x16x32_bf16 v[136:139], a[96:99], v[88:91], v[136:139]
    v_xor_b32 v16, s52, v16
    v_xor_b32 v17, s52, v17
    v_mfma_f32_16x16x32_bf16 v[152:155], a[100:103], v[88:91], v[152:155]
    v_exp_f32 v63, v63
    v_mfma_f32_16x16x32_bf16 v[168:171], a[104:107], v[88:91], v[168:171]
    v_cvt_pk_bf16_f32 v95, v62, v63
    v_xor_b32 v18, s52, v18
    v_mfma_f32_16x16x32_bf16 v[184:187], a[108:111], v[88:91], v[184:187]
    v_exp_f32 v32, v32
    v_mfma_f32_16x16x32_bf16 v[200:203], a[112:115], v[88:91], v[200:203]
    s_add_u32 m0, s7, 0
    s_cbranch_vccnz L_wsk19
    buffer_load_dwordx4 v112, s[40:43], s12 offen offset:0 lds
L_wsk19:
    v_mfma_f32_16x16x32_bf16 v[216:219], a[116:119], v[88:91], v[216:219]
    v_exp_f32 v33, v33
    v_mfma_f32_16x16x32_bf16 v[232:235], a[120:123], v[88:91], v[232:235]
    v_cvt_pk_bf16_f32 v80, v32, v33
    v_xor_b32 v19, s52, v19
    v_mfma_f32_16x16x32_bf16 v[248:251], a[124:127], v[88:91], v[248:251]
    v_exp_f32 v34, v34
    v_mfma_f32_16x16x32_bf16 v[104:107], a[252:255], v[88:91], v[104:107]
    v_mfma_f32_16x16x32_bf16 v[40:43], a[64:67], a[16:19], v[68:71]
    v_exp_f32 v35, v35
    v_mfma_f32_16x16x32_bf16 v[44:47], a[68:71], a[16:19], v[68:71]
    v_cvt_pk_bf16_f32 v81, v34, v35
    v_xor_b32 v8, s52, v8
    v_mfma_f32_16x16x32_bf16 v[40:43], a[72:75], a[20:23], v[40:43]
    v_exp_f32 v36, v36
    v_mfma_f32_16x16x32_bf16 v[44:47], a[76:79], a[20:23], v[44:47]
    s_cbranch_vccnz L_wsk20
    buffer_load_dwordx4 v113, s[40:43], s12 offen offset:1024 lds
L_wsk20:
    v_xor_b32 v9, s52, v9
    v_xor_b32 v10, s52, v10
    v_mfma_f32_16x16x32_bf16 v[40:43], a[80:83], a[24:27], v[40:43]
    v_exp_f32 v37, v37
    v_mfma_f32_16x16x32_bf16 v[44:47], a[84:87], a[24:27], v[44:47]
    v_cvt_pk_bf16_f32 v82, v36, v37
    v_xor_b32 v11, s52, v11
    v_mfma_f32_16x16x32_bf16 v[40:43], a[88:91], a[28:31], v[40:43]
    v_exp_f32 v38, v38
    v_mfma_f32_16x16x32_bf16 v[44:47], a[92:95], a[28:31], v[44:47]
    v_mfma_f32_16x16x32_bf16 v[140:143], a[96:99], v[92:95], v[140:143]
    v_exp_f32 v39, v39
    v_mfma_f32_16x16x32_bf16 v[156:159], a[100:103], v[92:95], v[156:159]
    ds_read_b64_tr_b16 a[96:97], v12 offset:0
    v_cvt_pk_bf16_f32 v83, v38, v39
    v_mfma_f32_16x16x32_bf16 v[172:175], a[104:107], v[92:95], v[172:175]
    ds_read_b64_tr_b16 a[98:99], v12 offset:4096
    ds_read_b64_tr_b16 a[100:101], v13 offset:0
    v_mfma_f32_16x16x32_bf16 v[188:191], a[108:111], v[92:95], v[188:191]
    ds_read_b64_tr_b16 a[102:103], v13 offset:4096
    ds_read_b64_tr_b16 a[104:105], v14 offset:0
    v_mfma_f32_16x16x32_bf16 v[204:207], a[112:115], v[92:95], v[204:207]
    v_exp_f32 v40, v40
    v_mfma_f32_16x16x32_bf16 v[220:223], a[116:119], v[92:95], v[220:223]
    ds_read_b64_tr_b16 a[106:107], v14 offset:4096
    ds_read_b64_tr_b16 a[108:109], v15 offset:0
    v_mfma_f32_16x16x32_bf16 v[236:239], a[120:123], v[92:95], v[236:239]
    v_exp_f32 v41, v41
    v_mfma_f32_16x16x32_bf16 v[252:255], a[124:127], v[92:95], v[252:255]
    ds_read_b64_tr_b16 a[110:111], v15 offset:4096
    v_cvt_pk_bf16_f32 v84, v40, v41
    v_mfma_f32_16x16x32_bf16 v[108:111], a[252:255], v[92:95], v[108:111]
    v_exp_f32 v42, v42
    v_mfma_f32_16x16x32_bf16 v[48:51], a[64:67], a[32:35], v[72:75]
    ds_read_b64_tr_b16 a[112:113], v16 offset:0
    ds_read_b64_tr_b16 a[114:115], v16 offset:4096
    v_mfma_f32_16x16x32_bf16 v[52:55], a[68:71], a[32:35], v[72:75]
    v_exp_f32 v43, v43
    v_mfma_f32_16x16x32_bf16 v[48:51], a[72:75], a[36:39], v[48:51]
    ds_read_b64_tr_b16 a[116:117], v17 offset:0
    v_cvt_pk_bf16_f32 v85, v42, v43
    v_mfma_f32_16x16x32_bf16 v[52:55], a[76:79], a[36:39], v[52:55]
    v_exp_f32 v44, v44
    v_mfma_f32_16x16x32_bf16 v[48:51], a[80:83], a[40:43], v[48:51]
    ds_read_b64_tr_b16 a[118:119], v17 offset:4096
    ds_read_b64_tr_b16 a[120:121], v18 offset:0
    v_mfma_f32_16x16x32_bf16 v[52:55], a[84:87], a[40:43], v[52:55]
    v_exp_f32 v45, v45
    v_mfma_f32_16x16x32_bf16 v[48:51], a[88:91], a[44:47], v[48:51]
    ds_read_b64_tr_b16 a[122:123], v18 offset:4096
    v_cvt_pk_bf16_f32 v86, v44, v45
    v_mfma_f32_16x16x32_bf16 v[52:55], a[92:95], a[44:47], v[52:55]
    v_exp_f32 v46, v46
    v_mfma_f32_16x16x32_bf16 v[56:59], a[64:67], a[48:51], v[76:79]
    ds_read_b64_tr_b16 a[124:125], v19 offset:0
    ds_read_b64_tr_b16 a[126:127], v19 offset:4096
    v_mfma_f32_16x16x32_bf16 v[60:63], a[68:71], a[48:51], v[76:79]
    v_exp_f32 v47, v47
    v_mfma_f32_16x16x32_bf16 v[56:59], a[72:75], a[52:55], v[56:59]
    s_cbranch_vccnz L_wsk21
    buffer_load_dwordx4 v114, s[40:43], s12 offen offset:2048 lds
L_wsk21:
    v_cvt_pk_bf16_f32 v87, v46, v47
    v_mfma_f32_16x16x32_bf16 v[60:63], a[76:79], a[52:55], v[60:63]
    v_exp_f32 v48, v48
    v_mfma_f32_16x16x32_bf16 v[56:59], a[80:83], a[56:59], v[56:59]
    v_mfma_f32_16x16x32_bf16 v[60:63], a[84:87], a[56:59], v[60:63]
    v_exp_f32 v49, v49
    v_mfma_f32_16x16x32_bf16 v[56:59], a[88:91], a[60:63], v[56:59]
    v_cvt_pk_bf16_f32 v88, v48, v49
    s_waitcnt lgkmcnt(0)
    v_mfma_f32_16x16x32_bf16 v[60:63], a[92:95], a[60:63], v[60:63]
    v_exp_f32 v50, v50
    v_mfma_f32_16x16x32_bf16 v[128:131], a[96:99], v[80:83], v[128:131]
    s_cbranch_vccnz L_wsk22
    buffer_load_dwordx4 v115, s[40:43], s12 offen offset:3072 lds
L_wsk22:
    v_mfma_f32_16x16x32_bf16 v[144:147], a[100:103], v[80:83], v[144:147]
    v_exp_f32 v51, v51
    v_mfma_f32_16x16x32_bf16 v[160:163], a[104:107], v[80:83], v[160:163]
    v_cvt_pk_bf16_f32 v89, v50, v51
    v_mfma_f32_16x16x32_bf16 v[176:179], a[108:111], v[80:83], v[176:179]
    v_exp_f32 v52, v52
    v_mfma_f32_16x16x32_bf16 v[192:195], a[112:115], v[80:83], v[192:195]
    v_mfma_f32_16x16x32_bf16 v[208:211], a[116:119], v[80:83], v[208:211]
    v_exp_f32 v53, v53
    v_mfma_f32_16x16x32_bf16 v[224:227], a[120:123], v[80:83], v[224:227]
    s_add_u32 m0, s7, 4096
    s_cbranch_vccnz L_wsk23
    buffer_load_dwordx4 v116, s[40:43], s12 offen offset:0 lds
L_wsk23:
    v_cvt_pk_bf16_f32 v90, v52, v53
    v_mfma_f32_16x16x32_bf16 v[240:243], a[124:127], v[80:83], v[240:243]
    v_exp_f32 v54, v54
    v_mfma_f32_16x16x32_bf16 v[96:99], a[252:255], v[80:83], v[96:99]
    v_mfma_f32_16x16x32_bf16 v[132:135], a[96:99], v[84:87], v[132:135]
    v_exp_f32 v55, v55
    v_mfma_f32_16x16x32_bf16 v[148:151], a[100:103], v[84:87], v[148:151]
    s_cbranch_vccnz L_wsk24
    buffer_load_dwordx4 v117, s[40:43], s12 offen offset:1024 lds
L_wsk24:
    v_cvt_pk_bf16_f32 v91, v54, v55
    v_mfma_f32_16x16x32_bf16 v[164:167], a[104:107], v[84:87], v[164:167]
    v_mfma_f32_16x16x32_bf16 v[180:183], a[108:111], v[84:87], v[180:183]
    v_mfma_f32_16x16x32_bf16 v[196:199], a[112:115], v[84:87], v[196:199]
    v_exp_f32 v56, v56
    v_mfma_f32_16x16x32_bf16 v[212:215], a[116:119], v[84:87], v[212:215]
    s_cbranch_vccnz L_wsk25
    buffer_load_dwordx4 v118, s[40:43], s12 offen offset:2048 lds
L_wsk25:
    v_mfma_f32_16x16x32_bf16 v[228:231], a[120:123], v[84:87], v[228:231]
    v_exp_f32 v57, v57
    v_mfma_f32_16x16x32_bf16 v[244:247], a[124:127], v[84:87], v[244:247]
    v_cvt_pk_bf16_f32 v92, v56, v57
    v_mfma_f32_16x16x32_bf16 v[100:103], a[252:255], v[84:87], v[100:103]
    v_exp_f32 v58, v58
    v_exp_f32 v59, v59
    s_cbranch_vccnz L_wsk26
    buffer_load_dwordx4 v119, s[40:43], s12 offen offset:3072 lds
L_wsk26:
    s_nop 0
    v_cvt_pk_bf16_f32 v93, v58, v59
    v_exp_f32 v60, v60
    v_exp_f32 v61, v61
    s_add_u32 m0, s7, 8192
    s_cbranch_vccnz L_wsk27
    buffer_load_dwordx4 v120, s[40:43], s12 offen offset:0 lds
L_wsk27:
    s_nop 0
    v_cvt_pk_bf16_f32 v94, v60, v61
    v_exp_f32 v62, v62
    s_nop 1
    v_mfma_f32_16x16x32_bf16 v[136:139], a[96:99], v[88:91], v[136:139]
    v_mfma_f32_16x16x32_bf16 v[152:155], a[100:103], v[88:91], v[152:155]
    v_exp_f32 v63, v63
    v_mfma_f32_16x16x32_bf16 v[168:171], a[104:107], v[88:91], v[168:171]
    v_cvt_pk_bf16_f32 v95, v62, v63
    v_mfma_f32_16x16x32_bf16 v[184:187], a[108:111], v[88:91], v[184:187]
    v_mfma_f32_16x16x32_bf16 v[200:203], a[112:115], v[88:91], v[200:203]
    v_mfma_f32_16x16x32_bf16 v[216:219], a[116:119], v[88:91], v[216:219]
    v_mfma_f32_16x16x32_bf16 v[232:235], a[120:123], v[88:91], v[232:235]
    v_mfma_f32_16x16x32_bf16 v[248:251], a[124:127], v[88:91], v[248:251]
    v_mfma_f32_16x16x32_bf16 v[104:107], a[252:255], v[88:91], v[104:107]
    v_mfma_f32_16x16x32_bf16 v[140:143], a[96:99], v[92:95], v[140:143]
    v_mfma_f32_16x16x32_bf16 v[156:159], a[100:103], v[92:95], v[156:159]
    v_mfma_f32_16x16x32_bf16 v[172:175], a[104:107], v[92:95], v[172:175]
    v_mfma_f32_16x16x32_bf16 v[188:191], a[108:111], v[92:95], v[188:191]
    v_mfma_f32_16x16x32_bf16 v[204:207], a[112:115], v[92:95], v[204:207]
    v_mfma_f32_16x16x32_bf16 v[220:223], a[116:119], v[92:95], v[220:223]
    v_mfma_f32_16x16x32_bf16 v[236:239], a[120:123], v[92:95], v[236:239]
    v_mfma_f32_16x16x32_bf16 v[252:255], a[124:127], v[92:95], v[252:255]
    v_mfma_f32_16x16x32_bf16 v[108:111], a[252:255], v[92:95], v[108:111]
    s_nop 4
    v_rcp_f32 v2, v96
    v_rcp_f32 v4, v100
    v_rcp_f32 v6, v104
    v_rcp_f32 v122, v108
    s_mov_b32 s54, 0x6f800000
    v_mov_b32 v31, s54
    s_mov_b64 s[88:89], 0
    v_cmp_nlt_f32 vcc, v96, v31
    s_nop 0
    s_or_b64 s[88:89], s[88:89], vcc
    v_cmp_nlt_f32 vcc, v100, v31
    s_nop 0
    s_or_b64 s[88:89], s[88:89], vcc
    v_cmp_nlt_f32 vcc, v104, v31
    s_nop 0
    s_or_b64 s[88:89], s[88:89], vcc
    v_cmp_nlt_f32 vcc, v108, v31
    s_nop 0
    s_or_b64 s[88:89], s[88:89], vcc
    v_lshlrev_b32 v12, 4, v1
    v_mov_b32 v3, v2
    v_mov_b32 v5, v4
    v_mov_b32 v7, v6
    v_mov_b32 v123, v122
    v_add_u32 v13, 4096, v12
    v_add_u32 v14, 8192, v12
    v_add_u32 v15, 12288, v12
    v_pk_mul_f32 v[128:129], v[128:129], v[2:3]
    v_pk_mul_f32 v[130:131], v[130:131], v[2:3]
    v_pk_mul_f32 v[144:145], v[144:145], v[2:3]
    v_pk_mul_f32 v[146:147], v[146:147], v[2:3]
    v_cvt_pk_bf16_f32 v32, v128, v129
    v_cvt_pk_bf16_f32 v33, v130, v131
    v_cvt_pk_bf16_f32 v34, v144, v145
    v_cvt_pk_bf16_f32 v35, v146, v147
    buffer_store_dwordx4 v[32:35], v12, s[36:39], s99 offen offset:0 sc1
    v_pk_mul_f32 v[132:133], v[132:133], v[4:5]
    v_pk_mul_f32 v[134:135], v[134:135], v[4:5]
    v_pk_mul_f32 v[148:149], v[148:149], v[4:5]
    v_pk_mul_f32 v[150:151], v[150:151], v[4:5]
    v_mfma_f32_16x16x32_bf16 v[108:111], a[188:191], v[32:35], 0
    v_cvt_pk_bf16_f32 v48, v132, v133
    v_cvt_pk_bf16_f32 v49, v134, v135
    v_cvt_pk_bf16_f32 v50, v148, v149
    v_cvt_pk_bf16_f32 v51, v150, v151
    buffer_store_dwordx4 v[48:51], v13, s[36:39], s99 offen offset:0 sc1
    v_pk_mul_f32 v[136:137], v[136:137], v[6:7]
    v_pk_mul_f32 v[138:139], v[138:139], v[6:7]
    v_pk_mul_f32 v[152:153], v[152:153], v[6:7]
    v_pk_mul_f32 v[154:155], v[154:155], v[6:7]
    v_mfma_f32_16x16x32_bf16 v[108:111], a[188:191], v[48:51], v[108:111]
    v_cvt_pk_bf16_f32 v64, v136, v137
    v_cvt_pk_bf16_f32 v65, v138, v139
    v_cvt_pk_bf16_f32 v66, v152, v153
    v_cvt_pk_bf16_f32 v67, v154, v155
    buffer_store_dwordx4 v[64:67], v14, s[36:39], s99 offen offset:0 sc1
    v_pk_mul_f32 v[140:141], v[140:141], v[122:123]
    v_pk_mul_f32 v[142:143], v[142:143], v[122:123]
    v_pk_mul_f32 v[156:157], v[156:157], v[122:123]
    v_pk_mul_f32 v[158:159], v[158:159], v[122:123]
    v_mfma_f32_16x16x32_bf16 v[108:111], a[188:191], v[64:67], v[108:111]
    v_cvt_pk_bf16_f32 v80, v140, v141
    v_cvt_pk_bf16_f32 v81, v142, v143
    v_cvt_pk_bf16_f32 v82, v156, v157
    v_cvt_pk_bf16_f32 v83, v158, v159
    buffer_store_dwordx4 v[80:83], v15, s[36:39], s99 offen offset:0 sc1
    v_pk_mul_f32 v[160:161], v[160:161], v[2:3]
    v_pk_mul_f32 v[162:163], v[162:163], v[2:3]
    v_pk_mul_f32 v[176:177], v[176:177], v[2:3]
    v_pk_mul_f32 v[178:179], v[178:179], v[2:3]
    v_mfma_f32_16x16x32_bf16 v[108:111], a[188:191], v[80:83], v[108:111]
    v_cvt_pk_bf16_f32 v36, v160, v161
    v_cvt_pk_bf16_f32 v37, v162, v163
    v_cvt_pk_bf16_f32 v38, v176, v177
    v_cvt_pk_bf16_f32 v39, v178, v179
    buffer_store_dwordx4 v[36:39], v12, s[36:39], s99 offen offset:1024 sc1
    v_pk_mul_f32 v[164:165], v[164:165], v[4:5]
    v_pk_mul_f32 v[166:167], v[166:167], v[4:5]
    v_pk_mul_f32 v[180:181], v[180:181], v[4:5]
    v_pk_mul_f32 v[182:183], v[182:183], v[4:5]
    v_mfma_f32_16x16x32_bf16 v[108:111], a[188:191], v[36:39], v[108:111]
    v_cvt_pk_bf16_f32 v52, v164, v165
    v_cvt_pk_bf16_f32 v53, v166, v167
    v_cvt_pk_bf16_f32 v54, v180, v181
    v_cvt_pk_bf16_f32 v55, v182, v183
    buffer_store_dwordx4 v[52:55], v13, s[36:39], s99 offen offset:1024 sc1
    v_pk_mul_f32 v[168:169], v[168:169], v[6:7]
    v_pk_mul_f32 v[170:171], v[170:171], v[6:7]
    v_pk_mul_f32 v[184:185], v[184:185], v[6:7]
    v_pk_mul_f32 v[186:187], v[186:187], v[6:7]
    v_mfma_f32_16x16x32_bf16 v[108:111], a[188:191], v[52:55], v[108:111]
    v_cvt_pk_bf16_f32 v68, v168, v169
    v_cvt_pk_bf16_f32 v69, v170, v171
    v_cvt_pk_bf16_f32 v70, v184, v185
    v_cvt_pk_bf16_f32 v71, v186, v187
    buffer_store_dwordx4 v[68:71], v14, s[36:39], s99 offen offset:1024 sc1
    v_pk_mul_f32 v[172:173], v[172:173], v[122:123]
    v_pk_mul_f32 v[174:175], v[174:175], v[122:123]
    v_pk_mul_f32 v[188:189], v[188:189], v[122:123]
    v_pk_mul_f32 v[190:191], v[190:191], v[122:123]
    v_mfma_f32_16x16x32_bf16 v[108:111], a[188:191], v[68:71], v[108:111]
    v_cvt_pk_bf16_f32 v84, v172, v173
    v_cvt_pk_bf16_f32 v85, v174, v175
    v_cvt_pk_bf16_f32 v86, v188, v189
    v_cvt_pk_bf16_f32 v87, v190, v191
    buffer_store_dwordx4 v[84:87], v15, s[36:39], s99 offen offset:1024 sc1
    v_pk_mul_f32 v[192:193], v[192:193], v[2:3]
    v_pk_mul_f32 v[194:195], v[194:195], v[2:3]
    v_pk_mul_f32 v[208:209], v[208:209], v[2:3]
    v_pk_mul_f32 v[210:211], v[210:211], v[2:3]
    v_mfma_f32_16x16x32_bf16 v[108:111], a[188:191], v[84:87], v[108:111]
    v_cvt_pk_bf16_f32 v40, v192, v193
    v_cvt_pk_bf16_f32 v41, v194, v195
    v_cvt_pk_bf16_f32 v42, v208, v209
    v_cvt_pk_bf16_f32 v43, v210, v211
    buffer_store_dwordx4 v[40:43], v12, s[36:39], s99 offen offset:2048 sc1
    v_pk_mul_f32 v[196:197], v[196:197], v[4:5]
    v_pk_mul_f32 v[198:199], v[198:199], v[4:5]
    v_pk_mul_f32 v[212:213], v[212:213], v[4:5]
    v_pk_mul_f32 v[214:215], v[214:215], v[4:5]
    v_mfma_f32_16x16x32_bf16 v[108:111], a[188:191], v[40:43], v[108:111]
    v_cvt_pk_bf16_f32 v56, v196, v197
    v_cvt_pk_bf16_f32 v57, v198, v199
    v_cvt_pk_bf16_f32 v58, v212, v213
    v_cvt_pk_bf16_f32 v59, v214, v215
    buffer_store_dwordx4 v[56:59], v13, s[36:39], s99 offen offset:2048 sc1
    v_pk_mul_f32 v[200:201], v[200:201], v[6:7]
    v_pk_mul_f32 v[202:203], v[202:203], v[6:7]
    v_pk_mul_f32 v[216:217], v[216:217], v[6:7]
    v_pk_mul_f32 v[218:219], v[218:219], v[6:7]
    v_mfma_f32_16x16x32_bf16 v[108:111], a[188:191], v[56:59], v[108:111]
    v_cvt_pk_bf16_f32 v72, v200, v201
    v_cvt_pk_bf16_f32 v73, v202, v203
    v_cvt_pk_bf16_f32 v74, v216, v217
    v_cvt_pk_bf16_f32 v75, v218, v219
    buffer_store_dwordx4 v[72:75], v14, s[36:39], s99 offen offset:2048 sc1
    v_pk_mul_f32 v[204:205], v[204:205], v[122:123]
    v_pk_mul_f32 v[206:207], v[206:207], v[122:123]
    v_pk_mul_f32 v[220:221], v[220:221], v[122:123]
    v_pk_mul_f32 v[222:223], v[222:223], v[122:123]
    v_mfma_f32_16x16x32_bf16 v[108:111], a[188:191], v[72:75], v[108:111]
    v_cvt_pk_bf16_f32 v88, v204, v205
    v_cvt_pk_bf16_f32 v89, v206, v207
    v_cvt_pk_bf16_f32 v90, v220, v221
    v_cvt_pk_bf16_f32 v91, v222, v223
    buffer_store_dwordx4 v[88:91], v15, s[36:39], s99 offen offset:2048 sc1
    v_pk_mul_f32 v[224:225], v[224:225], v[2:3]
    v_pk_mul_f32 v[226:227], v[226:227], v[2:3]
    v_pk_mul_f32 v[240:241], v[240:241], v[2:3]
    v_pk_mul_f32 v[242:243], v[242:243], v[2:3]
    v_mfma_f32_16x16x32_bf16 v[108:111], a[188:191], v[88:91], v[108:111]
    v_cvt_pk_bf16_f32 v44, v224, v225
    v_cvt_pk_bf16_f32 v45, v226, v227
    v_cvt_pk_bf16_f32 v46, v240, v241
    v_cvt_pk_bf16_f32 v47, v242, v243
    buffer_store_dwordx4 v[44:47], v12, s[36:39], s99 offen offset:3072 sc1
    v_pk_mul_f32 v[228:229], v[228:229], v[4:5]
    v_pk_mul_f32 v[230:231], v[230:231], v[4:5]
    v_pk_mul_f32 v[244:245], v[244:245], v[4:5]
    v_pk_mul_f32 v[246:247], v[246:247], v[4:5]
    v_mfma_f32_16x16x32_bf16 v[108:111], a[188:191], v[44:47], v[108:111]
    v_cvt_pk_bf16_f32 v60, v228, v229
    v_cvt_pk_bf16_f32 v61, v230, v231
    v_cvt_pk_bf16_f32 v62, v244, v245
    v_cvt_pk_bf16_f32 v63, v246, v247
    buffer_store_dwordx4 v[60:63], v13, s[36:39], s99 offen offset:3072 sc1
    v_pk_mul_f32 v[232:233], v[232:233], v[6:7]
    v_pk_mul_f32 v[234:235], v[234:235], v[6:7]
    v_pk_mul_f32 v[248:249], v[248:249], v[6:7]
    v_pk_mul_f32 v[250:251], v[250:251], v[6:7]
    v_mfma_f32_16x16x32_bf16 v[108:111], a[188:191], v[60:63], v[108:111]
    v_cvt_pk_bf16_f32 v76, v232, v233
    v_cvt_pk_bf16_f32 v77, v234, v235
    v_cvt_pk_bf16_f32 v78, v248, v249
    v_cvt_pk_bf16_f32 v79, v250, v251
    buffer_store_dwordx4 v[76:79], v14, s[36:39], s99 offen offset:3072 sc1
    v_pk_mul_f32 v[236:237], v[236:237], v[122:123]
    v_pk_mul_f32 v[238:239], v[238:239], v[122:123]
    v_pk_mul_f32 v[252:253], v[252:253], v[122:123]
    v_pk_mul_f32 v[254:255], v[254:255], v[122:123]
    v_mfma_f32_16x16x32_bf16 v[108:111], a[188:191], v[76:79], v[108:111]
    v_cvt_pk_bf16_f32 v92, v236, v237
    v_cvt_pk_bf16_f32 v93, v238, v239
    v_cvt_pk_bf16_f32 v94, v252, v253
    v_cvt_pk_bf16_f32 v95, v254, v255
    buffer_store_dwordx4 v[92:95], v15, s[36:39], s99 offen offset:3072 sc1
    s_nop 1
    v_mfma_f32_16x16x32_bf16 v[108:111], a[188:191], v[92:95], v[108:111]
    v_mov_b32 v96, v112
    v_mov_b32 v97, v113
    v_mov_b32 v98, v114
    v_mov_b32 v99, v115
    v_mov_b32 v100, v116
    v_mov_b32 v101, v117
    v_mov_b32 v102, v118
    v_mov_b32 v103, v119
    v_mov_b32 v104, v120
    s_lshl_b32 s54, s3, 2
    s_add_u32 s54, s54, 64512
    v_mov_b32 v2, s54
    v_mov_b32 v20, 1
    s_nop 3
    v_cmp_u_f32 vcc, v108, v108
    s_nop 0
    s_or_b64 s[88:89], s[88:89], vcc
    s_cmp_lg_u64 s[88:89], 0
    s_cselect_b32 s54, 1, 0
    v_mov_b32 v3, s54
    ds_write_b32 v2, v3
    v_mov_b32 v4, 64512
    s_waitcnt vmcnt(16) lgkmcnt(0)
    s_barrier
    ds_read_b128 v[124:127], v4
    v_readfirstlane_b32 s90, v30
    v_lshrrev_b32 v30, 4, v1
    v_bfe_u32 v31, v1, 2, 2
    v_lshl_add_u32 v30, v30, 2, v31
    v_mul_u32_u24 v30, 288, v30
    v_and_b32 v31, 3, v1
    v_lshl_add_u32 v8, v31, 3, v30
    v_add_u32 v9, 61440, v8
    v_add_u32 v10, 122880, v8
    v_lshlrev_b32 v11, 3, v1
    v_add_u32 v11, 4096, v11
    v_mov_b32 v20, 1
    s_lshl_b32 s54, s3, 2
    v_mov_b32 v21, s54
    s_lshl_b32 s54, s3, 3
    s_add_u32 s54, s54, 16
    v_mov_b32 v24, s54
    s_add_u32 s54, s54, 4
    v_mov_b32 v25, s54
    s_waitcnt lgkmcnt(0)
    v_or_b32 v124, v124, v125
    v_or3_b32 v124, v124, v126, v127
    s_nop 0
    v_readfirstlane_b32 s54, v124
    s_andn2_b32 s54, s54, s67
    s_cmp_lg_u32 s54, 0
    s_cbranch_scc1 L_fallback
    s_cmp_eq_u32 s3, 3
    s_cselect_b64 vcc, -1, 0
    ds_read_b64_tr_b16 a[192:193], v10 offset:14336
    ds_read_b64_tr_b16 a[194:195], v10 offset:18944
    ds_read_b64_tr_b16 a[196:197], v10 offset:14368
    ds_read_b64_tr_b16 a[198:199], v10 offset:18976
    ds_read_b64_tr_b16 a[200:201], v10 offset:14400
    ds_read_b64_tr_b16 a[202:203], v10 offset:19008
    ds_read_b64_tr_b16 a[204:205], v10 offset:14432
    ds_read_b64_tr_b16 a[206:207], v10 offset:19040
    ds_read_b64_tr_b16 a[208:209], v10 offset:14464
    ds_read_b64_tr_b16 a[210:211], v10 offset:19072
    ds_read_b64_tr_b16 a[212:213], v10 offset:14496
    ds_read_b64_tr_b16 a[214:215], v10 offset:19104
    s_waitcnt vmcnt(0)
    s_mov_b64 exec, 1
    buffer_store_dword v20, v21, s[36:39], s91 offen
    buffer_store_dword v20, v21, s[36:39], s101 offen sc1
    s_mov_b64 exec, -1
    s_waitcnt lgkmcnt(10)
    v_mfma_f32_16x16x32_bf16 v[112:115], a[192:195], v[32:35], 0
    ds_read_b64_tr_b16 a[216:217], v10 offset:14528
    ds_read_b64_tr_b16 a[218:219], v10 offset:19136
    v_mfma_f32_16x16x32_bf16 v[116:119], a[192:195], v[48:51], 0
    v_mfma_f32_16x16x32_bf16 v[120:123], a[192:195], v[64:67], 0
    v_mfma_f32_16x16x32_bf16 v[124:127], a[192:195], v[80:83], 0
    s_waitcnt lgkmcnt(10)
    v_mfma_f32_16x16x32_bf16 v[128:131], a[196:199], v[32:35], 0
    ds_read_b64_tr_b16 a[220:221], v10 offset:14560
    ds_read_b64_tr_b16 a[222:223], v10 offset:19168
    v_mfma_f32_16x16x32_bf16 v[132:135], a[196:199], v[48:51], 0
    s_add_u32 m0, s8, 0
    s_cbranch_vccnz L_wsk28
    buffer_load_dwordx4 v96, s[40:43], s13 offen offset:0 lds
L_wsk28:
    v_mfma_f32_16x16x32_bf16 v[136:139], a[196:199], v[64:67], 0
    v_mfma_f32_16x16x32_bf16 v[140:143], a[196:199], v[80:83], 0
    s_waitcnt lgkmcnt(10)
    v_mfma_f32_16x16x32_bf16 v[144:147], a[200:203], v[32:35], 0
    ds_read_b64_tr_b16 a[224:225], v10 offset:14592
    ds_read_b64_tr_b16 a[226:227], v10 offset:19200
    v_mfma_f32_16x16x32_bf16 v[148:151], a[200:203], v[48:51], 0
    v_mfma_f32_16x16x32_bf16 v[152:155], a[200:203], v[64:67], 0
    v_mfma_f32_16x16x32_bf16 v[156:159], a[200:203], v[80:83], 0
    s_waitcnt lgkmcnt(10)
    v_mfma_f32_16x16x32_bf16 v[160:163], a[204:207], v[32:35], 0
    ds_read_b64_tr_b16 a[228:229], v10 offset:23552
    ds_read_b64_tr_b16 a[230:231], v10 offset:28160
    v_mfma_f32_16x16x32_bf16 v[164:167], a[204:207], v[48:51], 0
    s_cbranch_vccnz L_wsk29
    buffer_load_dwordx4 v97, s[40:43], s13 offen offset:1024 lds
L_wsk29:
    v_mfma_f32_16x16x32_bf16 v[168:171], a[204:207], v[64:67], 0
    v_mfma_f32_16x16x32_bf16 v[172:175], a[204:207], v[80:83], 0
    s_waitcnt lgkmcnt(10)
    v_mfma_f32_16x16x32_bf16 v[176:179], a[208:211], v[32:35], 0
    ds_read_b64_tr_b16 a[232:233], v10 offset:23584
    ds_read_b64_tr_b16 a[234:235], v10 offset:28192
    v_mfma_f32_16x16x32_bf16 v[180:183], a[208:211], v[48:51], 0
    v_mfma_f32_16x16x32_bf16 v[184:187], a[208:211], v[64:67], 0
    v_mfma_f32_16x16x32_bf16 v[188:191], a[208:211], v[80:83], 0
    s_waitcnt lgkmcnt(10)
    v_mfma_f32_16x16x32_bf16 v[192:195], a[212:215], v[32:35], 0
    ds_read_b64_tr_b16 a[236:237], v10 offset:23616
    ds_read_b64_tr_b16 a[238:239], v10 offset:28224
    v_mfma_f32_16x16x32_bf16 v[196:199], a[212:215], v[48:51], 0
    s_cbranch_vccnz L_wsk30
    buffer_load_dwordx4 v98, s[40:43], s13 offen offset:2048 lds
L_wsk30:
    v_mfma_f32_16x16x32_bf16 v[200:203], a[212:215], v[64:67], 0
    v_mfma_f32_16x16x32_bf16 v[204:207], a[212:215], v[80:83], 0
    s_waitcnt lgkmcnt(10)
    v_mfma_f32_16x16x32_bf16 v[208:211], a[216:219], v[32:35], 0
    ds_read_b64_tr_b16 a[240:241], v10 offset:23648
    ds_read_b64_tr_b16 a[242:243], v10 offset:28256
    v_mfma_f32_16x16x32_bf16 v[212:215], a[216:219], v[48:51], 0
    v_mfma_f32_16x16x32_bf16 v[216:219], a[216:219], v[64:67], 0
    v_mfma_f32_16x16x32_bf16 v[220:223], a[216:219], v[80:83], 0
    s_waitcnt lgkmcnt(10)
    v_mfma_f32_16x16x32_bf16 v[224:227], a[220:223], v[32:35], 0
    ds_read_b64_tr_b16 a[244:245], v10 offset:23680
    ds_read_b64_tr_b16 a[246:247], v10 offset:28288
    v_mfma_f32_16x16x32_bf16 v[228:231], a[220:223], v[48:51], 0
    s_cbranch_vccnz L_wsk31
    buffer_load_dwordx4 v99, s[40:43], s13 offen offset:3072 lds
L_wsk31:
    v_mfma_f32_16x16x32_bf16 v[232:235], a[220:223], v[64:67], 0
    v_mfma_f32_16x16x32_bf16 v[236:239], a[220:223], v[80:83], 0
    s_waitcnt lgkmcnt(10)
    v_mfma_f32_16x16x32_bf16 v[240:243], a[224:227], v[32:35], 0
    ds_read_b64_tr_b16 a[248:249], v10 offset:23712
    ds_read_b64_tr_b16 a[250:251], v10 offset:28320
    v_mfma_f32_16x16x32_bf16 v[244:247], a[224:227], v[48:51], 0
    v_mfma_f32_16x16x32_bf16 v[248:251], a[224:227], v[64:67], 0
    v_mfma_f32_16x16x32_bf16 v[252:255], a[224:227], v[80:83], 0
    s_waitcnt lgkmcnt(10)
    v_mfma_f32_16x16x32_bf16 v[112:115], a[228:231], v[36:39], v[112:115]
    ds_read_b64_tr_b16 a[252:253], v10 offset:23744
    ds_read_b64_tr_b16 a[254:255], v10 offset:28352
    v_mfma_f32_16x16x32_bf16 v[116:119], a[228:231], v[52:55], v[116:119]
    s_add_u32 m0, s8, 4096
    s_cbranch_vccnz L_wsk32
    buffer_load_dwordx4 v100, s[40:43], s13 offen offset:0 lds
L_wsk32:
    v_mfma_f32_16x16x32_bf16 v[120:123], a[228:231], v[68:71], v[120:123]
    v_mfma_f32_16x16x32_bf16 v[124:127], a[228:231], v[84:87], v[124:127]
    s_waitcnt lgkmcnt(10)
    v_mfma_f32_16x16x32_bf16 v[128:131], a[232:235], v[36:39], v[128:131]
    ds_read_b64_tr_b16 a[192:193], v10 offset:23776
    ds_read_b64_tr_b16 a[194:195], v10 offset:28384
    v_mfma_f32_16x16x32_bf16 v[132:135], a[232:235], v[52:55], v[132:135]
    v_mfma_f32_16x16x32_bf16 v[136:139], a[232:235], v[68:71], v[136:139]
    v_mfma_f32_16x16x32_bf16 v[140:143], a[232:235], v[84:87], v[140:143]
    s_waitcnt lgkmcnt(10)
    v_mfma_f32_16x16x32_bf16 v[144:147], a[236:239], v[36:39], v[144:147]
    ds_read_b64_tr_b16 a[196:197], v10 offset:23808
    ds_read_b64_tr_b16 a[198:199], v10 offset:28416
    v_mfma_f32_16x16x32_bf16 v[148:151], a[236:239], v[52:55], v[148:151]
    s_cbranch_vccnz L_wsk33
    buffer_load_dwordx4 v101, s[40:43], s13 offen offset:1024 lds
L_wsk33:
    v_mfma_f32_16x16x32_bf16 v[152:155], a[236:239], v[68:71], v[152:155]
    v_mfma_f32_16x16x32_bf16 v[156:159], a[236:239], v[84:87], v[156:159]
    s_waitcnt lgkmcnt(10)
    v_mfma_f32_16x16x32_bf16 v[160:163], a[240:243], v[36:39], v[160:163]
    ds_read_b64_tr_b16 a[200:201], v8 offset:0
    ds_read_b64_tr_b16 a[202:203], v8 offset:4608
    v_mfma_f32_16x16x32_bf16 v[164:167], a[240:243], v[52:55], v[164:167]
    v_mfma_f32_16x16x32_bf16 v[168:171], a[240:243], v[68:71], v[168:171]
    v_mfma_f32_16x16x32_bf16 v[172:175], a[240:243], v[84:87], v[172:175]
    s_waitcnt lgkmcnt(10)
    v_mfma_f32_16x16x32_bf16 v[176:179], a[244:247], v[36:39], v[176:179]
    ds_read_b64_tr_b16 a[204:205], v8 offset:32
    ds_read_b64_tr_b16 a[206:207], v8 offset:4640
    v_mfma_f32_16x16x32_bf16 v[180:183], a[244:247], v[52:55], v[180:183]
    s_cbranch_vccnz L_wsk34
    buffer_load_dwordx4 v102, s[40:43], s13 offen offset:2048 lds
L_wsk34:
    v_mfma_f32_16x16x32_bf16 v[184:187], a[244:247], v[68:71], v[184:187]
    v_mfma_f32_16x16x32_bf16 v[188:191], a[244:247], v[84:87], v[188:191]
    s_waitcnt lgkmcnt(10)
    v_mfma_f32_16x16x32_bf16 v[192:195], a[248:251], v[36:39], v[192:195]
    ds_read_b64_tr_b16 a[208:209], v8 offset:64
    ds_read_b64_tr_b16 a[210:211], v8 offset:4672
    v_mfma_f32_16x16x32_bf16 v[196:199], a[248:251], v[52:55], v[196:199]
    v_mfma_f32_16x16x32_bf16 v[200:203], a[248:251], v[68:71], v[200:203]
    v_mfma_f32_16x16x32_bf16 v[204:207], a[248:251], v[84:87], v[204:207]
    s_waitcnt lgkmcnt(10)
    v_mfma_f32_16x16x32_bf16 v[208:211], a[252:255], v[36:39], v[208:211]
    ds_read_b64_tr_b16 a[212:213], v8 offset:96
    ds_read_b64_tr_b16 a[214:215], v8 offset:4704
    v_mfma_f32_16x16x32_bf16 v[212:215], a[252:255], v[52:55], v[212:215]
    s_cbranch_vccnz L_wsk35
    buffer_load_dwordx4 v103, s[40:43], s13 offen offset:3072 lds
L_wsk35:
    v_mfma_f32_16x16x32_bf16 v[216:219], a[252:255], v[68:71], v[216:219]
    v_mfma_f32_16x16x32_bf16 v[220:223], a[252:255], v[84:87], v[220:223]
    s_waitcnt lgkmcnt(10)
    v_mfma_f32_16x16x32_bf16 v[224:227], a[192:195], v[36:39], v[224:227]
    ds_read_b64_tr_b16 a[216:217], v8 offset:128
    ds_read_b64_tr_b16 a[218:219], v8 offset:4736
    v_mfma_f32_16x16x32_bf16 v[228:231], a[192:195], v[52:55], v[228:231]
    v_mfma_f32_16x16x32_bf16 v[232:235], a[192:195], v[68:71], v[232:235]
    v_mfma_f32_16x16x32_bf16 v[236:239], a[192:195], v[84:87], v[236:239]
    s_waitcnt lgkmcnt(10)
    v_mfma_f32_16x16x32_bf16 v[240:243], a[196:199], v[36:39], v[240:243]
    ds_read_b64_tr_b16 a[220:221], v8 offset:160
    ds_read_b64_tr_b16 a[222:223], v8 offset:4768
    v_mfma_f32_16x16x32_bf16 v[244:247], a[196:199], v[52:55], v[244:247]
    s_add_u32 m0, s8, 8192
    s_cbranch_vccnz L_wsk36
    buffer_load_dwordx4 v104, s[40:43], s13 offen offset:0 lds
L_wsk36:
    v_mfma_f32_16x16x32_bf16 v[248:251], a[196:199], v[68:71], v[248:251]
    v_mfma_f32_16x16x32_bf16 v[252:255], a[196:199], v[84:87], v[252:255]
    s_waitcnt lgkmcnt(10)
    v_mfma_f32_16x16x32_bf16 v[112:115], a[200:203], v[40:43], v[112:115]
    ds_read_b64_tr_b16 a[224:225], v8 offset:192
    ds_read_b64_tr_b16 a[226:227], v8 offset:4800
    v_mfma_f32_16x16x32_bf16 v[116:119], a[200:203], v[56:59], v[116:119]
    v_mfma_f32_16x16x32_bf16 v[120:123], a[200:203], v[72:75], v[120:123]
    v_mfma_f32_16x16x32_bf16 v[124:127], a[200:203], v[88:91], v[124:127]
    s_waitcnt lgkmcnt(10)
    v_mfma_f32_16x16x32_bf16 v[128:131], a[204:207], v[40:43], v[128:131]
    ds_read_b64_tr_b16 a[228:229], v8 offset:224
    ds_read_b64_tr_b16 a[230:231], v8 offset:4832
    v_mfma_f32_16x16x32_bf16 v[132:135], a[204:207], v[56:59], v[132:135]
    v_mfma_f32_16x16x32_bf16 v[136:139], a[204:207], v[72:75], v[136:139]
    v_mfma_f32_16x16x32_bf16 v[140:143], a[204:207], v[88:91], v[140:143]
    s_waitcnt lgkmcnt(10)
    v_mfma_f32_16x16x32_bf16 v[144:147], a[208:211], v[40:43], v[144:147]
    ds_read_b64_tr_b16 a[232:233], v8 offset:256
    ds_read_b64_tr_b16 a[234:235], v8 offset:4864
    v_mfma_f32_16x16x32_bf16 v[148:151], a[208:211], v[56:59], v[148:151]
    v_mfma_f32_16x16x32_bf16 v[152:155], a[208:211], v[72:75], v[152:155]
    v_mfma_f32_16x16x32_bf16 v[156:159], a[208:211], v[88:91], v[156:159]
    s_waitcnt lgkmcnt(10)
    v_mfma_f32_16x16x32_bf16 v[160:163], a[212:215], v[40:43], v[160:163]
    ds_read_b64_tr_b16 a[236:237], v8 offset:9216
    ds_read_b64_tr_b16 a[238:239], v8 offset:13824
    v_mfma_f32_16x16x32_bf16 v[164:167], a[212:215], v[56:59], v[164:167]
    v_mfma_f32_16x16x32_bf16 v[168:171], a[212:215], v[72:75], v[168:171]
    v_mfma_f32_16x16x32_bf16 v[172:175], a[212:215], v[88:91], v[172:175]
    s_waitcnt lgkmcnt(10)
    v_mfma_f32_16x16x32_bf16 v[176:179], a[216:219], v[40:43], v[176:179]
    ds_read_b64_tr_b16 a[240:241], v8 offset:9248
    ds_read_b64_tr_b16 a[242:243], v8 offset:13856
    v_mfma_f32_16x16x32_bf16 v[180:183], a[216:219], v[56:59], v[180:183]
    v_mfma_f32_16x16x32_bf16 v[184:187], a[216:219], v[72:75], v[184:187]
    v_mfma_f32_16x16x32_bf16 v[188:191], a[216:219], v[88:91], v[188:191]
    s_waitcnt lgkmcnt(10)
    v_mfma_f32_16x16x32_bf16 v[192:195], a[220:223], v[40:43], v[192:195]
    ds_read_b64_tr_b16 a[244:245], v8 offset:9280
    ds_read_b64_tr_b16 a[246:247], v8 offset:13888
    v_mfma_f32_16x16x32_bf16 v[196:199], a[220:223], v[56:59], v[196:199]
    v_mfma_f32_16x16x32_bf16 v[200:203], a[220:223], v[72:75], v[200:203]
    v_mfma_f32_16x16x32_bf16 v[204:207], a[220:223], v[88:91], v[204:207]
    s_waitcnt lgkmcnt(10)
    v_mfma_f32_16x16x32_bf16 v[208:211], a[224:227], v[40:43], v[208:211]
    ds_read_b64_tr_b16 a[248:249], v8 offset:9312
    ds_read_b64_tr_b16 a[250:251], v8 offset:13920
    v_mfma_f32_16x16x32_bf16 v[212:215], a[224:227], v[56:59], v[212:215]
    v_mfma_f32_16x16x32_bf16 v[216:219], a[224:227], v[72:75], v[216:219]
    v_mfma_f32_16x16x32_bf16 v[220:223], a[224:227], v[88:91], v[220:223]
    s_waitcnt lgkmcnt(10)
    v_mfma_f32_16x16x32_bf16 v[224:227], a[228:231], v[40:43], v[224:227]
    ds_read_b64_tr_b16 a[252:253], v8 offset:9344
    ds_read_b64_tr_b16 a[254:255], v8 offset:13952
    v_mfma_f32_16x16x32_bf16 v[228:231], a[228:231], v[56:59], v[228:231]
    v_mfma_f32_16x16x32_bf16 v[232:235], a[228:231], v[72:75], v[232:235]
    v_mfma_f32_16x16x32_bf16 v[236:239], a[228:231], v[88:91], v[236:239]
    s_waitcnt lgkmcnt(10)
    v_mfma_f32_16x16x32_bf16 v[240:243], a[232:235], v[40:43], v[240:243]
    ds_read_b64_tr_b16 a[192:193], v8 offset:9376
    ds_read_b64_tr_b16 a[194:195], v8 offset:13984
    v_mfma_f32_16x16x32_bf16 v[244:247], a[232:235], v[56:59], v[244:247]
    v_mfma_f32_16x16x32_bf16 v[248:251], a[232:235], v[72:75], v[248:251]
    v_mfma_f32_16x16x32_bf16 v[252:255], a[232:235], v[88:91], v[252:255]
    s_mov_b32 s56, s90
L_regchk:
    s_cmp_ge_u32 s56, 32
    s_cbranch_scc1 L_regok
    s_add_u32 s71, s71, 1
    s_cmp_ge_u32 s71, 0x4000
    s_cbranch_scc1 L_regok
    s_lshl_b32 s54, s64, 5
    v_mov_b32 v30, s54
    s_sleep 1
    global_load_dword v30, v30, s[16:17] sc1
    s_waitcnt vmcnt(0)
    v_readfirstlane_b32 s56, v30
    s_branch L_regchk
L_regok:
    v_and_b32 v2, 3, v1
    s_lshl_b32 s54, s68, 2
    v_add_u32 v2, s54, v2
    v_lshlrev_b32 v2, 7, v2
    v_add_u32 v2, v2, v21
    s_lshl_b32 s54, s64, 12
    s_add_u32 s54, s54, 62914560
    s_mov_b32 s59, 0
    s_mov_b32 s56, 0
    s_add_u32 s88, s54, 65536
L_poll_f1:
    s_and_b32 s55, s59, 7
    s_cmp_eq_u32 s55, 7
    s_cselect_b32 s89, s54, s88
    s_add_u32 s59, s59, 1
    buffer_load_dword v3, v2, s[36:39], s89 offen sc1
    s_waitcnt vmcnt(0)
    v_cmp_eq_u32 vcc, 1, v3
    s_nop 1
    s_or_b32 s56, s56, vcc_lo
    s_and_b32 s55, s56, 15
    s_cmp_eq_u32 s55, 15
    s_cbranch_scc1 L_pollx_f1
    s_nop 0
    s_cmp_ge_u32 s59, 0x8000
    s_cbranch_scc0 L_poll_f1
L_pollx_f1:
    buffer_load_dwordx4 a[0:3], v12, s[36:39], s96 offen offset:0
    buffer_load_dwordx4 a[16:19], v13, s[36:39], s96 offen offset:0
    buffer_load_dwordx4 a[4:7], v12, s[36:39], s96 offen offset:1024
    buffer_load_dwordx4 a[20:23], v13, s[36:39], s96 offen offset:1024
    buffer_load_dwordx4 a[8:11], v12, s[36:39], s96 offen offset:2048
    buffer_load_dwordx4 a[24:27], v13, s[36:39], s96 offen offset:2048
    buffer_load_dwordx4 a[12:15], v12, s[36:39], s96 offen offset:3072
    buffer_load_dwordx4 a[28:31], v13, s[36:39], s96 offen offset:3072
    s_cmp_eq_u32 s3, 3
    s_cselect_b64 vcc, -1, 0
    s_waitcnt lgkmcnt(10)
    v_mfma_f32_16x16x32_bf16 v[112:115], a[236:239], v[44:47], v[112:115]
    ds_read_b64_tr_b16 a[196:197], v8 offset:9408
    ds_read_b64_tr_b16 a[198:199], v8 offset:14016
    v_mfma_f32_16x16x32_bf16 v[116:119], a[236:239], v[60:63], v[116:119]
    v_mfma_f32_16x16x32_bf16 v[120:123], a[236:239], v[76:79], v[120:123]
    v_mfma_f32_16x16x32_bf16 v[124:127], a[236:239], v[92:95], v[124:127]
    s_waitcnt lgkmcnt(10)
    v_mfma_f32_16x16x32_bf16 v[128:131], a[240:243], v[44:47], v[128:131]
    ds_read_b64_tr_b16 a[200:201], v8 offset:9440
    ds_read_b64_tr_b16 a[202:203], v8 offset:14048
    v_mfma_f32_16x16x32_bf16 v[132:135], a[240:243], v[60:63], v[132:135]
    v_mfma_f32_16x16x32_bf16 v[136:139], a[240:243], v[76:79], v[136:139]
    v_mfma_f32_16x16x32_bf16 v[140:143], a[240:243], v[92:95], v[140:143]
    s_waitcnt lgkmcnt(10)
    v_mfma_f32_16x16x32_bf16 v[144:147], a[244:247], v[44:47], v[144:147]
    ds_read_b64_tr_b16 a[204:205], v8 offset:9472
    ds_read_b64_tr_b16 a[206:207], v8 offset:14080
    v_mfma_f32_16x16x32_bf16 v[148:151], a[244:247], v[60:63], v[148:151]
    buffer_load_dwordx4 a[64:67], v12, s[36:39], s97 offen offset:0
    v_mfma_f32_16x16x32_bf16 v[152:155], a[244:247], v[76:79], v[152:155]
    v_mfma_f32_16x16x32_bf16 v[156:159], a[244:247], v[92:95], v[156:159]
    s_waitcnt lgkmcnt(10)
    v_mfma_f32_16x16x32_bf16 v[160:163], a[248:251], v[44:47], v[160:163]
    ds_read_b64_tr_b16 a[208:209], v8 offset:18432
    ds_read_b64_tr_b16 a[210:211], v8 offset:23040
    v_mfma_f32_16x16x32_bf16 v[164:167], a[248:251], v[60:63], v[164:167]
    v_mfma_f32_16x16x32_bf16 v[168:171], a[248:251], v[76:79], v[168:171]
    v_mfma_f32_16x16x32_bf16 v[172:175], a[248:251], v[92:95], v[172:175]
    s_waitcnt lgkmcnt(10)
    v_mfma_f32_16x16x32_bf16 v[176:179], a[252:255], v[44:47], v[176:179]
    ds_read_b64_tr_b16 a[212:213], v8 offset:18464
    ds_read_b64_tr_b16 a[214:215], v8 offset:23072
    v_mfma_f32_16x16x32_bf16 v[180:183], a[252:255], v[60:63], v[180:183]
    buffer_load_dwordx4 a[80:83], v13, s[36:39], s97 offen offset:0
    v_mfma_f32_16x16x32_bf16 v[184:187], a[252:255], v[76:79], v[184:187]
    v_mfma_f32_16x16x32_bf16 v[188:191], a[252:255], v[92:95], v[188:191]
    s_waitcnt lgkmcnt(10)
    v_mfma_f32_16x16x32_bf16 v[192:195], a[192:195], v[44:47], v[192:195]
    ds_read_b64_tr_b16 a[216:217], v8 offset:18496
    ds_read_b64_tr_b16 a[218:219], v8 offset:23104
    v_mfma_f32_16x16x32_bf16 v[196:199], a[192:195], v[60:63], v[196:199]
    v_mfma_f32_16x16x32_bf16 v[200:203], a[192:195], v[76:79], v[200:203]
    v_mfma_f32_16x16x32_bf16 v[204:207], a[192:195], v[92:95], v[204:207]
    s_waitcnt lgkmcnt(10)
    v_mfma_f32_16x16x32_bf16 v[208:211], a[196:199], v[44:47], v[208:211]
    ds_read_b64_tr_b16 a[220:221], v8 offset:18528
    ds_read_b64_tr_b16 a[222:223], v8 offset:23136
    v_mfma_f32_16x16x32_bf16 v[212:215], a[196:199], v[60:63], v[212:215]
    buffer_load_dwordx4 a[68:71], v12, s[36:39], s97 offen offset:1024
    v_mfma_f32_16x16x32_bf16 v[216:219], a[196:199], v[76:79], v[216:219]
    v_mfma_f32_16x16x32_bf16 v[220:223], a[196:199], v[92:95], v[220:223]
    s_waitcnt lgkmcnt(10)
    v_mfma_f32_16x16x32_bf16 v[224:227], a[200:203], v[44:47], v[224:227]
    ds_read_b64_tr_b16 a[224:225], v8 offset:18560
    ds_read_b64_tr_b16 a[226:227], v8 offset:23168
    v_mfma_f32_16x16x32_bf16 v[228:231], a[200:203], v[60:63], v[228:231]
    v_mfma_f32_16x16x32_bf16 v[232:235], a[200:203], v[76:79], v[232:235]
    v_mfma_f32_16x16x32_bf16 v[236:239], a[200:203], v[92:95], v[236:239]
    s_waitcnt lgkmcnt(10)
    v_mfma_f32_16x16x32_bf16 v[240:243], a[204:207], v[44:47], v[240:243]
    ds_read_b64_tr_b16 a[228:229], v8 offset:18592
    ds_read_b64_tr_b16 a[230:231], v8 offset:23200
    v_mfma_f32_16x16x32_bf16 v[244:247], a[204:207], v[60:63], v[244:247]
    buffer_load_dwordx4 a[84:87], v13, s[36:39], s97 offen offset:1024
    v_mfma_f32_16x16x32_bf16 v[248:251], a[204:207], v[76:79], v[248:251]
    v_mfma_f32_16x16x32_bf16 v[252:255], a[204:207], v[92:95], v[252:255]
    s_waitcnt lgkmcnt(10)
    s_waitcnt vmcnt(10)
    v_mfma_f32_16x16x32_bf16 v[112:115], a[208:211], a[0:3], v[112:115]
    ds_read_b64_tr_b16 a[232:233], v8 offset:18624
    ds_read_b64_tr_b16 a[234:235], v8 offset:23232
    ds_read_b64_tr_b16 a[236:237], v8 offset:18656
    ds_read_b64_tr_b16 a[238:239], v8 offset:23264
    ds_read_b64_tr_b16 a[240:241], v8 offset:18688
    ds_read_b64_tr_b16 a[242:243], v8 offset:23296
    v_mfma_f32_16x16x32_bf16 v[116:119], a[208:211], a[16:19], v[116:119]
    s_waitcnt lgkmcnt(14)
    v_mfma_f32_16x16x32_bf16 v[128:131], a[212:215], a[0:3], v[128:131]
    ds_read_b64_tr_b16 a[244:245], v9 offset:20480
    ds_read_b64_tr_b16 a[246:247], v9 offset:25088
    v_mfma_f32_16x16x32_bf16 v[132:135], a[212:215], a[16:19], v[132:135]
    buffer_load_dwordx4 a[72:75], v12, s[36:39], s97 offen offset:2048
    s_waitcnt lgkmcnt(14)
    v_mfma_f32_16x16x32_bf16 v[144:147], a[216:219], a[0:3], v[144:147]
    ds_read_b64_tr_b16 a[248:249], v9 offset:20512
    ds_read_b64_tr_b16 a[250:251], v9 offset:25120
    v_mfma_f32_16x16x32_bf16 v[148:151], a[216:219], a[16:19], v[148:151]
    s_waitcnt lgkmcnt(14)
    v_mfma_f32_16x16x32_bf16 v[160:163], a[220:223], a[0:3], v[160:163]
    ds_read_b64_tr_b16 a[252:253], v9 offset:20544
    ds_read_b64_tr_b16 a[254:255], v9 offset:25152
    v_mfma_f32_16x16x32_bf16 v[164:167], a[220:223], a[16:19], v[164:167]
    buffer_load_dwordx4 a[88:91], v13, s[36:39], s97 offen offset:2048
    s_waitcnt lgkmcnt(14)
    v_mfma_f32_16x16x32_bf16 v[176:179], a[224:227], a[0:3], v[176:179]
    ds_read_b64_tr_b16 a[192:193], v9 offset:20576
    ds_read_b64_tr_b16 a[194:195], v9 offset:25184
    v_mfma_f32_16x16x32_bf16 v[180:183], a[224:227], a[16:19], v[180:183]
    buffer_load_dwordx4 a[128:131], v12, s[36:39], s98 offen offset:0
    s_waitcnt lgkmcnt(14)
    v_mfma_f32_16x16x32_bf16 v[192:195], a[228:231], a[0:3], v[192:195]
    ds_read_b64_tr_b16 a[196:197], v9 offset:20608
    ds_read_b64_tr_b16 a[198:199], v9 offset:25216
    v_mfma_f32_16x16x32_bf16 v[196:199], a[228:231], a[16:19], v[196:199]
    buffer_load_dwordx4 a[76:79], v12, s[36:39], s97 offen offset:3072
    s_waitcnt lgkmcnt(14)
    v_mfma_f32_16x16x32_bf16 v[208:211], a[232:235], a[0:3], v[208:211]
    ds_read_b64_tr_b16 a[200:201], v9 offset:20640
    ds_read_b64_tr_b16 a[202:203], v9 offset:25248
    v_mfma_f32_16x16x32_bf16 v[212:215], a[232:235], a[16:19], v[212:215]
    buffer_load_dwordx4 a[144:147], v13, s[36:39], s98 offen offset:0
    s_waitcnt lgkmcnt(14)
    v_mfma_f32_16x16x32_bf16 v[224:227], a[236:239], a[0:3], v[224:227]
    ds_read_b64_tr_b16 a[204:205], v9 offset:20672
    ds_read_b64_tr_b16 a[206:207], v9 offset:25280
    v_mfma_f32_16x16x32_bf16 v[228:231], a[236:239], a[16:19], v[228:231]
    buffer_load_dwordx4 a[92:95], v13, s[36:39], s97 offen offset:3072
    s_waitcnt lgkmcnt(14)
    v_mfma_f32_16x16x32_bf16 v[240:243], a[240:243], a[0:3], v[240:243]
    ds_read_b64_tr_b16 a[208:209], v9 offset:20704
    ds_read_b64_tr_b16 a[210:211], v9 offset:25312
    v_mfma_f32_16x16x32_bf16 v[244:247], a[240:243], a[16:19], v[244:247]
    buffer_load_dwordx4 a[132:135], v12, s[36:39], s98 offen offset:1024
    s_waitcnt lgkmcnt(14)
    s_waitcnt vmcnt(15)
    v_mfma_f32_16x16x32_bf16 v[112:115], a[244:247], a[4:7], v[112:115]
    ds_read_b64_tr_b16 a[212:213], v9 offset:20736
    ds_read_b64_tr_b16 a[214:215], v9 offset:25344
    v_mfma_f32_16x16x32_bf16 v[116:119], a[244:247], a[20:23], v[116:119]
    s_waitcnt lgkmcnt(14)
    v_mfma_f32_16x16x32_bf16 v[128:131], a[248:251], a[4:7], v[128:131]
    ds_read_b64_tr_b16 a[216:217], v8 offset:27648
    ds_read_b64_tr_b16 a[218:219], v8 offset:32256
    v_mfma_f32_16x16x32_bf16 v[132:135], a[248:251], a[20:23], v[132:135]
    buffer_load_dwordx4 a[148:151], v13, s[36:39], s98 offen offset:1024
    s_waitcnt lgkmcnt(14)
    v_mfma_f32_16x16x32_bf16 v[144:147], a[252:255], a[4:7], v[144:147]
    ds_read_b64_tr_b16 a[220:221], v8 offset:27680
    ds_read_b64_tr_b16 a[222:223], v8 offset:32288
    v_mfma_f32_16x16x32_bf16 v[148:151], a[252:255], a[20:23], v[148:151]
    s_waitcnt lgkmcnt(14)
    v_mfma_f32_16x16x32_bf16 v[160:163], a[192:195], a[4:7], v[160:163]
    ds_read_b64_tr_b16 a[224:225], v8 offset:27712
    ds_read_b64_tr_b16 a[226:227], v8 offset:32320
    v_mfma_f32_16x16x32_bf16 v[164:167], a[192:195], a[20:23], v[164:167]
    buffer_load_dwordx4 a[136:139], v12, s[36:39], s98 offen offset:2048
    s_waitcnt lgkmcnt(14)
    v_mfma_f32_16x16x32_bf16 v[176:179], a[196:199], a[4:7], v[176:179]
    ds_read_b64_tr_b16 a[228:229], v8 offset:27744
    ds_read_b64_tr_b16 a[230:231], v8 offset:32352
    v_mfma_f32_16x16x32_bf16 v[180:183], a[196:199], a[20:23], v[180:183]
    s_waitcnt lgkmcnt(14)
    v_mfma_f32_16x16x32_bf16 v[192:195], a[200:203], a[4:7], v[192:195]
    ds_read_b64_tr_b16 a[232:233], v8 offset:27776
    ds_read_b64_tr_b16 a[234:235], v8 offset:32384
    v_mfma_f32_16x16x32_bf16 v[196:199], a[200:203], a[20:23], v[196:199]
    buffer_load_dwordx4 a[152:155], v13, s[36:39], s98 offen offset:2048
    s_waitcnt lgkmcnt(14)
    v_mfma_f32_16x16x32_bf16 v[208:211], a[204:207], a[4:7], v[208:211]
    ds_read_b64_tr_b16 a[236:237], v8 offset:27808
    ds_read_b64_tr_b16 a[238:239], v8 offset:32416
    v_mfma_f32_16x16x32_bf16 v[212:215], a[204:207], a[20:23], v[212:215]
    s_waitcnt lgkmcnt(14)
    v_mfma_f32_16x16x32_bf16 v[224:227], a[208:211], a[4:7], v[224:227]
    ds_read_b64_tr_b16 a[240:241], v8 offset:27840
    ds_read_b64_tr_b16 a[242:243], v8 offset:32448
    v_mfma_f32_16x16x32_bf16 v[228:231], a[208:211], a[20:23], v[228:231]
    buffer_load_dwordx4 a[140:143], v12, s[36:39], s98 offen offset:3072
    s_waitcnt lgkmcnt(14)
    v_mfma_f32_16x16x32_bf16 v[240:243], a[212:215], a[4:7], v[240:243]
    ds_read_b64_tr_b16 a[244:245], v8 offset:27872
    ds_read_b64_tr_b16 a[246:247], v8 offset:32480
    v_mfma_f32_16x16x32_bf16 v[244:247], a[212:215], a[20:23], v[244:247]
    s_waitcnt lgkmcnt(14)
    s_waitcnt vmcnt(17)
    v_mfma_f32_16x16x32_bf16 v[112:115], a[216:219], a[8:11], v[112:115]
    ds_read_b64_tr_b16 a[248:249], v8 offset:27904
    ds_read_b64_tr_b16 a[250:251], v8 offset:32512
    v_mfma_f32_16x16x32_bf16 v[116:119], a[216:219], a[24:27], v[116:119]
    buffer_load_dwordx4 a[156:159], v13, s[36:39], s98 offen offset:3072
    s_waitcnt lgkmcnt(14)
    v_mfma_f32_16x16x32_bf16 v[128:131], a[220:223], a[8:11], v[128:131]
    ds_read_b64_tr_b16 a[252:253], v8 offset:36864
    ds_read_b64_tr_b16 a[254:255], v8 offset:41472
    v_mfma_f32_16x16x32_bf16 v[132:135], a[220:223], a[24:27], v[132:135]
    s_waitcnt lgkmcnt(14)
    v_mfma_f32_16x16x32_bf16 v[144:147], a[224:227], a[8:11], v[144:147]
    ds_read_b64_tr_b16 a[192:193], v8 offset:36896
    ds_read_b64_tr_b16 a[194:195], v8 offset:41504
    v_mfma_f32_16x16x32_bf16 v[148:151], a[224:227], a[24:27], v[148:151]
    s_waitcnt lgkmcnt(14)
    v_mfma_f32_16x16x32_bf16 v[160:163], a[228:231], a[8:11], v[160:163]
    ds_read_b64_tr_b16 a[196:197], v8 offset:36928
    ds_read_b64_tr_b16 a[198:199], v8 offset:41536
    v_mfma_f32_16x16x32_bf16 v[164:167], a[228:231], a[24:27], v[164:167]
    s_waitcnt lgkmcnt(14)
    v_mfma_f32_16x16x32_bf16 v[176:179], a[232:235], a[8:11], v[176:179]
    ds_read_b64_tr_b16 a[200:201], v8 offset:36960
    ds_read_b64_tr_b16 a[202:203], v8 offset:41568
    v_mfma_f32_16x16x32_bf16 v[180:183], a[232:235], a[24:27], v[180:183]
    buffer_load_dwordx4 a[32:35], v14, s[36:39], s96 offen offset:0
    s_waitcnt lgkmcnt(14)
    v_mfma_f32_16x16x32_bf16 v[192:195], a[236:239], a[8:11], v[192:195]
    ds_read_b64_tr_b16 a[204:205], v8 offset:36992
    ds_read_b64_tr_b16 a[206:207], v8 offset:41600
    v_mfma_f32_16x16x32_bf16 v[196:199], a[236:239], a[24:27], v[196:199]
    s_waitcnt lgkmcnt(14)
    v_mfma_f32_16x16x32_bf16 v[208:211], a[240:243], a[8:11], v[208:211]
    ds_read_b64_tr_b16 a[208:209], v8 offset:37024
    ds_read_b64_tr_b16 a[210:211], v8 offset:41632
    v_mfma_f32_16x16x32_bf16 v[212:215], a[240:243], a[24:27], v[212:215]
    s_waitcnt lgkmcnt(14)
    v_mfma_f32_16x16x32_bf16 v[224:227], a[244:247], a[8:11], v[224:227]
    ds_read_b64_tr_b16 a[212:213], v8 offset:37056
    ds_read_b64_tr_b16 a[214:215], v8 offset:41664
    v_mfma_f32_16x16x32_bf16 v[228:231], a[244:247], a[24:27], v[228:231]
    s_waitcnt lgkmcnt(14)
    v_mfma_f32_16x16x32_bf16 v[240:243], a[248:251], a[8:11], v[240:243]
    ds_read_b64_tr_b16 a[216:217], v8 offset:37088
    ds_read_b64_tr_b16 a[218:219], v8 offset:41696
    v_mfma_f32_16x16x32_bf16 v[244:247], a[248:251], a[24:27], v[244:247]
    s_waitcnt lgkmcnt(14)
    s_waitcnt vmcnt(17)
    v_mfma_f32_16x16x32_bf16 v[112:115], a[252:255], a[12:15], v[112:115]
    ds_read_b64_tr_b16 a[220:221], v8 offset:37120
    ds_read_b64_tr_b16 a[222:223], v8 offset:41728
    v_mfma_f32_16x16x32_bf16 v[116:119], a[252:255], a[28:31], v[116:119]
    s_waitcnt lgkmcnt(14)
    v_mfma_f32_16x16x32_bf16 v[128:131], a[192:195], a[12:15], v[128:131]
    ds_read_b64_tr_b16 a[224:225], v9 offset:29696
    ds_read_b64_tr_b16 a[226:227], v9 offset:34304
    v_mfma_f32_16x16x32_bf16 v[132:135], a[192:195], a[28:31], v[132:135]
    buffer_load_dwordx4 a[48:51], v15, s[36:39], s96 offen offset:0
    s_waitcnt lgkmcnt(14)
    v_mfma_f32_16x16x32_bf16 v[144:147], a[196:199], a[12:15], v[144:147]
    ds_read_b64_tr_b16 a[228:229], v9 offset:29728
    ds_read_b64_tr_b16 a[230:231], v9 offset:34336
    v_mfma_f32_16x16x32_bf16 v[148:151], a[196:199], a[28:31], v[148:151]
    s_waitcnt lgkmcnt(14)
    v_mfma_f32_16x16x32_bf16 v[160:163], a[200:203], a[12:15], v[160:163]
    ds_read_b64_tr_b16 a[232:233], v9 offset:29760
    ds_read_b64_tr_b16 a[234:235], v9 offset:34368
    v_mfma_f32_16x16x32_bf16 v[164:167], a[200:203], a[28:31], v[164:167]
    s_waitcnt lgkmcnt(14)
    v_mfma_f32_16x16x32_bf16 v[176:179], a[204:207], a[12:15], v[176:179]
    ds_read_b64_tr_b16 a[236:237], v9 offset:29792
    ds_read_b64_tr_b16 a[238:239], v9 offset:34400
    v_mfma_f32_16x16x32_bf16 v[180:183], a[204:207], a[28:31], v[180:183]
    s_waitcnt lgkmcnt(14)
    v_mfma_f32_16x16x32_bf16 v[192:195], a[208:211], a[12:15], v[192:195]
    ds_read_b64_tr_b16 a[240:241], v9 offset:29824
    ds_read_b64_tr_b16 a[242:243], v9 offset:34432
    v_mfma_f32_16x16x32_bf16 v[196:199], a[208:211], a[28:31], v[196:199]
    s_waitcnt lgkmcnt(14)
    v_mfma_f32_16x16x32_bf16 v[208:211], a[212:215], a[12:15], v[208:211]
    ds_read_b64_tr_b16 a[244:245], v9 offset:29856
    ds_read_b64_tr_b16 a[246:247], v9 offset:34464
    v_mfma_f32_16x16x32_bf16 v[212:215], a[212:215], a[28:31], v[212:215]
    s_waitcnt lgkmcnt(14)
    v_mfma_f32_16x16x32_bf16 v[224:227], a[216:219], a[12:15], v[224:227]
    ds_read_b64_tr_b16 a[248:249], v9 offset:29888
    ds_read_b64_tr_b16 a[250:251], v9 offset:34496
    v_mfma_f32_16x16x32_bf16 v[228:231], a[216:219], a[28:31], v[228:231]
    buffer_load_dwordx4 a[36:39], v14, s[36:39], s96 offen offset:1024
    s_waitcnt lgkmcnt(14)
    v_mfma_f32_16x16x32_bf16 v[240:243], a[220:223], a[12:15], v[240:243]
    ds_read_b64_tr_b16 a[252:253], v9 offset:29920
    ds_read_b64_tr_b16 a[254:255], v9 offset:34528
    v_mfma_f32_16x16x32_bf16 v[244:247], a[220:223], a[28:31], v[244:247]
    s_waitcnt lgkmcnt(14)
    s_waitcnt vmcnt(17)
    v_mfma_f32_16x16x32_bf16 v[112:115], a[224:227], a[64:67], v[112:115]
    ds_read_b64_tr_b16 a[192:193], v9 offset:29952
    ds_read_b64_tr_b16 a[194:195], v9 offset:34560
    v_mfma_f32_16x16x32_bf16 v[116:119], a[224:227], a[80:83], v[116:119]
    s_waitcnt lgkmcnt(14)
    v_mfma_f32_16x16x32_bf16 v[128:131], a[228:231], a[64:67], v[128:131]
    ds_read_b64_tr_b16 a[196:197], v9 offset:38912
    ds_read_b64_tr_b16 a[198:199], v9 offset:43520
    v_mfma_f32_16x16x32_bf16 v[132:135], a[228:231], a[80:83], v[132:135]
    s_waitcnt lgkmcnt(14)
    v_mfma_f32_16x16x32_bf16 v[144:147], a[232:235], a[64:67], v[144:147]
    ds_read_b64_tr_b16 a[200:201], v9 offset:38944
    ds_read_b64_tr_b16 a[202:203], v9 offset:43552
    v_mfma_f32_16x16x32_bf16 v[148:151], a[232:235], a[80:83], v[148:151]
    s_waitcnt lgkmcnt(14)
    v_mfma_f32_16x16x32_bf16 v[160:163], a[236:239], a[64:67], v[160:163]
    ds_read_b64_tr_b16 a[204:205], v9 offset:38976
    ds_read_b64_tr_b16 a[206:207], v9 offset:43584
    v_mfma_f32_16x16x32_bf16 v[164:167], a[236:239], a[80:83], v[164:167]
    s_waitcnt lgkmcnt(14)
    v_mfma_f32_16x16x32_bf16 v[176:179], a[240:243], a[64:67], v[176:179]
    ds_read_b64_tr_b16 a[208:209], v9 offset:39008
    ds_read_b64_tr_b16 a[210:211], v9 offset:43616
    v_mfma_f32_16x16x32_bf16 v[180:183], a[240:243], a[80:83], v[180:183]
    buffer_load_dwordx4 a[52:55], v15, s[36:39], s96 offen offset:1024
    s_waitcnt lgkmcnt(14)
    v_mfma_f32_16x16x32_bf16 v[192:195], a[244:247], a[64:67], v[192:195]
    ds_read_b64_tr_b16 a[212:213], v9 offset:39040
    ds_read_b64_tr_b16 a[214:215], v9 offset:43648
    v_mfma_f32_16x16x32_bf16 v[196:199], a[244:247], a[80:83], v[196:199]
    s_waitcnt lgkmcnt(14)
    v_mfma_f32_16x16x32_bf16 v[208:211], a[248:251], a[64:67], v[208:211]
    ds_read_b64_tr_b16 a[216:217], v9 offset:39072
    ds_read_b64_tr_b16 a[218:219], v9 offset:43680
    v_mfma_f32_16x16x32_bf16 v[212:215], a[248:251], a[80:83], v[212:215]
    s_waitcnt lgkmcnt(14)
    v_mfma_f32_16x16x32_bf16 v[224:227], a[252:255], a[64:67], v[224:227]
    ds_read_b64_tr_b16 a[220:221], v9 offset:39104
    ds_read_b64_tr_b16 a[222:223], v9 offset:43712
    v_mfma_f32_16x16x32_bf16 v[228:231], a[252:255], a[80:83], v[228:231]
    s_waitcnt lgkmcnt(14)
    v_mfma_f32_16x16x32_bf16 v[240:243], a[192:195], a[64:67], v[240:243]
    ds_read_b64_tr_b16 a[224:225], v9 offset:39136
    ds_read_b64_tr_b16 a[226:227], v9 offset:43744
    v_mfma_f32_16x16x32_bf16 v[244:247], a[192:195], a[80:83], v[244:247]
    s_waitcnt lgkmcnt(14)
    s_waitcnt vmcnt(16)
    s_barrier
    v_mfma_f32_16x16x32_bf16 v[112:115], a[196:199], a[68:71], v[112:115]
    ds_read_b64_tr_b16 a[228:229], v9 offset:39168
    ds_read_b64_tr_b16 a[230:231], v9 offset:43776
    v_mfma_f32_16x16x32_bf16 v[116:119], a[196:199], a[84:87], v[116:119]
    s_waitcnt lgkmcnt(14)
    v_mfma_f32_16x16x32_bf16 v[128:131], a[200:203], a[68:71], v[128:131]
    ds_read_b64_tr_b16 a[232:233], v8 offset:46080
    ds_read_b64_tr_b16 a[234:235], v8 offset:50688
    v_mfma_f32_16x16x32_bf16 v[132:135], a[200:203], a[84:87], v[132:135]
    buffer_load_dwordx4 a[40:43], v14, s[36:39], s96 offen offset:2048
    s_waitcnt lgkmcnt(14)
    v_mfma_f32_16x16x32_bf16 v[144:147], a[204:207], a[68:71], v[144:147]
    ds_read_b64_tr_b16 a[236:237], v8 offset:46112
    ds_read_b64_tr_b16 a[238:239], v8 offset:50720
    v_mfma_f32_16x16x32_bf16 v[148:151], a[204:207], a[84:87], v[148:151]
    s_waitcnt lgkmcnt(14)
    v_mfma_f32_16x16x32_bf16 v[160:163], a[208:211], a[68:71], v[160:163]
    ds_read_b64_tr_b16 a[240:241], v8 offset:46144
    ds_read_b64_tr_b16 a[242:243], v8 offset:50752
    v_mfma_f32_16x16x32_bf16 v[164:167], a[208:211], a[84:87], v[164:167]
    s_waitcnt lgkmcnt(14)
    v_mfma_f32_16x16x32_bf16 v[176:179], a[212:215], a[68:71], v[176:179]
    ds_read_b64_tr_b16 a[244:245], v8 offset:46176
    ds_read_b64_tr_b16 a[246:247], v8 offset:50784
    v_mfma_f32_16x16x32_bf16 v[180:183], a[212:215], a[84:87], v[180:183]
    s_waitcnt lgkmcnt(14)
    v_mfma_f32_16x16x32_bf16 v[192:195], a[216:219], a[68:71], v[192:195]
    ds_read_b64_tr_b16 a[248:249], v8 offset:46208
    ds_read_b64_tr_b16 a[250:251], v8 offset:50816
    v_mfma_f32_16x16x32_bf16 v[196:199], a[216:219], a[84:87], v[196:199]
    s_waitcnt lgkmcnt(14)
    v_mfma_f32_16x16x32_bf16 v[208:211], a[220:223], a[68:71], v[208:211]
    ds_read_b64_tr_b16 a[252:253], v8 offset:46240
    ds_read_b64_tr_b16 a[254:255], v8 offset:50848
    v_mfma_f32_16x16x32_bf16 v[212:215], a[220:223], a[84:87], v[212:215]
    s_waitcnt lgkmcnt(14)
    v_mfma_f32_16x16x32_bf16 v[224:227], a[224:227], a[68:71], v[224:227]
    ds_read_b64_tr_b16 a[192:193], v8 offset:46272
    ds_read_b64_tr_b16 a[194:195], v8 offset:50880
    v_mfma_f32_16x16x32_bf16 v[228:231], a[224:227], a[84:87], v[228:231]
    buffer_load_dwordx4 a[56:59], v15, s[36:39], s96 offen offset:2048
    s_waitcnt lgkmcnt(14)
    v_mfma_f32_16x16x32_bf16 v[240:243], a[228:231], a[68:71], v[240:243]
    ds_read_b64_tr_b16 a[196:197], v8 offset:46304
    ds_read_b64_tr_b16 a[198:199], v8 offset:50912
    v_mfma_f32_16x16x32_bf16 v[244:247], a[228:231], a[84:87], v[244:247]
    s_waitcnt lgkmcnt(14)
    s_waitcnt vmcnt(16)
    v_mfma_f32_16x16x32_bf16 v[112:115], a[232:235], a[72:75], v[112:115]
    ds_read_b64_tr_b16 a[200:201], v8 offset:46336
    ds_read_b64_tr_b16 a[202:203], v8 offset:50944
    v_mfma_f32_16x16x32_bf16 v[116:119], a[232:235], a[88:91], v[116:119]
    s_waitcnt lgkmcnt(14)
    v_mfma_f32_16x16x32_bf16 v[128:131], a[236:239], a[72:75], v[128:131]
    ds_read_b64_tr_b16 a[204:205], v8 offset:55296
    ds_read_b64_tr_b16 a[206:207], v8 offset:59904
    v_mfma_f32_16x16x32_bf16 v[132:135], a[236:239], a[88:91], v[132:135]
    s_waitcnt lgkmcnt(14)
    v_mfma_f32_16x16x32_bf16 v[144:147], a[240:243], a[72:75], v[144:147]
    ds_read_b64_tr_b16 a[208:209], v8 offset:55328
    ds_read_b64_tr_b16 a[210:211], v8 offset:59936
    v_mfma_f32_16x16x32_bf16 v[148:151], a[240:243], a[88:91], v[148:151]
    s_waitcnt lgkmcnt(14)
    v_mfma_f32_16x16x32_bf16 v[160:163], a[244:247], a[72:75], v[160:163]
    ds_read_b64_tr_b16 a[212:213], v8 offset:55360
    ds_read_b64_tr_b16 a[214:215], v8 offset:59968
    v_mfma_f32_16x16x32_bf16 v[164:167], a[244:247], a[88:91], v[164:167]
    s_waitcnt lgkmcnt(14)
    v_mfma_f32_16x16x32_bf16 v[176:179], a[248:251], a[72:75], v[176:179]
    ds_read_b64_tr_b16 a[216:217], v8 offset:55392
    ds_read_b64_tr_b16 a[218:219], v8 offset:60000
    v_mfma_f32_16x16x32_bf16 v[180:183], a[248:251], a[88:91], v[180:183]
    buffer_load_dwordx4 a[44:47], v14, s[36:39], s96 offen offset:3072
    s_waitcnt lgkmcnt(14)
    v_mfma_f32_16x16x32_bf16 v[192:195], a[252:255], a[72:75], v[192:195]
    ds_read_b64_tr_b16 a[220:221], v8 offset:55424
    ds_read_b64_tr_b16 a[222:223], v8 offset:60032
    v_mfma_f32_16x16x32_bf16 v[196:199], a[252:255], a[88:91], v[196:199]
    s_waitcnt lgkmcnt(14)
    v_mfma_f32_16x16x32_bf16 v[208:211], a[192:195], a[72:75], v[208:211]
    ds_read_b64_tr_b16 a[224:225], v8 offset:55456
    ds_read_b64_tr_b16 a[226:227], v8 offset:60064
    v_mfma_f32_16x16x32_bf16 v[212:215], a[192:195], a[88:91], v[212:215]
    s_waitcnt lgkmcnt(14)
    v_mfma_f32_16x16x32_bf16 v[224:227], a[196:199], a[72:75], v[224:227]
    ds_read_b64_tr_b16 a[228:229], v8 offset:55488
    ds_read_b64_tr_b16 a[230:231], v8 offset:60096
    v_mfma_f32_16x16x32_bf16 v[228:231], a[196:199], a[88:91], v[228:231]
    s_waitcnt lgkmcnt(14)
    v_mfma_f32_16x16x32_bf16 v[240:243], a[200:203], a[72:75], v[240:243]
    ds_read_b64_tr_b16 a[232:233], v8 offset:55520
    ds_read_b64_tr_b16 a[234:235], v8 offset:60128
    v_mfma_f32_16x16x32_bf16 v[244:247], a[200:203], a[88:91], v[244:247]
    s_waitcnt lgkmcnt(14)
    s_waitcnt vmcnt(13)
    v_mfma_f32_16x16x32_bf16 v[112:115], a[204:207], a[76:79], v[112:115]
    ds_read_b64_tr_b16 a[236:237], v8 offset:55552
    ds_read_b64_tr_b16 a[238:239], v8 offset:60160
    v_mfma_f32_16x16x32_bf16 v[116:119], a[204:207], a[92:95], v[116:119]
    s_waitcnt lgkmcnt(14)
    v_mfma_f32_16x16x32_bf16 v[128:131], a[208:211], a[76:79], v[128:131]
    ds_read_b64_tr_b16 a[240:241], v9 offset:48128
    ds_read_b64_tr_b16 a[242:243], v9 offset:52736
    v_mfma_f32_16x16x32_bf16 v[132:135], a[208:211], a[92:95], v[132:135]
    buffer_load_dwordx4 a[60:63], v15, s[36:39], s96 offen offset:3072
    s_waitcnt lgkmcnt(14)
    v_mfma_f32_16x16x32_bf16 v[144:147], a[212:215], a[76:79], v[144:147]
    ds_read_b64_tr_b16 a[244:245], v9 offset:48160
    ds_read_b64_tr_b16 a[246:247], v9 offset:52768
    v_mfma_f32_16x16x32_bf16 v[148:151], a[212:215], a[92:95], v[148:151]
    s_waitcnt lgkmcnt(14)
    v_mfma_f32_16x16x32_bf16 v[160:163], a[216:219], a[76:79], v[160:163]
    ds_read_b64_tr_b16 a[248:249], v9 offset:48192
    ds_read_b64_tr_b16 a[250:251], v9 offset:52800
    v_mfma_f32_16x16x32_bf16 v[164:167], a[216:219], a[92:95], v[164:167]
    s_waitcnt lgkmcnt(14)
    v_mfma_f32_16x16x32_bf16 v[176:179], a[220:223], a[76:79], v[176:179]
    ds_read_b64_tr_b16 a[252:253], v9 offset:48224
    ds_read_b64_tr_b16 a[254:255], v9 offset:52832
    v_mfma_f32_16x16x32_bf16 v[180:183], a[220:223], a[92:95], v[180:183]
    s_waitcnt lgkmcnt(14)
    v_mfma_f32_16x16x32_bf16 v[192:195], a[224:227], a[76:79], v[192:195]
    ds_read_b64_tr_b16 a[192:193], v9 offset:48256
    ds_read_b64_tr_b16 a[194:195], v9 offset:52864
    v_mfma_f32_16x16x32_bf16 v[196:199], a[224:227], a[92:95], v[196:199]
    s_waitcnt lgkmcnt(14)
    v_mfma_f32_16x16x32_bf16 v[208:211], a[228:231], a[76:79], v[208:211]
    ds_read_b64_tr_b16 a[196:197], v9 offset:48288
    ds_read_b64_tr_b16 a[198:199], v9 offset:52896
    v_mfma_f32_16x16x32_bf16 v[212:215], a[228:231], a[92:95], v[212:215]
    s_waitcnt lgkmcnt(14)
    v_mfma_f32_16x16x32_bf16 v[224:227], a[232:235], a[76:79], v[224:227]
    ds_read_b64_tr_b16 a[200:201], v9 offset:48320
    ds_read_b64_tr_b16 a[202:203], v9 offset:52928
    v_mfma_f32_16x16x32_bf16 v[228:231], a[232:235], a[92:95], v[228:231]
    buffer_load_dwordx4 a[96:99], v14, s[36:39], s97 offen offset:0
    s_waitcnt lgkmcnt(14)
    v_mfma_f32_16x16x32_bf16 v[240:243], a[236:239], a[76:79], v[240:243]
    ds_read_b64_tr_b16 a[204:205], v9 offset:48352
    ds_read_b64_tr_b16 a[206:207], v9 offset:52960
    v_mfma_f32_16x16x32_bf16 v[244:247], a[236:239], a[92:95], v[244:247]
    s_waitcnt lgkmcnt(14)
    s_waitcnt vmcnt(16)
    v_mfma_f32_16x16x32_bf16 v[112:115], a[240:243], a[128:131], v[112:115]
    ds_read_b64_tr_b16 a[208:209], v9 offset:48384
    ds_read_b64_tr_b16 a[210:211], v9 offset:52992
    v_mfma_f32_16x16x32_bf16 v[116:119], a[240:243], a[144:147], v[116:119]
    buffer_load_dwordx4 a[112:115], v15, s[36:39], s97 offen offset:0
    s_waitcnt lgkmcnt(14)
    v_mfma_f32_16x16x32_bf16 v[128:131], a[244:247], a[128:131], v[128:131]
    ds_read_b64_tr_b16 a[212:213], v9 offset:57344
    ds_read_b64_tr_b16 a[214:215], v9 offset:61952
    v_mfma_f32_16x16x32_bf16 v[132:135], a[244:247], a[144:147], v[132:135]
    s_waitcnt lgkmcnt(14)
    v_mfma_f32_16x16x32_bf16 v[144:147], a[248:251], a[128:131], v[144:147]
    ds_read_b64_tr_b16 a[216:217], v9 offset:57376
    ds_read_b64_tr_b16 a[218:219], v9 offset:61984
    v_mfma_f32_16x16x32_bf16 v[148:151], a[248:251], a[144:147], v[148:151]
    buffer_load_dwordx4 a[100:103], v14, s[36:39], s97 offen offset:1024
    s_waitcnt lgkmcnt(14)
    v_mfma_f32_16x16x32_bf16 v[160:163], a[252:255], a[128:131], v[160:163]
    ds_read_b64_tr_b16 a[220:221], v9 offset:57408
    ds_read_b64_tr_b16 a[222:223], v9 offset:62016
    v_mfma_f32_16x16x32_bf16 v[164:167], a[252:255], a[144:147], v[164:167]
    s_waitcnt lgkmcnt(14)
    v_mfma_f32_16x16x32_bf16 v[176:179], a[192:195], a[128:131], v[176:179]
    ds_read_b64_tr_b16 a[224:225], v9 offset:57440
    ds_read_b64_tr_b16 a[226:227], v9 offset:62048
    v_mfma_f32_16x16x32_bf16 v[180:183], a[192:195], a[144:147], v[180:183]
    buffer_load_dwordx4 a[116:119], v15, s[36:39], s97 offen offset:1024
    s_waitcnt lgkmcnt(14)
    v_mfma_f32_16x16x32_bf16 v[192:195], a[196:199], a[128:131], v[192:195]
    ds_read_b64_tr_b16 a[228:229], v9 offset:57472
    ds_read_b64_tr_b16 a[230:231], v9 offset:62080
    v_mfma_f32_16x16x32_bf16 v[196:199], a[196:199], a[144:147], v[196:199]
    s_waitcnt lgkmcnt(14)
    v_mfma_f32_16x16x32_bf16 v[208:211], a[200:203], a[128:131], v[208:211]
    ds_read_b64_tr_b16 a[232:233], v9 offset:57504
    ds_read_b64_tr_b16 a[234:235], v9 offset:62112
    v_mfma_f32_16x16x32_bf16 v[212:215], a[200:203], a[144:147], v[212:215]
    buffer_load_dwordx4 a[104:107], v14, s[36:39], s97 offen offset:2048
    s_waitcnt lgkmcnt(14)
    v_mfma_f32_16x16x32_bf16 v[224:227], a[204:207], a[128:131], v[224:227]
    ds_read_b64_tr_b16 a[236:237], v9 offset:57536
    ds_read_b64_tr_b16 a[238:239], v9 offset:62144
    v_mfma_f32_16x16x32_bf16 v[228:231], a[204:207], a[144:147], v[228:231]
    s_waitcnt lgkmcnt(14)
    v_mfma_f32_16x16x32_bf16 v[240:243], a[208:211], a[128:131], v[240:243]
    ds_read_b64_tr_b16 a[240:241], v9 offset:57568
    ds_read_b64_tr_b16 a[242:243], v9 offset:62176
    v_mfma_f32_16x16x32_bf16 v[244:247], a[208:211], a[144:147], v[244:247]
    buffer_load_dwordx4 a[120:123], v15, s[36:39], s97 offen offset:2048
    s_waitcnt lgkmcnt(14)
    s_waitcnt vmcnt(18)
    v_mfma_f32_16x16x32_bf16 v[112:115], a[212:215], a[132:135], v[112:115]
    ds_read_b64_tr_b16 a[244:245], v9 offset:57600
    ds_read_b64_tr_b16 a[246:247], v9 offset:62208
    v_mfma_f32_16x16x32_bf16 v[116:119], a[212:215], a[148:151], v[116:119]
    s_waitcnt lgkmcnt(14)
    v_mfma_f32_16x16x32_bf16 v[128:131], a[216:219], a[132:135], v[128:131]
    ds_read_b64_tr_b16 a[248:249], v10 offset:5120
    ds_read_b64_tr_b16 a[250:251], v10 offset:9728
    v_mfma_f32_16x16x32_bf16 v[132:135], a[216:219], a[148:151], v[132:135]
    buffer_load_dwordx4 a[108:111], v14, s[36:39], s97 offen offset:3072
    s_waitcnt lgkmcnt(14)
    v_mfma_f32_16x16x32_bf16 v[144:147], a[220:223], a[132:135], v[144:147]
    ds_read_b64_tr_b16 a[252:253], v10 offset:5152
    ds_read_b64_tr_b16 a[254:255], v10 offset:9760
    v_mfma_f32_16x16x32_bf16 v[148:151], a[220:223], a[148:151], v[148:151]
    s_waitcnt lgkmcnt(14)
    v_mfma_f32_16x16x32_bf16 v[160:163], a[224:227], a[132:135], v[160:163]
    ds_read_b64_tr_b16 a[192:193], v10 offset:5184
    ds_read_b64_tr_b16 a[194:195], v10 offset:9792
    v_mfma_f32_16x16x32_bf16 v[164:167], a[224:227], a[148:151], v[164:167]
    buffer_load_dwordx4 a[124:127], v15, s[36:39], s97 offen offset:3072
    s_waitcnt lgkmcnt(14)
    v_mfma_f32_16x16x32_bf16 v[176:179], a[228:231], a[132:135], v[176:179]
    ds_read_b64_tr_b16 a[196:197], v10 offset:5216
    ds_read_b64_tr_b16 a[198:199], v10 offset:9824
    v_mfma_f32_16x16x32_bf16 v[180:183], a[228:231], a[148:151], v[180:183]
    s_waitcnt lgkmcnt(14)
    v_mfma_f32_16x16x32_bf16 v[192:195], a[232:235], a[132:135], v[192:195]
    ds_read_b64_tr_b16 a[200:201], v10 offset:5248
    ds_read_b64_tr_b16 a[202:203], v10 offset:9856
    v_mfma_f32_16x16x32_bf16 v[196:199], a[232:235], a[148:151], v[196:199]
    s_waitcnt lgkmcnt(14)
    v_mfma_f32_16x16x32_bf16 v[208:211], a[236:239], a[132:135], v[208:211]
    ds_read_b64_tr_b16 a[204:205], v10 offset:5280
    ds_read_b64_tr_b16 a[206:207], v10 offset:9888
    v_mfma_f32_16x16x32_bf16 v[212:215], a[236:239], a[148:151], v[212:215]
    s_waitcnt lgkmcnt(14)
    v_mfma_f32_16x16x32_bf16 v[224:227], a[240:243], a[132:135], v[224:227]
    ds_read_b64_tr_b16 a[208:209], v10 offset:5312
    ds_read_b64_tr_b16 a[210:211], v10 offset:9920
    v_mfma_f32_16x16x32_bf16 v[228:231], a[240:243], a[148:151], v[228:231]
    buffer_load_dwordx4 a[160:163], v14, s[36:39], s98 offen offset:0
    s_waitcnt lgkmcnt(14)
    v_mfma_f32_16x16x32_bf16 v[240:243], a[244:247], a[132:135], v[240:243]
    ds_read_b64_tr_b16 a[212:213], v10 offset:5344
    ds_read_b64_tr_b16 a[214:215], v10 offset:9952
    v_mfma_f32_16x16x32_bf16 v[244:247], a[244:247], a[148:151], v[244:247]
    s_waitcnt lgkmcnt(14)
    s_waitcnt vmcnt(19)
    v_mfma_f32_16x16x32_bf16 v[112:115], a[248:251], a[136:139], v[112:115]
    ds_read_b64_tr_b16 a[216:217], v10 offset:5376
    ds_read_b64_tr_b16 a[218:219], v10 offset:9984
    v_mfma_f32_16x16x32_bf16 v[116:119], a[248:251], a[152:155], v[116:119]
    buffer_load_dwordx4 a[176:179], v15, s[36:39], s98 offen offset:0
    s_waitcnt lgkmcnt(14)
    v_mfma_f32_16x16x32_bf16 v[128:131], a[252:255], a[136:139], v[128:131]
    ds_read_b64_tr_b16 a[220:221], v9 offset:4096
    ds_read_b64_tr_b16 a[222:223], v9 offset:8704
    v_mfma_f32_16x16x32_bf16 v[132:135], a[252:255], a[152:155], v[132:135]
    s_waitcnt lgkmcnt(14)
    v_mfma_f32_16x16x32_bf16 v[144:147], a[192:195], a[136:139], v[144:147]
    ds_read_b64_tr_b16 a[224:225], v9 offset:4128
    ds_read_b64_tr_b16 a[226:227], v9 offset:8736
    v_mfma_f32_16x16x32_bf16 v[148:151], a[192:195], a[152:155], v[148:151]
    buffer_load_dwordx4 a[164:167], v14, s[36:39], s98 offen offset:1024
    s_waitcnt lgkmcnt(14)
    v_mfma_f32_16x16x32_bf16 v[160:163], a[196:199], a[136:139], v[160:163]
    ds_read_b64_tr_b16 a[228:229], v9 offset:4160
    ds_read_b64_tr_b16 a[230:231], v9 offset:8768
    v_mfma_f32_16x16x32_bf16 v[164:167], a[196:199], a[152:155], v[164:167]
    s_waitcnt lgkmcnt(14)
    v_mfma_f32_16x16x32_bf16 v[176:179], a[200:203], a[136:139], v[176:179]
    ds_read_b64_tr_b16 a[232:233], v9 offset:4192
    ds_read_b64_tr_b16 a[234:235], v9 offset:8800
    v_mfma_f32_16x16x32_bf16 v[180:183], a[200:203], a[152:155], v[180:183]
    buffer_load_dwordx4 a[180:183], v15, s[36:39], s98 offen offset:1024
    s_waitcnt lgkmcnt(14)
    v_mfma_f32_16x16x32_bf16 v[192:195], a[204:207], a[136:139], v[192:195]
    ds_read_b64_tr_b16 a[236:237], v9 offset:4224
    ds_read_b64_tr_b16 a[238:239], v9 offset:8832
    v_mfma_f32_16x16x32_bf16 v[196:199], a[204:207], a[152:155], v[196:199]
    s_waitcnt lgkmcnt(14)
    v_mfma_f32_16x16x32_bf16 v[208:211], a[208:211], a[136:139], v[208:211]
    ds_read_b64_tr_b16 a[240:241], v9 offset:4256
    ds_read_b64_tr_b16 a[242:243], v9 offset:8864
    v_mfma_f32_16x16x32_bf16 v[212:215], a[208:211], a[152:155], v[212:215]
    buffer_load_dwordx4 a[168:171], v14, s[36:39], s98 offen offset:2048
    s_waitcnt lgkmcnt(14)
    v_mfma_f32_16x16x32_bf16 v[224:227], a[212:215], a[136:139], v[224:227]
    ds_read_b64_tr_b16 a[244:245], v9 offset:4288
    ds_read_b64_tr_b16 a[246:247], v9 offset:8896
    v_mfma_f32_16x16x32_bf16 v[228:231], a[212:215], a[152:155], v[228:231]
    s_waitcnt lgkmcnt(14)
    v_mfma_f32_16x16x32_bf16 v[240:243], a[216:219], a[136:139], v[240:243]
    ds_read_b64_tr_b16 a[248:249], v9 offset:4320
    ds_read_b64_tr_b16 a[250:251], v9 offset:8928
    v_mfma_f32_16x16x32_bf16 v[244:247], a[216:219], a[152:155], v[244:247]
    buffer_load_dwordx4 a[184:187], v15, s[36:39], s98 offen offset:2048
    s_waitcnt lgkmcnt(14)
    s_waitcnt vmcnt(22)
    v_mfma_f32_16x16x32_bf16 v[112:115], a[220:223], a[140:143], v[112:115]
    ds_read_b64_tr_b16 a[252:253], v9 offset:4352
    ds_read_b64_tr_b16 a[254:255], v9 offset:8960
    v_mfma_f32_16x16x32_bf16 v[116:119], a[220:223], a[156:159], v[116:119]
    s_waitcnt lgkmcnt(14)
    v_mfma_f32_16x16x32_bf16 v[128:131], a[224:227], a[140:143], v[128:131]
    ds_read_b64_tr_b16 a[192:193], v8 offset:18432
    ds_read_b64_tr_b16 a[194:195], v8 offset:23040
    v_mfma_f32_16x16x32_bf16 v[132:135], a[224:227], a[156:159], v[132:135]
    buffer_load_dwordx4 a[172:175], v14, s[36:39], s98 offen offset:3072
    s_waitcnt lgkmcnt(14)
    v_mfma_f32_16x16x32_bf16 v[144:147], a[228:231], a[140:143], v[144:147]
    ds_read_b64_tr_b16 a[196:197], v8 offset:18464
    ds_read_b64_tr_b16 a[198:199], v8 offset:23072
    v_mfma_f32_16x16x32_bf16 v[148:151], a[228:231], a[156:159], v[148:151]
    s_waitcnt lgkmcnt(14)
    v_mfma_f32_16x16x32_bf16 v[160:163], a[232:235], a[140:143], v[160:163]
    ds_read_b64_tr_b16 a[200:201], v8 offset:18496
    ds_read_b64_tr_b16 a[202:203], v8 offset:23104
    v_mfma_f32_16x16x32_bf16 v[164:167], a[232:235], a[156:159], v[164:167]
    buffer_load_dwordx4 a[188:191], v15, s[36:39], s98 offen offset:3072
    s_waitcnt lgkmcnt(14)
    v_mfma_f32_16x16x32_bf16 v[176:179], a[236:239], a[140:143], v[176:179]
    ds_read_b64_tr_b16 a[204:205], v8 offset:18528
    ds_read_b64_tr_b16 a[206:207], v8 offset:23136
    v_mfma_f32_16x16x32_bf16 v[180:183], a[236:239], a[156:159], v[180:183]
    s_waitcnt lgkmcnt(14)
    v_mfma_f32_16x16x32_bf16 v[192:195], a[240:243], a[140:143], v[192:195]
    ds_read_b64_tr_b16 a[208:209], v8 offset:18560
    ds_read_b64_tr_b16 a[210:211], v8 offset:23168
    v_mfma_f32_16x16x32_bf16 v[196:199], a[240:243], a[156:159], v[196:199]
    s_waitcnt lgkmcnt(14)
    v_mfma_f32_16x16x32_bf16 v[208:211], a[244:247], a[140:143], v[208:211]
    ds_read_b64_tr_b16 a[212:213], v8 offset:18592
    ds_read_b64_tr_b16 a[214:215], v8 offset:23200
    v_mfma_f32_16x16x32_bf16 v[212:215], a[244:247], a[156:159], v[212:215]
    s_waitcnt lgkmcnt(14)
    v_mfma_f32_16x16x32_bf16 v[224:227], a[248:251], a[140:143], v[224:227]
    ds_read_b64_tr_b16 a[216:217], v8 offset:18624
    ds_read_b64_tr_b16 a[218:219], v8 offset:23232
    v_mfma_f32_16x16x32_bf16 v[228:231], a[248:251], a[156:159], v[228:231]
    s_waitcnt lgkmcnt(14)
    v_mfma_f32_16x16x32_bf16 v[240:243], a[252:255], a[140:143], v[240:243]
    ds_read_b64_tr_b16 a[220:221], v8 offset:18656
    ds_read_b64_tr_b16 a[222:223], v8 offset:23264
    v_mfma_f32_16x16x32_bf16 v[244:247], a[252:255], a[156:159], v[244:247]
    s_nop 4
    v_cvt_pk_bf16_f32 v112, v112, v113
    v_cvt_pk_bf16_f32 v113, v114, v115
    v_cvt_pk_bf16_f32 v114, v128, v129
    v_cvt_pk_bf16_f32 v115, v130, v131
    v_cvt_pk_bf16_f32 v144, v144, v145
    v_cvt_pk_bf16_f32 v145, v146, v147
    v_cvt_pk_bf16_f32 v146, v160, v161
    v_cvt_pk_bf16_f32 v147, v162, v163
    v_cvt_pk_bf16_f32 v176, v176, v177
    v_cvt_pk_bf16_f32 v177, v178, v179
    v_cvt_pk_bf16_f32 v178, v192, v193
    v_cvt_pk_bf16_f32 v179, v194, v195
    v_cvt_pk_bf16_f32 v208, v208, v209
    v_cvt_pk_bf16_f32 v209, v210, v211
    v_cvt_pk_bf16_f32 v210, v224, v225
    v_cvt_pk_bf16_f32 v211, v226, v227
    v_cvt_pk_bf16_f32 v240, v240, v241
    v_cvt_pk_bf16_f32 v241, v242, v243
    v_cvt_pk_bf16_f32 v116, v116, v117
    v_cvt_pk_bf16_f32 v117, v118, v119
    v_cvt_pk_bf16_f32 v118, v132, v133
    v_cvt_pk_bf16_f32 v119, v134, v135
    v_cvt_pk_bf16_f32 v148, v148, v149
    v_cvt_pk_bf16_f32 v149, v150, v151
    v_cvt_pk_bf16_f32 v150, v164, v165
    v_cvt_pk_bf16_f32 v151, v166, v167
    v_cvt_pk_bf16_f32 v180, v180, v181
    v_cvt_pk_bf16_f32 v181, v182, v183
    v_cvt_pk_bf16_f32 v182, v196, v197
    v_cvt_pk_bf16_f32 v183, v198, v199
    v_cvt_pk_bf16_f32 v212, v212, v213
    v_cvt_pk_bf16_f32 v213, v214, v215
    v_cvt_pk_bf16_f32 v214, v228, v229
    v_cvt_pk_bf16_f32 v215, v230, v231
    v_cvt_pk_bf16_f32 v244, v244, v245
    v_cvt_pk_bf16_f32 v245, v246, v247
    s_waitcnt lgkmcnt(14)
    s_waitcnt vmcnt(22)
    v_mfma_f32_16x16x32_bf16 v[120:123], a[192:195], a[32:35], v[120:123]
    ds_read_b64_tr_b16 a[224:225], v8 offset:18688
    ds_read_b64_tr_b16 a[226:227], v8 offset:23296
    v_mfma_f32_16x16x32_bf16 v[124:127], a[192:195], a[48:51], v[124:127]
    s_add_u32 s99, s100, 0
    buffer_store_dwordx4 v[112:115], v12, s[36:39], s99 offen offset:0 sc1
    s_waitcnt lgkmcnt(14)
    v_mfma_f32_16x16x32_bf16 v[136:139], a[196:199], a[32:35], v[136:139]
    ds_read_b64_tr_b16 a[228:229], v9 offset:20480
    ds_read_b64_tr_b16 a[230:231], v9 offset:25088
    v_mfma_f32_16x16x32_bf16 v[140:143], a[196:199], a[48:51], v[140:143]
    s_waitcnt lgkmcnt(14)
    v_mfma_f32_16x16x32_bf16 v[152:155], a[200:203], a[32:35], v[152:155]
    ds_read_b64_tr_b16 a[232:233], v9 offset:20512
    ds_read_b64_tr_b16 a[234:235], v9 offset:25120
    v_mfma_f32_16x16x32_bf16 v[156:159], a[200:203], a[48:51], v[156:159]
    buffer_store_dwordx4 v[144:147], v12, s[36:39], s99 offen offset:1024 sc1
    s_waitcnt lgkmcnt(14)
    v_mfma_f32_16x16x32_bf16 v[168:171], a[204:207], a[32:35], v[168:171]
    ds_read_b64_tr_b16 a[236:237], v9 offset:20544
    ds_read_b64_tr_b16 a[238:239], v9 offset:25152
    v_mfma_f32_16x16x32_bf16 v[172:175], a[204:207], a[48:51], v[172:175]
    s_waitcnt lgkmcnt(14)
    v_mfma_f32_16x16x32_bf16 v[184:187], a[208:211], a[32:35], v[184:187]
    ds_read_b64_tr_b16 a[240:241], v9 offset:20576
    ds_read_b64_tr_b16 a[242:243], v9 offset:25184
    v_mfma_f32_16x16x32_bf16 v[188:191], a[208:211], a[48:51], v[188:191]
    buffer_store_dwordx4 v[176:179], v12, s[36:39], s99 offen offset:2048 sc1
    s_waitcnt lgkmcnt(14)
    v_mfma_f32_16x16x32_bf16 v[200:203], a[212:215], a[32:35], v[200:203]
    ds_read_b64_tr_b16 a[244:245], v9 offset:20608
    ds_read_b64_tr_b16 a[246:247], v9 offset:25216
    v_mfma_f32_16x16x32_bf16 v[204:207], a[212:215], a[48:51], v[204:207]
    s_waitcnt lgkmcnt(14)
    v_mfma_f32_16x16x32_bf16 v[216:219], a[216:219], a[32:35], v[216:219]
    ds_read_b64_tr_b16 a[248:249], v9 offset:20640
    ds_read_b64_tr_b16 a[250:251], v9 offset:25248
    v_mfma_f32_16x16x32_bf16 v[220:223], a[216:219], a[48:51], v[220:223]
    buffer_store_dwordx4 v[208:211], v12, s[36:39], s99 offen offset:3072 sc1
    s_waitcnt lgkmcnt(14)
    v_mfma_f32_16x16x32_bf16 v[232:235], a[220:223], a[32:35], v[232:235]
    ds_read_b64_tr_b16 a[252:253], v9 offset:20672
    ds_read_b64_tr_b16 a[254:255], v9 offset:25280
    v_mfma_f32_16x16x32_bf16 v[236:239], a[220:223], a[48:51], v[236:239]
    s_waitcnt lgkmcnt(14)
    v_mfma_f32_16x16x32_bf16 v[248:251], a[224:227], a[32:35], v[248:251]
    ds_read_b64_tr_b16 a[192:193], v9 offset:20704
    ds_read_b64_tr_b16 a[194:195], v9 offset:25312
    v_mfma_f32_16x16x32_bf16 v[252:255], a[224:227], a[48:51], v[252:255]
    buffer_store_dwordx2 v[240:241], v11, s[36:39], s99 offen sc1
    s_waitcnt lgkmcnt(14)
    s_waitcnt vmcnt(25)
    v_mfma_f32_16x16x32_bf16 v[120:123], a[228:231], a[36:39], v[120:123]
    ds_read_b64_tr_b16 a[196:197], v9 offset:20736
    ds_read_b64_tr_b16 a[198:199], v9 offset:25344
    v_mfma_f32_16x16x32_bf16 v[124:127], a[228:231], a[52:55], v[124:127]
    s_waitcnt lgkmcnt(14)
    v_mfma_f32_16x16x32_bf16 v[136:139], a[232:235], a[36:39], v[136:139]
    ds_read_b64_tr_b16 a[200:201], v8 offset:27648
    ds_read_b64_tr_b16 a[202:203], v8 offset:32256
    v_mfma_f32_16x16x32_bf16 v[140:143], a[232:235], a[52:55], v[140:143]
    s_add_u32 s99, s100, 81920
    buffer_store_dwordx4 v[116:119], v12, s[36:39], s99 offen offset:0 sc1
    s_waitcnt lgkmcnt(14)
    v_mfma_f32_16x16x32_bf16 v[152:155], a[236:239], a[36:39], v[152:155]
    ds_read_b64_tr_b16 a[204:205], v8 offset:27680
    ds_read_b64_tr_b16 a[206:207], v8 offset:32288
    v_mfma_f32_16x16x32_bf16 v[156:159], a[236:239], a[52:55], v[156:159]
    s_waitcnt lgkmcnt(14)
    v_mfma_f32_16x16x32_bf16 v[168:171], a[240:243], a[36:39], v[168:171]
    ds_read_b64_tr_b16 a[208:209], v8 offset:27712
    ds_read_b64_tr_b16 a[210:211], v8 offset:32320
    v_mfma_f32_16x16x32_bf16 v[172:175], a[240:243], a[52:55], v[172:175]
    buffer_store_dwordx4 v[148:151], v12, s[36:39], s99 offen offset:1024 sc1
    s_waitcnt lgkmcnt(14)
    v_mfma_f32_16x16x32_bf16 v[184:187], a[244:247], a[36:39], v[184:187]
    ds_read_b64_tr_b16 a[212:213], v8 offset:27744
    ds_read_b64_tr_b16 a[214:215], v8 offset:32352
    v_mfma_f32_16x16x32_bf16 v[188:191], a[244:247], a[52:55], v[188:191]
    s_waitcnt lgkmcnt(14)
    v_mfma_f32_16x16x32_bf16 v[200:203], a[248:251], a[36:39], v[200:203]
    ds_read_b64_tr_b16 a[216:217], v8 offset:27776
    ds_read_b64_tr_b16 a[218:219], v8 offset:32384
    v_mfma_f32_16x16x32_bf16 v[204:207], a[248:251], a[52:55], v[204:207]
    buffer_store_dwordx4 v[180:183], v12, s[36:39], s99 offen offset:2048 sc1
    s_waitcnt lgkmcnt(14)
    v_mfma_f32_16x16x32_bf16 v[216:219], a[252:255], a[36:39], v[216:219]
    ds_read_b64_tr_b16 a[220:221], v8 offset:27808
    ds_read_b64_tr_b16 a[222:223], v8 offset:32416
    v_mfma_f32_16x16x32_bf16 v[220:223], a[252:255], a[52:55], v[220:223]
    s_waitcnt lgkmcnt(14)
    v_mfma_f32_16x16x32_bf16 v[232:235], a[192:195], a[36:39], v[232:235]
    ds_read_b64_tr_b16 a[224:225], v8 offset:27840
    ds_read_b64_tr_b16 a[226:227], v8 offset:32448
    v_mfma_f32_16x16x32_bf16 v[236:239], a[192:195], a[52:55], v[236:239]
    buffer_store_dwordx4 v[212:215], v12, s[36:39], s99 offen offset:3072 sc1
    s_waitcnt lgkmcnt(14)
    v_mfma_f32_16x16x32_bf16 v[248:251], a[196:199], a[36:39], v[248:251]
    ds_read_b64_tr_b16 a[228:229], v8 offset:27872
    ds_read_b64_tr_b16 a[230:231], v8 offset:32480
    v_mfma_f32_16x16x32_bf16 v[252:255], a[196:199], a[52:55], v[252:255]
    s_waitcnt lgkmcnt(14)
    s_waitcnt vmcnt(27)
    v_mfma_f32_16x16x32_bf16 v[120:123], a[200:203], a[40:43], v[120:123]
    ds_read_b64_tr_b16 a[232:233], v8 offset:27904
    ds_read_b64_tr_b16 a[234:235], v8 offset:32512
    v_mfma_f32_16x16x32_bf16 v[124:127], a[200:203], a[56:59], v[124:127]
    buffer_store_dwordx2 v[244:245], v11, s[36:39], s99 offen sc1
    s_waitcnt lgkmcnt(14)
    v_mfma_f32_16x16x32_bf16 v[136:139], a[204:207], a[40:43], v[136:139]
    ds_read_b64_tr_b16 a[236:237], v8 offset:36864
    ds_read_b64_tr_b16 a[238:239], v8 offset:41472
    v_mfma_f32_16x16x32_bf16 v[140:143], a[204:207], a[56:59], v[140:143]
    s_waitcnt lgkmcnt(14)
    v_mfma_f32_16x16x32_bf16 v[152:155], a[208:211], a[40:43], v[152:155]
    ds_read_b64_tr_b16 a[240:241], v8 offset:36896
    ds_read_b64_tr_b16 a[242:243], v8 offset:41504
    v_mfma_f32_16x16x32_bf16 v[156:159], a[208:211], a[56:59], v[156:159]
    s_waitcnt lgkmcnt(14)
    v_mfma_f32_16x16x32_bf16 v[168:171], a[212:215], a[40:43], v[168:171]
    ds_read_b64_tr_b16 a[244:245], v8 offset:36928
    ds_read_b64_tr_b16 a[246:247], v8 offset:41536
    v_mfma_f32_16x16x32_bf16 v[172:175], a[212:215], a[56:59], v[172:175]
    s_waitcnt lgkmcnt(14)
    v_mfma_f32_16x16x32_bf16 v[184:187], a[216:219], a[40:43], v[184:187]
    ds_read_b64_tr_b16 a[248:249], v8 offset:36960
    ds_read_b64_tr_b16 a[250:251], v8 offset:41568
    v_mfma_f32_16x16x32_bf16 v[188:191], a[216:219], a[56:59], v[188:191]
    s_waitcnt lgkmcnt(14)
    v_mfma_f32_16x16x32_bf16 v[200:203], a[220:223], a[40:43], v[200:203]
    ds_read_b64_tr_b16 a[252:253], v8 offset:36992
    ds_read_b64_tr_b16 a[254:255], v8 offset:41600
    v_mfma_f32_16x16x32_bf16 v[204:207], a[220:223], a[56:59], v[204:207]
    s_waitcnt lgkmcnt(14)
    v_mfma_f32_16x16x32_bf16 v[216:219], a[224:227], a[40:43], v[216:219]
    ds_read_b64_tr_b16 a[192:193], v8 offset:37024
    ds_read_b64_tr_b16 a[194:195], v8 offset:41632
    v_mfma_f32_16x16x32_bf16 v[220:223], a[224:227], a[56:59], v[220:223]
    s_waitcnt lgkmcnt(14)
    v_mfma_f32_16x16x32_bf16 v[232:235], a[228:231], a[40:43], v[232:235]
    ds_read_b64_tr_b16 a[196:197], v8 offset:37056
    ds_read_b64_tr_b16 a[198:199], v8 offset:41664
    v_mfma_f32_16x16x32_bf16 v[236:239], a[228:231], a[56:59], v[236:239]
    s_waitcnt lgkmcnt(14)
    v_mfma_f32_16x16x32_bf16 v[248:251], a[232:235], a[40:43], v[248:251]
    ds_read_b64_tr_b16 a[200:201], v8 offset:37088
    ds_read_b64_tr_b16 a[202:203], v8 offset:41696
    v_mfma_f32_16x16x32_bf16 v[252:255], a[232:235], a[56:59], v[252:255]
    s_waitcnt lgkmcnt(14)
    s_waitcnt vmcnt(26)
    v_mfma_f32_16x16x32_bf16 v[120:123], a[236:239], a[44:47], v[120:123]
    ds_read_b64_tr_b16 a[204:205], v8 offset:37120
    ds_read_b64_tr_b16 a[206:207], v8 offset:41728
    v_mfma_f32_16x16x32_bf16 v[124:127], a[236:239], a[60:63], v[124:127]
    s_waitcnt lgkmcnt(14)
    v_mfma_f32_16x16x32_bf16 v[136:139], a[240:243], a[44:47], v[136:139]
    ds_read_b64_tr_b16 a[208:209], v9 offset:29696
    ds_read_b64_tr_b16 a[210:211], v9 offset:34304
    v_mfma_f32_16x16x32_bf16 v[140:143], a[240:243], a[60:63], v[140:143]
    s_waitcnt lgkmcnt(14)
    v_mfma_f32_16x16x32_bf16 v[152:155], a[244:247], a[44:47], v[152:155]
    ds_read_b64_tr_b16 a[212:213], v9 offset:29728
    ds_read_b64_tr_b16 a[214:215], v9 offset:34336
    v_mfma_f32_16x16x32_bf16 v[156:159], a[244:247], a[60:63], v[156:159]
    s_waitcnt lgkmcnt(14)
    v_mfma_f32_16x16x32_bf16 v[168:171], a[248:251], a[44:47], v[168:171]
    ds_read_b64_tr_b16 a[216:217], v9 offset:29760
    ds_read_b64_tr_b16 a[218:219], v9 offset:34368
    v_mfma_f32_16x16x32_bf16 v[172:175], a[248:251], a[60:63], v[172:175]
    s_waitcnt lgkmcnt(14)
    v_mfma_f32_16x16x32_bf16 v[184:187], a[252:255], a[44:47], v[184:187]
    ds_read_b64_tr_b16 a[220:221], v9 offset:29792
    ds_read_b64_tr_b16 a[222:223], v9 offset:34400
    v_mfma_f32_16x16x32_bf16 v[188:191], a[252:255], a[60:63], v[188:191]
    s_waitcnt lgkmcnt(14)
    v_mfma_f32_16x16x32_bf16 v[200:203], a[192:195], a[44:47], v[200:203]
    ds_read_b64_tr_b16 a[224:225], v9 offset:29824
    ds_read_b64_tr_b16 a[226:227], v9 offset:34432
    v_mfma_f32_16x16x32_bf16 v[204:207], a[192:195], a[60:63], v[204:207]
    s_waitcnt lgkmcnt(14)
    v_mfma_f32_16x16x32_bf16 v[216:219], a[196:199], a[44:47], v[216:219]
    ds_read_b64_tr_b16 a[228:229], v9 offset:29856
    ds_read_b64_tr_b16 a[230:231], v9 offset:34464
    v_mfma_f32_16x16x32_bf16 v[220:223], a[196:199], a[60:63], v[220:223]
    s_waitcnt lgkmcnt(14)
    v_mfma_f32_16x16x32_bf16 v[232:235], a[200:203], a[44:47], v[232:235]
    ds_read_b64_tr_b16 a[232:233], v9 offset:29888
    ds_read_b64_tr_b16 a[234:235], v9 offset:34496
    v_mfma_f32_16x16x32_bf16 v[236:239], a[200:203], a[60:63], v[236:239]
    s_waitcnt lgkmcnt(14)
    v_mfma_f32_16x16x32_bf16 v[248:251], a[204:207], a[44:47], v[248:251]
    ds_read_b64_tr_b16 a[236:237], v9 offset:29920
    ds_read_b64_tr_b16 a[238:239], v9 offset:34528
    v_mfma_f32_16x16x32_bf16 v[252:255], a[204:207], a[60:63], v[252:255]
    s_waitcnt lgkmcnt(14)
    s_waitcnt vmcnt(24)
    v_mfma_f32_16x16x32_bf16 v[120:123], a[208:211], a[96:99], v[120:123]
    ds_read_b64_tr_b16 a[240:241], v9 offset:29952
    ds_read_b64_tr_b16 a[242:243], v9 offset:34560
    v_mfma_f32_16x16x32_bf16 v[124:127], a[208:211], a[112:115], v[124:127]
    s_waitcnt lgkmcnt(14)
    v_mfma_f32_16x16x32_bf16 v[136:139], a[212:215], a[96:99], v[136:139]
    ds_read_b64_tr_b16 a[244:245], v9 offset:38912
    ds_read_b64_tr_b16 a[246:247], v9 offset:43520
    v_mfma_f32_16x16x32_bf16 v[140:143], a[212:215], a[112:115], v[140:143]
    s_waitcnt lgkmcnt(14)
    v_mfma_f32_16x16x32_bf16 v[152:155], a[216:219], a[96:99], v[152:155]
    ds_read_b64_tr_b16 a[248:249], v9 offset:38944
    ds_read_b64_tr_b16 a[250:251], v9 offset:43552
    v_mfma_f32_16x16x32_bf16 v[156:159], a[216:219], a[112:115], v[156:159]
    s_waitcnt lgkmcnt(14)
    v_mfma_f32_16x16x32_bf16 v[168:171], a[220:223], a[96:99], v[168:171]
    ds_read_b64_tr_b16 a[252:253], v9 offset:38976
    ds_read_b64_tr_b16 a[254:255], v9 offset:43584
    v_mfma_f32_16x16x32_bf16 v[172:175], a[220:223], a[112:115], v[172:175]
    s_waitcnt lgkmcnt(14)
    v_mfma_f32_16x16x32_bf16 v[184:187], a[224:227], a[96:99], v[184:187]
    ds_read_b64_tr_b16 a[192:193], v9 offset:39008
    ds_read_b64_tr_b16 a[194:195], v9 offset:43616
    v_mfma_f32_16x16x32_bf16 v[188:191], a[224:227], a[112:115], v[188:191]
    s_waitcnt lgkmcnt(14)
    v_mfma_f32_16x16x32_bf16 v[200:203], a[228:231], a[96:99], v[200:203]
    ds_read_b64_tr_b16 a[196:197], v9 offset:39040
    ds_read_b64_tr_b16 a[198:199], v9 offset:43648
    v_mfma_f32_16x16x32_bf16 v[204:207], a[228:231], a[112:115], v[204:207]
    s_waitcnt lgkmcnt(14)
    v_mfma_f32_16x16x32_bf16 v[216:219], a[232:235], a[96:99], v[216:219]
    ds_read_b64_tr_b16 a[200:201], v9 offset:39072
    ds_read_b64_tr_b16 a[202:203], v9 offset:43680
    v_mfma_f32_16x16x32_bf16 v[220:223], a[232:235], a[112:115], v[220:223]
    s_waitcnt lgkmcnt(14)
    v_mfma_f32_16x16x32_bf16 v[232:235], a[236:239], a[96:99], v[232:235]
    ds_read_b64_tr_b16 a[204:205], v9 offset:39104
    ds_read_b64_tr_b16 a[206:207], v9 offset:43712
    v_mfma_f32_16x16x32_bf16 v[236:239], a[236:239], a[112:115], v[236:239]
    s_waitcnt lgkmcnt(14)
    v_mfma_f32_16x16x32_bf16 v[248:251], a[240:243], a[96:99], v[248:251]
    ds_read_b64_tr_b16 a[208:209], v9 offset:39136
    ds_read_b64_tr_b16 a[210:211], v9 offset:43744
    v_mfma_f32_16x16x32_bf16 v[252:255], a[240:243], a[112:115], v[252:255]
    s_waitcnt lgkmcnt(14)
    s_waitcnt vmcnt(22)
    v_mfma_f32_16x16x32_bf16 v[120:123], a[244:247], a[100:103], v[120:123]
    ds_read_b64_tr_b16 a[212:213], v9 offset:39168
    ds_read_b64_tr_b16 a[214:215], v9 offset:43776
    v_mfma_f32_16x16x32_bf16 v[124:127], a[244:247], a[116:119], v[124:127]
    s_waitcnt lgkmcnt(14)
    v_mfma_f32_16x16x32_bf16 v[136:139], a[248:251], a[100:103], v[136:139]
    ds_read_b64_tr_b16 a[216:217], v8 offset:46080
    ds_read_b64_tr_b16 a[218:219], v8 offset:50688
    v_mfma_f32_16x16x32_bf16 v[140:143], a[248:251], a[116:119], v[140:143]
    s_waitcnt lgkmcnt(14)
    v_mfma_f32_16x16x32_bf16 v[152:155], a[252:255], a[100:103], v[152:155]
    ds_read_b64_tr_b16 a[220:221], v8 offset:46112
    ds_read_b64_tr_b16 a[222:223], v8 offset:50720
    v_mfma_f32_16x16x32_bf16 v[156:159], a[252:255], a[116:119], v[156:159]
    s_waitcnt lgkmcnt(14)
    v_mfma_f32_16x16x32_bf16 v[168:171], a[192:195], a[100:103], v[168:171]
    ds_read_b64_tr_b16 a[224:225], v8 offset:46144
    ds_read_b64_tr_b16 a[226:227], v8 offset:50752
    v_mfma_f32_16x16x32_bf16 v[172:175], a[192:195], a[116:119], v[172:175]
    s_waitcnt lgkmcnt(14)
    v_mfma_f32_16x16x32_bf16 v[184:187], a[196:199], a[100:103], v[184:187]
    ds_read_b64_tr_b16 a[228:229], v8 offset:46176
    ds_read_b64_tr_b16 a[230:231], v8 offset:50784
    v_mfma_f32_16x16x32_bf16 v[188:191], a[196:199], a[116:119], v[188:191]
    s_waitcnt lgkmcnt(14)
    v_mfma_f32_16x16x32_bf16 v[200:203], a[200:203], a[100:103], v[200:203]
    ds_read_b64_tr_b16 a[232:233], v8 offset:46208
    ds_read_b64_tr_b16 a[234:235], v8 offset:50816
    v_mfma_f32_16x16x32_bf16 v[204:207], a[200:203], a[116:119], v[204:207]
    s_waitcnt lgkmcnt(14)
    v_mfma_f32_16x16x32_bf16 v[216:219], a[204:207], a[100:103], v[216:219]
    ds_read_b64_tr_b16 a[236:237], v8 offset:46240
    ds_read_b64_tr_b16 a[238:239], v8 offset:50848
    v_mfma_f32_16x16x32_bf16 v[220:223], a[204:207], a[116:119], v[220:223]
    s_waitcnt lgkmcnt(14)
    v_mfma_f32_16x16x32_bf16 v[232:235], a[208:211], a[100:103], v[232:235]
    ds_read_b64_tr_b16 a[240:241], v8 offset:46272
    ds_read_b64_tr_b16 a[242:243], v8 offset:50880
    v_mfma_f32_16x16x32_bf16 v[236:239], a[208:211], a[116:119], v[236:239]
    s_waitcnt lgkmcnt(14)
    v_mfma_f32_16x16x32_bf16 v[248:251], a[212:215], a[100:103], v[248:251]
    ds_read_b64_tr_b16 a[244:245], v8 offset:46304
    ds_read_b64_tr_b16 a[246:247], v8 offset:50912
    v_mfma_f32_16x16x32_bf16 v[252:255], a[212:215], a[116:119], v[252:255]
    s_waitcnt vmcnt(0)
    s_mov_b64 exec, 1
    buffer_store_dword v20, v24, s[36:39], s101 offen sc1
    s_mov_b64 exec, -1
    s_waitcnt lgkmcnt(14)
    s_waitcnt vmcnt(20)
    v_mfma_f32_16x16x32_bf16 v[120:123], a[216:219], a[104:107], v[120:123]
    ds_read_b64_tr_b16 a[248:249], v8 offset:46336
    ds_read_b64_tr_b16 a[250:251], v8 offset:50944
    v_mfma_f32_16x16x32_bf16 v[124:127], a[216:219], a[120:123], v[124:127]
    s_waitcnt lgkmcnt(14)
    v_mfma_f32_16x16x32_bf16 v[136:139], a[220:223], a[104:107], v[136:139]
    ds_read_b64_tr_b16 a[252:253], v8 offset:55296
    ds_read_b64_tr_b16 a[254:255], v8 offset:59904
    v_mfma_f32_16x16x32_bf16 v[140:143], a[220:223], a[120:123], v[140:143]
    s_waitcnt lgkmcnt(14)
    v_mfma_f32_16x16x32_bf16 v[152:155], a[224:227], a[104:107], v[152:155]
    ds_read_b64_tr_b16 a[192:193], v8 offset:55328
    ds_read_b64_tr_b16 a[194:195], v8 offset:59936
    v_mfma_f32_16x16x32_bf16 v[156:159], a[224:227], a[120:123], v[156:159]
    s_waitcnt lgkmcnt(14)
    v_mfma_f32_16x16x32_bf16 v[168:171], a[228:231], a[104:107], v[168:171]
    ds_read_b64_tr_b16 a[196:197], v8 offset:55360
    ds_read_b64_tr_b16 a[198:199], v8 offset:59968
    v_mfma_f32_16x16x32_bf16 v[172:175], a[228:231], a[120:123], v[172:175]
    s_waitcnt lgkmcnt(14)
    v_mfma_f32_16x16x32_bf16 v[184:187], a[232:235], a[104:107], v[184:187]
    ds_read_b64_tr_b16 a[200:201], v8 offset:55392
    ds_read_b64_tr_b16 a[202:203], v8 offset:60000
    v_mfma_f32_16x16x32_bf16 v[188:191], a[232:235], a[120:123], v[188:191]
    s_waitcnt lgkmcnt(14)
    v_mfma_f32_16x16x32_bf16 v[200:203], a[236:239], a[104:107], v[200:203]
    ds_read_b64_tr_b16 a[204:205], v8 offset:55424
    ds_read_b64_tr_b16 a[206:207], v8 offset:60032
    v_mfma_f32_16x16x32_bf16 v[204:207], a[236:239], a[120:123], v[204:207]
    s_waitcnt lgkmcnt(14)
    v_mfma_f32_16x16x32_bf16 v[216:219], a[240:243], a[104:107], v[216:219]
    ds_read_b64_tr_b16 a[208:209], v8 offset:55456
    ds_read_b64_tr_b16 a[210:211], v8 offset:60064
    v_mfma_f32_16x16x32_bf16 v[220:223], a[240:243], a[120:123], v[220:223]
    s_waitcnt lgkmcnt(14)
    v_mfma_f32_16x16x32_bf16 v[232:235], a[244:247], a[104:107], v[232:235]
    ds_read_b64_tr_b16 a[212:213], v8 offset:55488
    ds_read_b64_tr_b16 a[214:215], v8 offset:60096
    v_mfma_f32_16x16x32_bf16 v[236:239], a[244:247], a[120:123], v[236:239]
    s_waitcnt lgkmcnt(14)
    v_mfma_f32_16x16x32_bf16 v[248:251], a[248:251], a[104:107], v[248:251]
    ds_read_b64_tr_b16 a[216:217], v8 offset:55520
    ds_read_b64_tr_b16 a[218:219], v8 offset:60128
    v_mfma_f32_16x16x32_bf16 v[252:255], a[248:251], a[120:123], v[252:255]
    s_waitcnt lgkmcnt(14)
    s_waitcnt vmcnt(19)
    v_mfma_f32_16x16x32_bf16 v[120:123], a[252:255], a[108:111], v[120:123]
    ds_read_b64_tr_b16 a[220:221], v8 offset:55552
    ds_read_b64_tr_b16 a[222:223], v8 offset:60160
    v_mfma_f32_16x16x32_bf16 v[124:127], a[252:255], a[124:127], v[124:127]
    s_waitcnt lgkmcnt(14)
    v_mfma_f32_16x16x32_bf16 v[136:139], a[192:195], a[108:111], v[136:139]
    ds_read_b64_tr_b16 a[224:225], v9 offset:48128
    ds_read_b64_tr_b16 a[226:227], v9 offset:52736
    v_mfma_f32_16x16x32_bf16 v[140:143], a[192:195], a[124:127], v[140:143]
    s_waitcnt lgkmcnt(14)
    v_mfma_f32_16x16x32_bf16 v[152:155], a[196:199], a[108:111], v[152:155]
    ds_read_b64_tr_b16 a[228:229], v9 offset:48160
    ds_read_b64_tr_b16 a[230:231], v9 offset:52768
    v_mfma_f32_16x16x32_bf16 v[156:159], a[196:199], a[124:127], v[156:159]
    s_waitcnt lgkmcnt(14)
    v_mfma_f32_16x16x32_bf16 v[168:171], a[200:203], a[108:111], v[168:171]
    ds_read_b64_tr_b16 a[232:233], v9 offset:48192
    ds_read_b64_tr_b16 a[234:235], v9 offset:52800
    v_mfma_f32_16x16x32_bf16 v[172:175], a[200:203], a[124:127], v[172:175]
    s_waitcnt lgkmcnt(14)
    v_mfma_f32_16x16x32_bf16 v[184:187], a[204:207], a[108:111], v[184:187]
    ds_read_b64_tr_b16 a[236:237], v9 offset:48224
    ds_read_b64_tr_b16 a[238:239], v9 offset:52832
    v_mfma_f32_16x16x32_bf16 v[188:191], a[204:207], a[124:127], v[188:191]
    s_waitcnt lgkmcnt(14)
    v_mfma_f32_16x16x32_bf16 v[200:203], a[208:211], a[108:111], v[200:203]
    ds_read_b64_tr_b16 a[240:241], v9 offset:48256
    ds_read_b64_tr_b16 a[242:243], v9 offset:52864
    v_mfma_f32_16x16x32_bf16 v[204:207], a[208:211], a[124:127], v[204:207]
    s_waitcnt lgkmcnt(14)
    v_mfma_f32_16x16x32_bf16 v[216:219], a[212:215], a[108:111], v[216:219]
    ds_read_b64_tr_b16 a[244:245], v9 offset:48288
    ds_read_b64_tr_b16 a[246:247], v9 offset:52896
    v_mfma_f32_16x16x32_bf16 v[220:223], a[212:215], a[124:127], v[220:223]
    s_waitcnt lgkmcnt(14)
    v_mfma_f32_16x16x32_bf16 v[232:235], a[216:219], a[108:111], v[232:235]
    ds_read_b64_tr_b16 a[248:249], v9 offset:48320
    ds_read_b64_tr_b16 a[250:251], v9 offset:52928
    v_mfma_f32_16x16x32_bf16 v[236:239], a[216:219], a[124:127], v[236:239]
    s_waitcnt lgkmcnt(14)
    v_mfma_f32_16x16x32_bf16 v[248:251], a[220:223], a[108:111], v[248:251]
    ds_read_b64_tr_b16 a[252:253], v9 offset:48352
    ds_read_b64_tr_b16 a[254:255], v9 offset:52960
    v_mfma_f32_16x16x32_bf16 v[252:255], a[220:223], a[124:127], v[252:255]
    s_waitcnt lgkmcnt(14)
    s_waitcnt vmcnt(17)
    v_mfma_f32_16x16x32_bf16 v[120:123], a[224:227], a[160:163], v[120:123]
    ds_read_b64_tr_b16 a[192:193], v9 offset:48384
    ds_read_b64_tr_b16 a[194:195], v9 offset:52992
    v_mfma_f32_16x16x32_bf16 v[124:127], a[224:227], a[176:179], v[124:127]
    s_waitcnt lgkmcnt(14)
    v_mfma_f32_16x16x32_bf16 v[136:139], a[228:231], a[160:163], v[136:139]
    ds_read_b64_tr_b16 a[196:197], v9 offset:57344
    ds_read_b64_tr_b16 a[198:199], v9 offset:61952
    v_mfma_f32_16x16x32_bf16 v[140:143], a[228:231], a[176:179], v[140:143]
    s_waitcnt lgkmcnt(14)
    v_mfma_f32_16x16x32_bf16 v[152:155], a[232:235], a[160:163], v[152:155]
    ds_read_b64_tr_b16 a[200:201], v9 offset:57376
    ds_read_b64_tr_b16 a[202:203], v9 offset:61984
    v_mfma_f32_16x16x32_bf16 v[156:159], a[232:235], a[176:179], v[156:159]
    s_waitcnt lgkmcnt(14)
    v_mfma_f32_16x16x32_bf16 v[168:171], a[236:239], a[160:163], v[168:171]
    ds_read_b64_tr_b16 a[204:205], v9 offset:57408
    ds_read_b64_tr_b16 a[206:207], v9 offset:62016
    v_mfma_f32_16x16x32_bf16 v[172:175], a[236:239], a[176:179], v[172:175]
    s_waitcnt lgkmcnt(14)
    v_mfma_f32_16x16x32_bf16 v[184:187], a[240:243], a[160:163], v[184:187]
    ds_read_b64_tr_b16 a[208:209], v9 offset:57440
    ds_read_b64_tr_b16 a[210:211], v9 offset:62048
    v_mfma_f32_16x16x32_bf16 v[188:191], a[240:243], a[176:179], v[188:191]
    s_waitcnt lgkmcnt(14)
    v_mfma_f32_16x16x32_bf16 v[200:203], a[244:247], a[160:163], v[200:203]
    ds_read_b64_tr_b16 a[212:213], v9 offset:57472
    ds_read_b64_tr_b16 a[214:215], v9 offset:62080
    v_mfma_f32_16x16x32_bf16 v[204:207], a[244:247], a[176:179], v[204:207]
    s_waitcnt lgkmcnt(14)
    v_mfma_f32_16x16x32_bf16 v[216:219], a[248:251], a[160:163], v[216:219]
    ds_read_b64_tr_b16 a[216:217], v9 offset:57504
    ds_read_b64_tr_b16 a[218:219], v9 offset:62112
    v_mfma_f32_16x16x32_bf16 v[220:223], a[248:251], a[176:179], v[220:223]
    s_waitcnt lgkmcnt(14)
    v_mfma_f32_16x16x32_bf16 v[232:235], a[252:255], a[160:163], v[232:235]
    ds_read_b64_tr_b16 a[220:221], v9 offset:57536
    ds_read_b64_tr_b16 a[222:223], v9 offset:62144
    v_mfma_f32_16x16x32_bf16 v[236:239], a[252:255], a[176:179], v[236:239]
    s_waitcnt lgkmcnt(14)
    v_mfma_f32_16x16x32_bf16 v[248:251], a[192:195], a[160:163], v[248:251]
    ds_read_b64_tr_b16 a[224:225], v9 offset:57568
    ds_read_b64_tr_b16 a[226:227], v9 offset:62176
    v_mfma_f32_16x16x32_bf16 v[252:255], a[192:195], a[176:179], v[252:255]
    s_waitcnt lgkmcnt(14)
    s_waitcnt vmcnt(15)
    v_mfma_f32_16x16x32_bf16 v[120:123], a[196:199], a[164:167], v[120:123]
    ds_read_b64_tr_b16 a[228:229], v9 offset:57600
    ds_read_b64_tr_b16 a[230:231], v9 offset:62208
    v_mfma_f32_16x16x32_bf16 v[124:127], a[196:199], a[180:183], v[124:127]
    s_waitcnt lgkmcnt(14)
    v_mfma_f32_16x16x32_bf16 v[136:139], a[200:203], a[164:167], v[136:139]
    ds_read_b64_tr_b16 a[232:233], v10 offset:5120
    ds_read_b64_tr_b16 a[234:235], v10 offset:9728
    v_mfma_f32_16x16x32_bf16 v[140:143], a[200:203], a[180:183], v[140:143]
    s_waitcnt lgkmcnt(14)
    v_mfma_f32_16x16x32_bf16 v[152:155], a[204:207], a[164:167], v[152:155]
    ds_read_b64_tr_b16 a[236:237], v10 offset:5152
    ds_read_b64_tr_b16 a[238:239], v10 offset:9760
    v_mfma_f32_16x16x32_bf16 v[156:159], a[204:207], a[180:183], v[156:159]
    s_waitcnt lgkmcnt(14)
    v_mfma_f32_16x16x32_bf16 v[168:171], a[208:211], a[164:167], v[168:171]
    ds_read_b64_tr_b16 a[240:241], v10 offset:5184
    ds_read_b64_tr_b16 a[242:243], v10 offset:9792
    v_mfma_f32_16x16x32_bf16 v[172:175], a[208:211], a[180:183], v[172:175]
    s_waitcnt lgkmcnt(14)
    v_mfma_f32_16x16x32_bf16 v[184:187], a[212:215], a[164:167], v[184:187]
    ds_read_b64_tr_b16 a[244:245], v10 offset:5216
    ds_read_b64_tr_b16 a[246:247], v10 offset:9824
    v_mfma_f32_16x16x32_bf16 v[188:191], a[212:215], a[180:183], v[188:191]
    s_waitcnt lgkmcnt(14)
    v_mfma_f32_16x16x32_bf16 v[200:203], a[216:219], a[164:167], v[200:203]
    ds_read_b64_tr_b16 a[248:249], v10 offset:5248
    ds_read_b64_tr_b16 a[250:251], v10 offset:9856
    v_mfma_f32_16x16x32_bf16 v[204:207], a[216:219], a[180:183], v[204:207]
    s_waitcnt lgkmcnt(14)
    v_mfma_f32_16x16x32_bf16 v[216:219], a[220:223], a[164:167], v[216:219]
    ds_read_b64_tr_b16 a[252:253], v10 offset:5280
    ds_read_b64_tr_b16 a[254:255], v10 offset:9888
    v_mfma_f32_16x16x32_bf16 v[220:223], a[220:223], a[180:183], v[220:223]
    s_waitcnt lgkmcnt(14)
    v_mfma_f32_16x16x32_bf16 v[232:235], a[224:227], a[164:167], v[232:235]
    ds_read_b64_tr_b16 a[192:193], v10 offset:5312
    ds_read_b64_tr_b16 a[194:195], v10 offset:9920
    v_mfma_f32_16x16x32_bf16 v[236:239], a[224:227], a[180:183], v[236:239]
    s_waitcnt lgkmcnt(14)
    v_mfma_f32_16x16x32_bf16 v[248:251], a[228:231], a[164:167], v[248:251]
    ds_read_b64_tr_b16 a[196:197], v10 offset:5344
    ds_read_b64_tr_b16 a[198:199], v10 offset:9952
    v_mfma_f32_16x16x32_bf16 v[252:255], a[228:231], a[180:183], v[252:255]
    v_lshlrev_b32 v16, 4, v1
    s_lshl_b32 s55, s3, 10
    v_mov_b32 v17, v11
    v_add_u32 v16, s55, v16
    s_cmp_ge_u32 s3, 1
    s_cselect_b32 s55, 0x40000000, 0
    v_add_u32 v17, s55, v17
    v_and_b32 v18, 15, v1
    v_mul_u32_u24 v18, 1152, v18
    v_lshrrev_b32 v19, 4, v1
    v_lshl_add_u32 v18, v19, 3, v18
    v_and_b32 v2, 7, v1
    v_lshlrev_b32 v2, 2, v2
    v_add_u32 v2, s69, v2
    v_lshlrev_b32 v2, 7, v2
    s_lshr_b32 s54, s68, 1
    s_lshl_b32 s54, s54, 3
    s_add_u32 s54, s54, 16
    v_add_u32 v2, s54, v2
    s_lshl_b32 s54, s64, 12
    s_add_u32 s54, s54, 62914560
    s_mov_b32 s59, 0
    s_mov_b32 s56, 0
    s_add_u32 s88, s54, 65536
L_poll_f2a:
    s_and_b32 s55, s59, 0
    s_cmp_eq_u32 s55, 0
    s_cselect_b32 s89, s54, s88
    s_add_u32 s59, s59, 1
    buffer_load_dword v3, v2, s[36:39], s89 offen sc1
    s_waitcnt vmcnt(0)
    v_cmp_eq_u32 vcc, 1, v3
    s_nop 1
    s_or_b32 s56, s56, vcc_lo
    s_and_b32 s55, s56, 255
    s_cmp_eq_u32 s55, 255
    s_cbranch_scc1 L_pollx_f2a
    s_sleep 4
    s_cmp_ge_u32 s59, 0x8000
    s_cbranch_scc0 L_poll_f2a
L_pollx_f2a:
    s_waitcnt lgkmcnt(14)
    s_waitcnt vmcnt(13)
    v_mfma_f32_16x16x32_bf16 v[120:123], a[232:235], a[168:171], v[120:123]
    ds_read_b64_tr_b16 a[200:201], v10 offset:5376
    ds_read_b64_tr_b16 a[202:203], v10 offset:9984
    v_mfma_f32_16x16x32_bf16 v[124:127], a[232:235], a[184:187], v[124:127]
    s_add_u32 s55, s14, 0
    buffer_load_dwordx4 v[32:35], v16, s[36:39], s55 offen
    buffer_load_dwordx2 v[64:65], v17, s[36:39], s55 offen
    s_waitcnt lgkmcnt(14)
    v_mfma_f32_16x16x32_bf16 v[136:139], a[236:239], a[168:171], v[136:139]
    ds_read_b64_tr_b16 a[204:205], v9 offset:4096
    ds_read_b64_tr_b16 a[206:207], v9 offset:8704
    v_mfma_f32_16x16x32_bf16 v[140:143], a[236:239], a[184:187], v[140:143]
    s_add_u32 s55, s14, 5120
    buffer_load_dwordx4 v[36:39], v16, s[36:39], s55 offen
    buffer_load_dwordx2 v[66:67], v17, s[36:39], s55 offen
    s_waitcnt lgkmcnt(14)
    v_mfma_f32_16x16x32_bf16 v[152:155], a[240:243], a[168:171], v[152:155]
    ds_read_b64_tr_b16 a[208:209], v9 offset:4128
    ds_read_b64_tr_b16 a[210:211], v9 offset:8736
    v_mfma_f32_16x16x32_bf16 v[156:159], a[240:243], a[184:187], v[156:159]
    s_add_u32 s55, s14, 10240
    buffer_load_dwordx4 v[40:43], v16, s[36:39], s55 offen
    buffer_load_dwordx2 v[68:69], v17, s[36:39], s55 offen
    s_waitcnt lgkmcnt(14)
    v_mfma_f32_16x16x32_bf16 v[168:171], a[244:247], a[168:171], v[168:171]
    ds_read_b64_tr_b16 a[212:213], v9 offset:4160
    ds_read_b64_tr_b16 a[214:215], v9 offset:8768
    v_mfma_f32_16x16x32_bf16 v[172:175], a[244:247], a[184:187], v[172:175]
    s_add_u32 s55, s14, 15360
    buffer_load_dwordx4 v[44:47], v16, s[36:39], s55 offen
    buffer_load_dwordx2 v[70:71], v17, s[36:39], s55 offen
    s_waitcnt lgkmcnt(14)
    v_mfma_f32_16x16x32_bf16 v[184:187], a[248:251], a[168:171], v[184:187]
    ds_read_b64_tr_b16 a[216:217], v9 offset:4192
    ds_read_b64_tr_b16 a[218:219], v9 offset:8800
    v_mfma_f32_16x16x32_bf16 v[188:191], a[248:251], a[184:187], v[188:191]
    s_add_u32 s55, s14, 20480
    buffer_load_dwordx4 v[48:51], v16, s[36:39], s55 offen
    buffer_load_dwordx2 v[72:73], v17, s[36:39], s55 offen
    s_waitcnt lgkmcnt(14)
    v_mfma_f32_16x16x32_bf16 v[200:203], a[252:255], a[168:171], v[200:203]
    ds_read_b64_tr_b16 a[220:221], v9 offset:4224
    ds_read_b64_tr_b16 a[222:223], v9 offset:8832
    v_mfma_f32_16x16x32_bf16 v[204:207], a[252:255], a[184:187], v[204:207]
    s_add_u32 s55, s14, 25600
    buffer_load_dwordx4 v[52:55], v16, s[36:39], s55 offen
    buffer_load_dwordx2 v[74:75], v17, s[36:39], s55 offen
    s_waitcnt lgkmcnt(14)
    v_mfma_f32_16x16x32_bf16 v[216:219], a[192:195], a[168:171], v[216:219]
    ds_read_b64_tr_b16 a[224:225], v9 offset:4256
    ds_read_b64_tr_b16 a[226:227], v9 offset:8864
    v_mfma_f32_16x16x32_bf16 v[220:223], a[192:195], a[184:187], v[220:223]
    s_add_u32 s55, s14, 30720
    buffer_load_dwordx4 v[56:59], v16, s[36:39], s55 offen
    buffer_load_dwordx2 v[76:77], v17, s[36:39], s55 offen
    s_waitcnt lgkmcnt(14)
    v_mfma_f32_16x16x32_bf16 v[232:235], a[196:199], a[168:171], v[232:235]
    ds_read_b64_tr_b16 a[228:229], v9 offset:4288
    ds_read_b64_tr_b16 a[230:231], v9 offset:8896
    v_mfma_f32_16x16x32_bf16 v[236:239], a[196:199], a[184:187], v[236:239]
    s_add_u32 s55, s14, 35840
    buffer_load_dwordx4 v[60:63], v16, s[36:39], s55 offen
    buffer_load_dwordx2 v[78:79], v17, s[36:39], s55 offen
    s_waitcnt lgkmcnt(14)
    v_mfma_f32_16x16x32_bf16 v[248:251], a[200:203], a[168:171], v[248:251]
    ds_read_b64_tr_b16 a[232:233], v9 offset:4320
    ds_read_b64_tr_b16 a[234:235], v9 offset:8928
    v_mfma_f32_16x16x32_bf16 v[252:255], a[200:203], a[184:187], v[252:255]
    s_waitcnt lgkmcnt(14)
    s_waitcnt vmcnt(27)
    v_mfma_f32_16x16x32_bf16 v[120:123], a[204:207], a[172:175], v[120:123]
    ds_read_b64_tr_b16 a[236:237], v9 offset:4352
    ds_read_b64_tr_b16 a[238:239], v9 offset:8960
    v_mfma_f32_16x16x32_bf16 v[124:127], a[204:207], a[188:191], v[124:127]
    s_waitcnt lgkmcnt(14)
    v_mfma_f32_16x16x32_bf16 v[136:139], a[208:211], a[172:175], v[136:139]
    v_mfma_f32_16x16x32_bf16 v[140:143], a[208:211], a[188:191], v[140:143]
    s_waitcnt lgkmcnt(12)
    v_mfma_f32_16x16x32_bf16 v[152:155], a[212:215], a[172:175], v[152:155]
    v_mfma_f32_16x16x32_bf16 v[156:159], a[212:215], a[188:191], v[156:159]
    s_waitcnt lgkmcnt(10)
    v_mfma_f32_16x16x32_bf16 v[168:171], a[216:219], a[172:175], v[168:171]
    v_mfma_f32_16x16x32_bf16 v[172:175], a[216:219], a[188:191], v[172:175]
    s_waitcnt lgkmcnt(8)
    v_mfma_f32_16x16x32_bf16 v[184:187], a[220:223], a[172:175], v[184:187]
    v_mfma_f32_16x16x32_bf16 v[188:191], a[220:223], a[188:191], v[188:191]
    s_waitcnt lgkmcnt(6)
    v_mfma_f32_16x16x32_bf16 v[200:203], a[224:227], a[172:175], v[200:203]
    v_mfma_f32_16x16x32_bf16 v[204:207], a[224:227], a[188:191], v[204:207]
    s_waitcnt lgkmcnt(4)
    v_mfma_f32_16x16x32_bf16 v[216:219], a[228:231], a[172:175], v[216:219]
    v_mfma_f32_16x16x32_bf16 v[220:223], a[228:231], a[188:191], v[220:223]
    s_waitcnt lgkmcnt(2)
    v_mfma_f32_16x16x32_bf16 v[232:235], a[232:235], a[172:175], v[232:235]
    v_mfma_f32_16x16x32_bf16 v[236:239], a[232:235], a[188:191], v[236:239]
    s_waitcnt lgkmcnt(0)
    v_mfma_f32_16x16x32_bf16 v[248:251], a[236:239], a[172:175], v[248:251]
    v_mfma_f32_16x16x32_bf16 v[252:255], a[236:239], a[188:191], v[252:255]
    s_nop 4
    v_cvt_pk_bf16_f32 v120, v120, v121
    v_cvt_pk_bf16_f32 v121, v122, v123
    v_cvt_pk_bf16_f32 v122, v136, v137
    v_cvt_pk_bf16_f32 v123, v138, v139
    v_cvt_pk_bf16_f32 v152, v152, v153
    v_cvt_pk_bf16_f32 v153, v154, v155
    v_cvt_pk_bf16_f32 v154, v168, v169
    v_cvt_pk_bf16_f32 v155, v170, v171
    v_cvt_pk_bf16_f32 v184, v184, v185
    v_cvt_pk_bf16_f32 v185, v186, v187
    v_cvt_pk_bf16_f32 v186, v200, v201
    v_cvt_pk_bf16_f32 v187, v202, v203
    v_cvt_pk_bf16_f32 v216, v216, v217
    v_cvt_pk_bf16_f32 v217, v218, v219
    v_cvt_pk_bf16_f32 v218, v232, v233
    v_cvt_pk_bf16_f32 v219, v234, v235
    v_cvt_pk_bf16_f32 v248, v248, v249
    v_cvt_pk_bf16_f32 v249, v250, v251
    s_add_u32 s99, s100, 40960
    buffer_store_dwordx4 v[120:123], v12, s[36:39], s99 offen offset:0 sc1
    buffer_store_dwordx4 v[152:155], v12, s[36:39], s99 offen offset:1024 sc1
    buffer_store_dwordx4 v[184:187], v12, s[36:39], s99 offen offset:2048 sc1
    buffer_store_dwordx4 v[216:219], v12, s[36:39], s99 offen offset:3072 sc1
    buffer_store_dwordx2 v[248:249], v11, s[36:39], s99 offen sc1
    v_cvt_pk_bf16_f32 v124, v124, v125
    v_cvt_pk_bf16_f32 v125, v126, v127
    v_cvt_pk_bf16_f32 v126, v140, v141
    v_cvt_pk_bf16_f32 v127, v142, v143
    v_cvt_pk_bf16_f32 v156, v156, v157
    v_cvt_pk_bf16_f32 v157, v158, v159
    v_cvt_pk_bf16_f32 v158, v172, v173
    v_cvt_pk_bf16_f32 v159, v174, v175
    v_cvt_pk_bf16_f32 v188, v188, v189
    v_cvt_pk_bf16_f32 v189, v190, v191
    v_cvt_pk_bf16_f32 v190, v204, v205
    v_cvt_pk_bf16_f32 v191, v206, v207
    v_cvt_pk_bf16_f32 v220, v220, v221
    v_cvt_pk_bf16_f32 v221, v222, v223
    v_cvt_pk_bf16_f32 v222, v236, v237
    v_cvt_pk_bf16_f32 v223, v238, v239
    v_cvt_pk_bf16_f32 v252, v252, v253
    v_cvt_pk_bf16_f32 v253, v254, v255
    s_add_u32 s99, s100, 122880
    buffer_store_dwordx4 v[124:127], v12, s[36:39], s99 offen offset:0 sc1
    buffer_store_dwordx4 v[156:159], v12, s[36:39], s99 offen offset:1024 sc1
    buffer_store_dwordx4 v[188:191], v12, s[36:39], s99 offen offset:2048 sc1
    buffer_store_dwordx4 v[220:223], v12, s[36:39], s99 offen offset:3072 sc1
    buffer_store_dwordx2 v[252:253], v11, s[36:39], s99 offen sc1
    s_waitcnt vmcnt(0)
    s_mov_b64 exec, 1
    buffer_store_dword v20, v25, s[36:39], s101 offen sc1
    s_mov_b64 exec, -1
    s_waitcnt vmcnt(11)
    s_mov_b32 s55, 0x00003f80
    s_mov_b32 s56, 0x3f800000
    v_dot2_f32_bf16 v80, v32, s55, 0
    v_dot2_f32_bf16 v81, v32, s56, 0
    v_dot2_f32_bf16 v82, v33, s55, 0
    v_dot2_f32_bf16 v83, v33, s56, 0
    v_dot2_f32_bf16 v84, v34, s55, 0
    v_dot2_f32_bf16 v85, v34, s56, 0
    v_dot2_f32_bf16 v86, v35, s55, 0
    v_dot2_f32_bf16 v87, v35, s56, 0
    v_dot2_f32_bf16 v88, v64, s55, 0
    v_dot2_f32_bf16 v89, v64, s56, 0
    v_dot2_f32_bf16 v90, v65, s55, 0
    v_dot2_f32_bf16 v91, v65, s56, 0
    v_dot2_f32_bf16 v80, v36, s55, v80
    v_dot2_f32_bf16 v81, v36, s56, v81
    v_dot2_f32_bf16 v82, v37, s55, v82
    v_dot2_f32_bf16 v83, v37, s56, v83
    v_dot2_f32_bf16 v84, v38, s55, v84
    v_dot2_f32_bf16 v85, v38, s56, v85
    v_dot2_f32_bf16 v86, v39, s55, v86
    v_dot2_f32_bf16 v87, v39, s56, v87
    v_dot2_f32_bf16 v88, v66, s55, v88
    v_dot2_f32_bf16 v89, v66, s56, v89
    v_dot2_f32_bf16 v90, v67, s55, v90
    v_dot2_f32_bf16 v91, v67, s56, v91
    v_dot2_f32_bf16 v80, v40, s55, v80
    v_dot2_f32_bf16 v81, v40, s56, v81
    v_dot2_f32_bf16 v82, v41, s55, v82
    v_dot2_f32_bf16 v83, v41, s56, v83
    v_dot2_f32_bf16 v84, v42, s55, v84
    v_dot2_f32_bf16 v85, v42, s56, v85
    v_dot2_f32_bf16 v86, v43, s55, v86
    v_dot2_f32_bf16 v87, v43, s56, v87
    v_dot2_f32_bf16 v88, v68, s55, v88
    v_dot2_f32_bf16 v89, v68, s56, v89
    v_dot2_f32_bf16 v90, v69, s55, v90
    v_dot2_f32_bf16 v91, v69, s56, v91
    v_dot2_f32_bf16 v80, v44, s55, v80
    v_dot2_f32_bf16 v81, v44, s56, v81
    v_dot2_f32_bf16 v82, v45, s55, v82
    v_dot2_f32_bf16 v83, v45, s56, v83
    v_dot2_f32_bf16 v84, v46, s55, v84
    v_dot2_f32_bf16 v85, v46, s56, v85
    v_dot2_f32_bf16 v86, v47, s55, v86
    v_dot2_f32_bf16 v87, v47, s56, v87
    v_dot2_f32_bf16 v88, v70, s55, v88
    v_dot2_f32_bf16 v89, v70, s56, v89
    v_dot2_f32_bf16 v90, v71, s55, v90
    v_dot2_f32_bf16 v91, v71, s56, v91
    v_dot2_f32_bf16 v80, v48, s55, v80
    v_dot2_f32_bf16 v81, v48, s56, v81
    v_dot2_f32_bf16 v82, v49, s55, v82
    v_dot2_f32_bf16 v83, v49, s56, v83
    v_dot2_f32_bf16 v84, v50, s55, v84
    v_dot2_f32_bf16 v85, v50, s56, v85
    v_dot2_f32_bf16 v86, v51, s55, v86
    v_dot2_f32_bf16 v87, v51, s56, v87
    v_dot2_f32_bf16 v88, v72, s55, v88
    v_dot2_f32_bf16 v89, v72, s56, v89
    v_dot2_f32_bf16 v90, v73, s55, v90
    v_dot2_f32_bf16 v91, v73, s56, v91
    v_dot2_f32_bf16 v80, v52, s55, v80
    v_dot2_f32_bf16 v81, v52, s56, v81
    v_dot2_f32_bf16 v82, v53, s55, v82
    v_dot2_f32_bf16 v83, v53, s56, v83
    v_dot2_f32_bf16 v84, v54, s55, v84
    v_dot2_f32_bf16 v85, v54, s56, v85
    v_dot2_f32_bf16 v86, v55, s55, v86
    v_dot2_f32_bf16 v87, v55, s56, v87
    v_dot2_f32_bf16 v88, v74, s55, v88
    v_dot2_f32_bf16 v89, v74, s56, v89
    v_dot2_f32_bf16 v90, v75, s55, v90
    v_dot2_f32_bf16 v91, v75, s56, v91
    v_dot2_f32_bf16 v80, v56, s55, v80
    v_dot2_f32_bf16 v81, v56, s56, v81
    v_dot2_f32_bf16 v82, v57, s55, v82
    v_dot2_f32_bf16 v83, v57, s56, v83
    v_dot2_f32_bf16 v84, v58, s55, v84
    v_dot2_f32_bf16 v85, v58, s56, v85
    v_dot2_f32_bf16 v86, v59, s55, v86
    v_dot2_f32_bf16 v87, v59, s56, v87
    v_dot2_f32_bf16 v88, v76, s55, v88
    v_dot2_f32_bf16 v89, v76, s56, v89
    v_dot2_f32_bf16 v90, v77, s55, v90
    v_dot2_f32_bf16 v91, v77, s56, v91
    v_dot2_f32_bf16 v80, v60, s55, v80
    v_dot2_f32_bf16 v81, v60, s56, v81
    v_dot2_f32_bf16 v82, v61, s55, v82
    v_dot2_f32_bf16 v83, v61, s56, v83
    v_dot2_f32_bf16 v84, v62, s55, v84
    v_dot2_f32_bf16 v85, v62, s56, v85
    v_dot2_f32_bf16 v86, v63, s55, v86
    v_dot2_f32_bf16 v87, v63, s56, v87
    v_dot2_f32_bf16 v88, v78, s55, v88
    v_dot2_f32_bf16 v89, v78, s56, v89
    v_dot2_f32_bf16 v90, v79, s55, v90
    v_dot2_f32_bf16 v91, v79, s56, v91
    s_nop 2
    v_cvt_pk_bf16_f32 v92, v80, v81
    v_cvt_pk_bf16_f32 v93, v82, v83
    v_cvt_pk_bf16_f32 v94, v84, v85
    v_cvt_pk_bf16_f32 v95, v86, v87
    v_cvt_pk_bf16_f32 v96, v88, v89
    v_cvt_pk_bf16_f32 v97, v90, v91
    s_add_u32 s54, s15, 0
    s_cmp_ge_u32 s3, 1
    s_cselect_b32 s55, 0x7ffff000, s54
    s_lshl_b32 s56, s3, 6
    s_add_u32 s54, s54, s56
    buffer_store_dwordx2 v[92:93], v18, s[44:47], s54 offen
    buffer_store_dwordx2 v[94:95], v18, s[44:47], s54 offen offset:32
    buffer_store_dwordx2 v[96:97], v18, s[44:47], s55 offen offset:256
    v_and_b32 v2, 7, v1
    v_lshlrev_b32 v2, 2, v2
    v_add_u32 v2, s69, v2
    v_lshlrev_b32 v2, 7, v2
    s_lshr_b32 s54, s68, 1
    s_lshl_b32 s54, s54, 3
    s_add_u32 s54, s54, 20
    v_add_u32 v2, s54, v2
    s_lshl_b32 s54, s64, 12
    s_add_u32 s54, s54, 62914560
    s_mov_b32 s59, 0
    s_mov_b32 s56, 0
    s_add_u32 s88, s54, 65536
L_poll_f2b:
    s_and_b32 s55, s59, 0
    s_cmp_eq_u32 s55, 0
    s_cselect_b32 s89, s54, s88
    s_add_u32 s59, s59, 1
    buffer_load_dword v3, v2, s[36:39], s89 offen sc1
    s_waitcnt vmcnt(0)
    v_cmp_eq_u32 vcc, 1, v3
    s_nop 1
    s_or_b32 s56, s56, vcc_lo
    s_and_b32 s55, s56, 255
    s_cmp_eq_u32 s55, 255
    s_cbranch_scc1 L_pollx_f2b
    s_sleep 4
    s_cmp_ge_u32 s59, 0x8000
    s_cbranch_scc0 L_poll_f2b
L_pollx_f2b:
    s_add_u32 s55, s14, 40960
    buffer_load_dwordx4 v[32:35], v16, s[36:39], s55 offen
    buffer_load_dwordx2 v[64:65], v17, s[36:39], s55 offen
    s_add_u32 s55, s14, 46080
    buffer_load_dwordx4 v[36:39], v16, s[36:39], s55 offen
    buffer_load_dwordx2 v[66:67], v17, s[36:39], s55 offen
    s_add_u32 s55, s14, 51200
    buffer_load_dwordx4 v[40:43], v16, s[36:39], s55 offen
    buffer_load_dwordx2 v[68:69], v17, s[36:39], s55 offen
    s_add_u32 s55, s14, 56320
    buffer_load_dwordx4 v[44:47], v16, s[36:39], s55 offen
    buffer_load_dwordx2 v[70:71], v17, s[36:39], s55 offen
    s_add_u32 s55, s14, 61440
    buffer_load_dwordx4 v[48:51], v16, s[36:39], s55 offen
    buffer_load_dwordx2 v[72:73], v17, s[36:39], s55 offen
    s_add_u32 s55, s14, 66560
    buffer_load_dwordx4 v[52:55], v16, s[36:39], s55 offen
    buffer_load_dwordx2 v[74:75], v17, s[36:39], s55 offen
    s_add_u32 s55, s14, 71680
    buffer_load_dwordx4 v[56:59], v16, s[36:39], s55 offen
    buffer_load_dwordx2 v[76:77], v17, s[36:39], s55 offen
    s_add_u32 s55, s14, 76800
    buffer_load_dwordx4 v[60:63], v16, s[36:39], s55 offen
    buffer_load_dwordx2 v[78:79], v17, s[36:39], s55 offen
    s_waitcnt vmcnt(0)
    s_mov_b32 s55, 0x00003f80
    s_mov_b32 s56, 0x3f800000
    v_dot2_f32_bf16 v80, v32, s55, 0
    v_dot2_f32_bf16 v81, v32, s56, 0
    v_dot2_f32_bf16 v82, v33, s55, 0
    v_dot2_f32_bf16 v83, v33, s56, 0
    v_dot2_f32_bf16 v84, v34, s55, 0
    v_dot2_f32_bf16 v85, v34, s56, 0
    v_dot2_f32_bf16 v86, v35, s55, 0
    v_dot2_f32_bf16 v87, v35, s56, 0
    v_dot2_f32_bf16 v88, v64, s55, 0
    v_dot2_f32_bf16 v89, v64, s56, 0
    v_dot2_f32_bf16 v90, v65, s55, 0
    v_dot2_f32_bf16 v91, v65, s56, 0
    v_dot2_f32_bf16 v80, v36, s55, v80
    v_dot2_f32_bf16 v81, v36, s56, v81
    v_dot2_f32_bf16 v82, v37, s55, v82
    v_dot2_f32_bf16 v83, v37, s56, v83
    v_dot2_f32_bf16 v84, v38, s55, v84
    v_dot2_f32_bf16 v85, v38, s56, v85
    v_dot2_f32_bf16 v86, v39, s55, v86
    v_dot2_f32_bf16 v87, v39, s56, v87
    v_dot2_f32_bf16 v88, v66, s55, v88
    v_dot2_f32_bf16 v89, v66, s56, v89
    v_dot2_f32_bf16 v90, v67, s55, v90
    v_dot2_f32_bf16 v91, v67, s56, v91
    v_dot2_f32_bf16 v80, v40, s55, v80
    v_dot2_f32_bf16 v81, v40, s56, v81
    v_dot2_f32_bf16 v82, v41, s55, v82
    v_dot2_f32_bf16 v83, v41, s56, v83
    v_dot2_f32_bf16 v84, v42, s55, v84
    v_dot2_f32_bf16 v85, v42, s56, v85
    v_dot2_f32_bf16 v86, v43, s55, v86
    v_dot2_f32_bf16 v87, v43, s56, v87
    v_dot2_f32_bf16 v88, v68, s55, v88
    v_dot2_f32_bf16 v89, v68, s56, v89
    v_dot2_f32_bf16 v90, v69, s55, v90
    v_dot2_f32_bf16 v91, v69, s56, v91
    v_dot2_f32_bf16 v80, v44, s55, v80
    v_dot2_f32_bf16 v81, v44, s56, v81
    v_dot2_f32_bf16 v82, v45, s55, v82
    v_dot2_f32_bf16 v83, v45, s56, v83
    v_dot2_f32_bf16 v84, v46, s55, v84
    v_dot2_f32_bf16 v85, v46, s56, v85
    v_dot2_f32_bf16 v86, v47, s55, v86
    v_dot2_f32_bf16 v87, v47, s56, v87
    v_dot2_f32_bf16 v88, v70, s55, v88
    v_dot2_f32_bf16 v89, v70, s56, v89
    v_dot2_f32_bf16 v90, v71, s55, v90
    v_dot2_f32_bf16 v91, v71, s56, v91
    v_dot2_f32_bf16 v80, v48, s55, v80
    v_dot2_f32_bf16 v81, v48, s56, v81
    v_dot2_f32_bf16 v82, v49, s55, v82
    v_dot2_f32_bf16 v83, v49, s56, v83
    v_dot2_f32_bf16 v84, v50, s55, v84
    v_dot2_f32_bf16 v85, v50, s56, v85
    v_dot2_f32_bf16 v86, v51, s55, v86
    v_dot2_f32_bf16 v87, v51, s56, v87
    v_dot2_f32_bf16 v88, v72, s55, v88
    v_dot2_f32_bf16 v89, v72, s56, v89
    v_dot2_f32_bf16 v90, v73, s55, v90
    v_dot2_f32_bf16 v91, v73, s56, v91
    v_dot2_f32_bf16 v80, v52, s55, v80
    v_dot2_f32_bf16 v81, v52, s56, v81
    v_dot2_f32_bf16 v82, v53, s55, v82
    v_dot2_f32_bf16 v83, v53, s56, v83
    v_dot2_f32_bf16 v84, v54, s55, v84
    v_dot2_f32_bf16 v85, v54, s56, v85
    v_dot2_f32_bf16 v86, v55, s55, v86
    v_dot2_f32_bf16 v87, v55, s56, v87
    v_dot2_f32_bf16 v88, v74, s55, v88
    v_dot2_f32_bf16 v89, v74, s56, v89
    v_dot2_f32_bf16 v90, v75, s55, v90
    v_dot2_f32_bf16 v91, v75, s56, v91
    v_dot2_f32_bf16 v80, v56, s55, v80
    v_dot2_f32_bf16 v81, v56, s56, v81
    v_dot2_f32_bf16 v82, v57, s55, v82
    v_dot2_f32_bf16 v83, v57, s56, v83
    v_dot2_f32_bf16 v84, v58, s55, v84
    v_dot2_f32_bf16 v85, v58, s56, v85
    v_dot2_f32_bf16 v86, v59, s55, v86
    v_dot2_f32_bf16 v87, v59, s56, v87
    v_dot2_f32_bf16 v88, v76, s55, v88
    v_dot2_f32_bf16 v89, v76, s56, v89
    v_dot2_f32_bf16 v90, v77, s55, v90
    v_dot2_f32_bf16 v91, v77, s56, v91
    v_dot2_f32_bf16 v80, v60, s55, v80
    v_dot2_f32_bf16 v81, v60, s56, v81
    v_dot2_f32_bf16 v82, v61, s55, v82
    v_dot2_f32_bf16 v83, v61, s56, v83
    v_dot2_f32_bf16 v84, v62, s55, v84
    v_dot2_f32_bf16 v85, v62, s56, v85
    v_dot2_f32_bf16 v86, v63, s55, v86
    v_dot2_f32_bf16 v87, v63, s56, v87
    v_dot2_f32_bf16 v88, v78, s55, v88
    v_dot2_f32_bf16 v89, v78, s56, v89
    v_dot2_f32_bf16 v90, v79, s55, v90
    v_dot2_f32_bf16 v91, v79, s56, v91
    s_nop 2
    v_cvt_pk_bf16_f32 v92, v80, v81
    v_cvt_pk_bf16_f32 v93, v82, v83
    v_cvt_pk_bf16_f32 v94, v84, v85
    v_cvt_pk_bf16_f32 v95, v86, v87
    v_cvt_pk_bf16_f32 v96, v88, v89
    v_cvt_pk_bf16_f32 v97, v90, v91
    s_add_u32 s54, s15, 36864
    s_cmp_ge_u32 s3, 1
    s_cselect_b32 s55, 0x7ffff000, s54
    s_lshl_b32 s56, s3, 6
    s_add_u32 s54, s54, s56
    buffer_store_dwordx2 v[92:93], v18, s[44:47], s54 offen
    buffer_store_dwordx2 v[94:95], v18, s[44:47], s54 offen offset:32
    buffer_store_dwordx2 v[96:97], v18, s[44:47], s55 offen offset:256
    s_endpgm
L_fallback:
    s_waitcnt vmcnt(0) lgkmcnt(0)
    s_barrier
    v_lshrrev_b32 v3, 4, v1
    v_and_b32 v5, 15, v1
    v_mov_b32 v6, v3
    v_add_u32 v4, 0, v3
    v_xor_b32 v4, v4, v5
    v_lshlrev_b32 v4, 4, v4
    v_lshl_add_u32 v20, v6, 8, v4
    v_add_u32 v4, 4, v3
    v_xor_b32 v4, v4, v5
    v_lshlrev_b32 v4, 4, v4
    v_lshl_add_u32 v21, v6, 8, v4
    v_add_u32 v4, 8, v3
    v_xor_b32 v4, v4, v5
    v_lshlrev_b32 v4, 4, v4
    v_lshl_add_u32 v22, v6, 8, v4
    v_add_u32 v4, 12, v3
    v_xor_b32 v4, v4, v5
    v_lshlrev_b32 v4, 4, v4
    v_lshl_add_u32 v23, v6, 8, v4
    v_add_u32 v4, 0, v3
    v_lshlrev_b32 v4, 1, v4
    v_xor_b32 v4, v4, v5
    v_lshlrev_b32 v4, 4, v4
    v_lshl_add_u32 v24, v6, 8, v4
    v_add_u32 v4, 4, v3
    v_lshlrev_b32 v4, 1, v4
    v_xor_b32 v4, v4, v5
    v_lshlrev_b32 v4, 4, v4
    v_lshl_add_u32 v25, v6, 8, v4
    v_lshrrev_b32 v2, 4, v1
    v_bfe_u32 v3, v1, 2, 2
    v_and_b32 v4, 3, v1
    v_and_b32 v5, 15, v1
    v_lshlrev_b32 v6, 8, v5
    v_add_u32 v7, 0, v2
    v_xor_b32 v7, v7, v5
    v_lshl_add_u32 v8, v7, 4, v6
    v_add_u32 v7, 4, v2
    v_xor_b32 v7, v7, v5
    v_lshl_add_u32 v9, v7, 4, v6
    v_add_u32 v7, 8, v2
    v_xor_b32 v7, v7, v5
    v_lshl_add_u32 v10, v7, 4, v6
    v_add_u32 v7, 12, v2
    v_xor_b32 v7, v7, v5
    v_lshl_add_u32 v11, v7, 4, v6
    v_lshl_add_u32 v6, v2, 2, v3
    v_and_b32 v30, 7, v6
    v_lshlrev_b32 v30, 1, v30
    v_lshlrev_b32 v6, 8, v6
    v_and_b32 v7, 1, v4
    v_lshl_add_u32 v6, v7, 3, v6
    v_add_u32 v6, 65536, v6
    v_lshrrev_b32 v31, 1, v4
    v_add_u32 v7, 0, v31
    v_xor_b32 v7, v7, v30
    v_lshl_add_u32 v12, v7, 4, v6
    v_add_u32 v7, 2, v31
    v_xor_b32 v7, v7, v30
    v_lshl_add_u32 v13, v7, 4, v6
    v_add_u32 v7, 4, v31
    v_xor_b32 v7, v7, v30
    v_lshl_add_u32 v14, v7, 4, v6
    v_add_u32 v7, 6, v31
    v_xor_b32 v7, v7, v30
    v_lshl_add_u32 v15, v7, 4, v6
    v_add_u32 v7, 8, v31
    v_xor_b32 v7, v7, v30
    v_lshl_add_u32 v16, v7, 4, v6
    v_add_u32 v7, 10, v31
    v_xor_b32 v7, v7, v30
    v_lshl_add_u32 v17, v7, 4, v6
    v_add_u32 v7, 12, v31
    v_xor_b32 v7, v7, v30
    v_lshl_add_u32 v18, v7, 4, v6
    v_add_u32 v7, 14, v31
    v_xor_b32 v7, v7, v30
    v_lshl_add_u32 v19, v7, 4, v6
    v_mov_b32 v26, 0xff800000
    v_mov_b32 v27, 0xff800000
    v_mov_b32 v28, 0xff800000
    v_mov_b32 v29, 0xff800000
    s_mov_b32 s49, s48
L_fb_loop:
    s_mov_b32 m0, s48
    s_nop 0
    buffer_load_dwordx4 v20, s[28:31], s49 offen offset:0 nt lds
    buffer_load_dwordx4 v21, s[28:31], s49 offen offset:1024 nt lds
    buffer_load_dwordx4 v22, s[28:31], s49 offen offset:2048 nt lds
    buffer_load_dwordx4 v23, s[28:31], s49 offen offset:3072 nt lds
    s_waitcnt vmcnt(0)
    s_barrier
    ds_read_b128 a[64:67], v8 offset:0
    ds_read_b128 a[68:71], v8 offset:4096
    ds_read_b128 a[72:75], v9 offset:0
    ds_read_b128 a[76:79], v9 offset:4096
    ds_read_b128 a[80:83], v10 offset:0
    ds_read_b128 a[84:87], v10 offset:4096
    ds_read_b128 a[88:91], v11 offset:0
    ds_read_b128 a[92:95], v11 offset:4096
    s_waitcnt lgkmcnt(0)
    v_mfma_f32_16x16x32_bf16 v[32:35], a[64:67], a[0:3], 0
    v_mfma_f32_16x16x32_bf16 v[36:39], a[68:71], a[0:3], 0
    v_mfma_f32_16x16x32_bf16 v[32:35], a[72:75], a[4:7], v[32:35]
    v_mfma_f32_16x16x32_bf16 v[36:39], a[76:79], a[4:7], v[36:39]
    v_mfma_f32_16x16x32_bf16 v[32:35], a[80:83], a[8:11], v[32:35]
    v_mfma_f32_16x16x32_bf16 v[36:39], a[84:87], a[8:11], v[36:39]
    v_mfma_f32_16x16x32_bf16 v[32:35], a[88:91], a[12:15], v[32:35]
    v_mfma_f32_16x16x32_bf16 v[36:39], a[92:95], a[12:15], v[36:39]
    v_mfma_f32_16x16x32_bf16 v[40:43], a[64:67], a[16:19], 0
    v_mfma_f32_16x16x32_bf16 v[44:47], a[68:71], a[16:19], 0
    v_mfma_f32_16x16x32_bf16 v[40:43], a[72:75], a[20:23], v[40:43]
    v_mfma_f32_16x16x32_bf16 v[44:47], a[76:79], a[20:23], v[44:47]
    v_mfma_f32_16x16x32_bf16 v[40:43], a[80:83], a[24:27], v[40:43]
    v_mfma_f32_16x16x32_bf16 v[44:47], a[84:87], a[24:27], v[44:47]
    v_mfma_f32_16x16x32_bf16 v[40:43], a[88:91], a[28:31], v[40:43]
    v_mfma_f32_16x16x32_bf16 v[44:47], a[92:95], a[28:31], v[44:47]
    v_mfma_f32_16x16x32_bf16 v[48:51], a[64:67], a[32:35], 0
    v_mfma_f32_16x16x32_bf16 v[52:55], a[68:71], a[32:35], 0
    v_mfma_f32_16x16x32_bf16 v[48:51], a[72:75], a[36:39], v[48:51]
    v_mfma_f32_16x16x32_bf16 v[52:55], a[76:79], a[36:39], v[52:55]
    v_mfma_f32_16x16x32_bf16 v[48:51], a[80:83], a[40:43], v[48:51]
    v_mfma_f32_16x16x32_bf16 v[52:55], a[84:87], a[40:43], v[52:55]
    v_mfma_f32_16x16x32_bf16 v[48:51], a[88:91], a[44:47], v[48:51]
    v_mfma_f32_16x16x32_bf16 v[52:55], a[92:95], a[44:47], v[52:55]
    v_mfma_f32_16x16x32_bf16 v[56:59], a[64:67], a[48:51], 0
    v_mfma_f32_16x16x32_bf16 v[60:63], a[68:71], a[48:51], 0
    v_mfma_f32_16x16x32_bf16 v[56:59], a[72:75], a[52:55], v[56:59]
    v_mfma_f32_16x16x32_bf16 v[60:63], a[76:79], a[52:55], v[60:63]
    v_mfma_f32_16x16x32_bf16 v[56:59], a[80:83], a[56:59], v[56:59]
    v_mfma_f32_16x16x32_bf16 v[60:63], a[84:87], a[56:59], v[60:63]
    v_mfma_f32_16x16x32_bf16 v[56:59], a[88:91], a[60:63], v[56:59]
    v_mfma_f32_16x16x32_bf16 v[60:63], a[92:95], a[60:63], v[60:63]
    s_nop 7
    v_max3_f32 v26, v26, v32, v33
    v_max3_f32 v26, v26, v34, v35
    v_max3_f32 v26, v26, v36, v37
    v_max3_f32 v26, v26, v38, v39
    v_max3_f32 v27, v27, v40, v41
    v_max3_f32 v27, v27, v42, v43
    v_max3_f32 v27, v27, v44, v45
    v_max3_f32 v27, v27, v46, v47
    v_max3_f32 v28, v28, v48, v49
    v_max3_f32 v28, v28, v50, v51
    v_max3_f32 v28, v28, v52, v53
    v_max3_f32 v28, v28, v54, v55
    v_max3_f32 v29, v29, v56, v57
    v_max3_f32 v29, v29, v58, v59
    v_max3_f32 v29, v29, v60, v61
    v_max3_f32 v29, v29, v62, v63
    ds_read_b128 a[64:67], v8 offset:8192
    ds_read_b128 a[68:71], v8 offset:12288
    ds_read_b128 a[72:75], v9 offset:8192
    ds_read_b128 a[76:79], v9 offset:12288
    ds_read_b128 a[80:83], v10 offset:8192
    ds_read_b128 a[84:87], v10 offset:12288
    ds_read_b128 a[88:91], v11 offset:8192
    ds_read_b128 a[92:95], v11 offset:12288
    s_waitcnt lgkmcnt(0)
    v_mfma_f32_16x16x32_bf16 v[32:35], a[64:67], a[0:3], 0
    v_mfma_f32_16x16x32_bf16 v[36:39], a[68:71], a[0:3], 0
    v_mfma_f32_16x16x32_bf16 v[32:35], a[72:75], a[4:7], v[32:35]
    v_mfma_f32_16x16x32_bf16 v[36:39], a[76:79], a[4:7], v[36:39]
    v_mfma_f32_16x16x32_bf16 v[32:35], a[80:83], a[8:11], v[32:35]
    v_mfma_f32_16x16x32_bf16 v[36:39], a[84:87], a[8:11], v[36:39]
    v_mfma_f32_16x16x32_bf16 v[32:35], a[88:91], a[12:15], v[32:35]
    v_mfma_f32_16x16x32_bf16 v[36:39], a[92:95], a[12:15], v[36:39]
    v_mfma_f32_16x16x32_bf16 v[40:43], a[64:67], a[16:19], 0
    v_mfma_f32_16x16x32_bf16 v[44:47], a[68:71], a[16:19], 0
    v_mfma_f32_16x16x32_bf16 v[40:43], a[72:75], a[20:23], v[40:43]
    v_mfma_f32_16x16x32_bf16 v[44:47], a[76:79], a[20:23], v[44:47]
    v_mfma_f32_16x16x32_bf16 v[40:43], a[80:83], a[24:27], v[40:43]
    v_mfma_f32_16x16x32_bf16 v[44:47], a[84:87], a[24:27], v[44:47]
    v_mfma_f32_16x16x32_bf16 v[40:43], a[88:91], a[28:31], v[40:43]
    v_mfma_f32_16x16x32_bf16 v[44:47], a[92:95], a[28:31], v[44:47]
    v_mfma_f32_16x16x32_bf16 v[48:51], a[64:67], a[32:35], 0
    v_mfma_f32_16x16x32_bf16 v[52:55], a[68:71], a[32:35], 0
    v_mfma_f32_16x16x32_bf16 v[48:51], a[72:75], a[36:39], v[48:51]
    v_mfma_f32_16x16x32_bf16 v[52:55], a[76:79], a[36:39], v[52:55]
    v_mfma_f32_16x16x32_bf16 v[48:51], a[80:83], a[40:43], v[48:51]
    v_mfma_f32_16x16x32_bf16 v[52:55], a[84:87], a[40:43], v[52:55]
    v_mfma_f32_16x16x32_bf16 v[48:51], a[88:91], a[44:47], v[48:51]
    v_mfma_f32_16x16x32_bf16 v[52:55], a[92:95], a[44:47], v[52:55]
    v_mfma_f32_16x16x32_bf16 v[56:59], a[64:67], a[48:51], 0
    v_mfma_f32_16x16x32_bf16 v[60:63], a[68:71], a[48:51], 0
    v_mfma_f32_16x16x32_bf16 v[56:59], a[72:75], a[52:55], v[56:59]
    v_mfma_f32_16x16x32_bf16 v[60:63], a[76:79], a[52:55], v[60:63]
    v_mfma_f32_16x16x32_bf16 v[56:59], a[80:83], a[56:59], v[56:59]
    v_mfma_f32_16x16x32_bf16 v[60:63], a[84:87], a[56:59], v[60:63]
    v_mfma_f32_16x16x32_bf16 v[56:59], a[88:91], a[60:63], v[56:59]
    v_mfma_f32_16x16x32_bf16 v[60:63], a[92:95], a[60:63], v[60:63]
    s_nop 7
    v_max3_f32 v26, v26, v32, v33
    v_max3_f32 v26, v26, v34, v35
    v_max3_f32 v26, v26, v36, v37
    v_max3_f32 v26, v26, v38, v39
    v_max3_f32 v27, v27, v40, v41
    v_max3_f32 v27, v27, v42, v43
    v_max3_f32 v27, v27, v44, v45
    v_max3_f32 v27, v27, v46, v47
    v_max3_f32 v28, v28, v48, v49
    v_max3_f32 v28, v28, v50, v51
    v_max3_f32 v28, v28, v52, v53
    v_max3_f32 v28, v28, v54, v55
    v_max3_f32 v29, v29, v56, v57
    v_max3_f32 v29, v29, v58, v59
    v_max3_f32 v29, v29, v60, v61
    v_max3_f32 v29, v29, v62, v63
    s_barrier
    s_add_u32 s49, s49, 16384
    s_cmp_lt_u32 s49, 262144
    s_cbranch_scc1 L_fb_loop
    s_mov_b32 m0, s48
    s_mov_b32 s49, s70
    buffer_load_dwordx4 v20, s[28:31], s49 offen offset:0 nt lds
    buffer_load_dwordx4 v21, s[28:31], s49 offen offset:1024 nt lds
    buffer_load_dwordx4 v22, s[28:31], s49 offen offset:2048 nt lds
    buffer_load_dwordx4 v23, s[28:31], s49 offen offset:3072 nt lds
    s_lshl_b32 s56, s3, 11
    s_add_u32 m0, s56, 73728
    s_sub_u32 s56, s70, s56
    buffer_load_dwordx4 v24, s[32:35], s56 offen offset:0 nt lds
    buffer_load_dwordx4 v25, s[32:35], s56 offen offset:1024 nt lds
    s_add_u32 m0, s48, 16384
    s_add_u32 s49, s70, 16384
    s_and_b32 s49, s49, 0x3ffff
    buffer_load_dwordx4 v20, s[28:31], s49 offen offset:0 nt lds
    buffer_load_dwordx4 v21, s[28:31], s49 offen offset:1024 nt lds
    buffer_load_dwordx4 v22, s[28:31], s49 offen offset:2048 nt lds
    buffer_load_dwordx4 v23, s[28:31], s49 offen offset:3072 nt lds
    s_add_u32 m0, s48, 81920
    s_add_u32 s50, s70, 8192
    s_and_b32 s50, s50, 0x3ffff
    buffer_load_dwordx4 v24, s[32:35], s50 offen offset:0 nt lds
    buffer_load_dwordx4 v25, s[32:35], s50 offen offset:1024 nt lds
    buffer_load_dwordx4 v24, s[32:35], s50 offen offset:2048 nt lds
    buffer_load_dwordx4 v25, s[32:35], s50 offen offset:3072 nt lds
    s_add_u32 m0, s48, 98304
    s_add_u32 s50, s70, 24576
    s_and_b32 s50, s50, 0x3ffff
    buffer_load_dwordx4 v24, s[32:35], s50 offen offset:0 nt lds
    buffer_load_dwordx4 v25, s[32:35], s50 offen offset:1024 nt lds
    buffer_load_dwordx4 v24, s[32:35], s50 offen offset:2048 nt lds
    buffer_load_dwordx4 v25, s[32:35], s50 offen offset:3072 nt lds
    s_add_u32 m0, s48, 32768
    s_add_u32 s49, s70, 32768
    s_and_b32 s49, s49, 0x3ffff
    buffer_load_dwordx4 v20, s[28:31], s49 offen offset:0 nt lds
    buffer_load_dwordx4 v21, s[28:31], s49 offen offset:1024 nt lds
    buffer_load_dwordx4 v22, s[28:31], s49 offen offset:2048 nt lds
    buffer_load_dwordx4 v23, s[28:31], s49 offen offset:3072 nt lds
    s_mov_b32 s67, 1
    s_branch L_p2start
L_end:
    s_endpgm
.p2align 6
L_codeend:
.section .rodata,"a"
.p2align 6
.amdhsa_kernel standalone__mha_block_cached__near_ridge_kernel
.amdhsa_next_free_vgpr 512
.amdhsa_next_free_sgpr 102
.amdhsa_accum_offset 256
.amdhsa_group_segment_fixed_size 0
.amdhsa_kernarg_size 64
.amdhsa_user_sgpr_count 2
.amdhsa_user_sgpr_kernarg_segment_ptr 1
.amdhsa_system_sgpr_workgroup_id_x 1
.end_amdhsa_kernel
```
